```python
import torch

def _softmax(x, axis=-1):
    return torch.softmax(x, dim=axis)
def _gelu(x):
    return torch.nn.functional.gelu(x, approximate="tanh")
def _silu(x):
    return torch.nn.functional.silu(x)
def _sigmoid(x):
    return torch.sigmoid(x)
def _layernorm(x, axis=-1, eps=1e-5):
    m = x.mean(dim=axis, keepdim=True)
    v = x.var(dim=axis, keepdim=True, unbiased=False)
    return (x - m) / torch.sqrt(v + eps)
def _scatter_add(tgt, idx, src, axis=0):
    return tgt.clone().index_add_(axis, idx, src)
def _segment_sum(src, seg, n):
    out = torch.zeros((n,) + src.shape[1:], dtype=src.dtype)
    return out.index_add_(0, seg, src)
def _pad(x, pw):
    flat = tuple(v for pair in reversed(pw) for v in pair)
    return torch.nn.functional.pad(x, flat)

kernel_name = 'concat_heads__mha_block_cached__mha_block_cached__near_ridge'

def setup_inputs():

    _w = (lambda a: (lambda t: t.to(torch.bfloat16) if t.is_floating_point() else t)(torch.as_tensor(a)))
    def _A_setup():
        B, Sq, D = 8, 208, 512
        H, Sk, Dh = 32, 512, 128
        return {
            "x": _w((lambda *s: torch.randn(*s, dtype=torch.bfloat16) * 0.8)(B, Sq, D)),
            "k_cache": _w((lambda *s: torch.randn(*s, dtype=torch.bfloat16) * 0.8)(B, H, Sk, Dh)),
            "v_cache": _w((lambda *s: torch.randn(*s, dtype=torch.bfloat16) * 0.05)(B, H, Sk, Dh)),
            "wq": _w((lambda *s: torch.randn(*s, dtype=torch.bfloat16) * 0.8)(D, H * Dh) * (D ** -0.5)),
            "wo": _w((lambda *s: torch.randn(*s, dtype=torch.bfloat16) * 0.05)(H * Dh, D) * ((H * Dh) ** -0.5)),
        }
    _A_in = _A_setup()

    def _B_setup():
        B, Sq, D = 8, 208, 512
        H, Sk, Dh = 32, 512, 128
        return {
            "x": _w((lambda *s: torch.randn(*s, dtype=torch.bfloat16) * 0.8)(B, Sq, D)),
            "k_cache": _w((lambda *s: torch.randn(*s, dtype=torch.bfloat16) * 0.8)(B, H, Sk, Dh)),
            "v_cache": _w((lambda *s: torch.randn(*s, dtype=torch.bfloat16) * 0.05)(B, H, Sk, Dh)),
            "wq": _w((lambda *s: torch.randn(*s, dtype=torch.bfloat16) * 0.8)(D, H * Dh) * (D ** -0.5)),
            "wo": _w((lambda *s: torch.randn(*s, dtype=torch.bfloat16) * 0.05)(H * Dh, D) * ((H * Dh) ** -0.5)),
        }
    _B_in = _B_setup()

    return {
        "A_x": _A_in["x"],
        "A_k_cache": _A_in["k_cache"],
        "A_v_cache": _A_in["v_cache"],
        "A_wq": _A_in["wq"],
        "A_wo": _A_in["wo"],
        "B_x": _B_in["x"],
        "B_k_cache": _B_in["k_cache"],
        "B_v_cache": _B_in["v_cache"],
        "B_wq": _B_in["wq"],
        "B_wo": _B_in["wo"],
    }

def reference(A_x, A_k_cache, A_v_cache, A_wq, A_wo, B_x, B_k_cache, B_v_cache, B_wq, B_wo):
    def _A_ref(x, k_cache, v_cache, wq, wo):
        B, Sq, D = x.shape
        H, Dh = 32, 128
        q = (lambda x, *d: x.permute(*d))((x @ wq).reshape(B, Sq, H, Dh), 0, 2, 1, 3)
        scores = torch.einsum("bhqd,bhkd->bhqk", q, k_cache) * (Dh ** -0.5)
        p = _softmax(scores, axis=-1)
        o = torch.einsum("bhqk,bhkd->bhqd", p, v_cache)
        return (lambda x, *d: x.permute(*d))(o, 0, 2, 1, 3).reshape(B, Sq, H * Dh) @ wo

    def _B_ref(x, k_cache, v_cache, wq, wo):
        B, Sq, D = x.shape
        H, Dh = 32, 128
        q = (lambda x, *d: x.permute(*d))((x @ wq).reshape(B, Sq, H, Dh), 0, 2, 1, 3)
        scores = torch.einsum("bhqd,bhkd->bhqk", q, k_cache) * (Dh ** -0.5)
        p = _softmax(scores, axis=-1)
        o = torch.einsum("bhqk,bhkd->bhqd", p, v_cache)
        return (lambda x, *d: x.permute(*d))(o, 0, 2, 1, 3).reshape(B, Sq, H * Dh) @ wo

    a = _A_ref(A_x, A_k_cache, A_v_cache, A_wq, A_wo)
    b = _B_ref(B_x, B_k_cache, B_v_cache, B_wq, B_wo)
    return torch.concatenate([a, b], axis=-1)
```

```asm
; @launch kernel=concat_heads__mha_block_cached__mha_block_cached__near_ridge_kernel grid=(256,1,1) block=(512,1,1) lds=163840
; @launch kernel=oproj_kernel grid=(256,1,1) block=(512,1,1) lds=65536
.amdgcn_target "amdgcn-amd-amdhsa--gfx950"
.text
.globl concat_heads__mha_block_cached__mha_block_cached__near_ridge_kernel
.p2align 8
.type concat_heads__mha_block_cached__mha_block_cached__near_ridge_kernel,@function
concat_heads__mha_block_cached__mha_block_cached__near_ridge_kernel:
    s_cmp_ge_u32 s2, 256
    s_cbranch_scc1 k1_done
    s_and_b32 s58, s2, 7
    s_lshr_b32 s59, s2, 3
    s_lshr_b32 s3, s58, 2
    s_lshl_b32 s3, s3, 7
    s_and_b32 s58, s58, 3
    s_lshl_b32 s58, s58, 2
    s_add_u32 s3, s3, s58
    s_and_b32 s58, s59, 3
    s_add_u32 s3, s3, s58
    s_lshr_b32 s59, s59, 2
    s_lshl_b32 s59, s59, 4
    s_add_u32 s3, s3, s59
    s_lshr_b32 s37, s3, 7
    s_mul_i32 s38, s37, 40
    s_add_u32 s4, s0, s38
    s_addc_u32 s5, s1, 0
    s_load_dwordx8 s[48:55], s[4:5], 0
    s_load_dwordx2 s[56:57], s[0:1], 96
    s_load_dwordx2 s[98:99], s[4:5], 32
    v_lshrrev_b32 v245, 6, v0
    s_nop 0
    v_readfirstlane_b32 s29, v245
    v_and_b32 v240, 63, v0
    v_lshrrev_b32 v241, 4, v240
    v_and_b32 v242, 15, v240
    v_lshrrev_b32 v243, 2, v242
    v_and_b32 v244, 3, v242
    v_lshlrev_b32 v239, 4, v240
    s_and_b32 s28, s29, 3
    s_lshr_b32 s30, s29, 2
    s_lshr_b32 s45, s3, 4
    s_and_b32 s45, s45, 7
    s_and_b32 s47, s3, 15
    s_lshl_b32 s47, s47, 1
    s_add_u32 s47, s47, s30
    s_lshl_b32 s38, s45, 5
    s_add_u32 s38, s38, s47
    s_waitcnt lgkmcnt(0)
    s_mul_i32 s58, s45, 212992
    s_add_u32 s20, s48, s58
    s_addc_u32 s21, s49, 0
    s_mov_b32 s22, 212992
    s_mov_b32 s23, 131072
    s_lshl_b32 s58, s38, 17
    s_add_u32 s8, s50, s58
    s_addc_u32 s9, s51, 0
    s_mov_b32 s10, 131072
    s_mov_b32 s11, 131072
    s_add_u32 s12, s52, s58
    s_addc_u32 s13, s53, 0
    s_mov_b32 s14, 131072
    s_mov_b32 s15, 131072
    s_lshl_b32 s58, s47, 8
    s_add_u32 s16, s54, s58
    s_addc_u32 s17, s55, 0
    s_sub_u32 s18, 4194304, s58
    s_mov_b32 s19, 131072
    s_lshl_b32 s58, s37, 3
    s_add_u32 s58, s58, s45
    s_mul_i32 s58, s58, 1703936
    s_lshl_b32 s59, s47, 12
    s_add_u32 s58, s58, s59
    s_add_u32 s24, s56, s58
    s_addc_u32 s25, s57, 0
    s_mov_b32 s26, 1576960
    s_mov_b32 s27, 131072
    s_mov_b32 s48, s98
    s_mov_b32 s49, s99
    s_mov_b32 s50, 4194304
    s_mov_b32 s51, 131072
    s_mov_b32 s31, 0x41800000
    s_mov_b32 s46, 0x3e0293ee
    s_lshl_b32 s40, s28, 10
    s_lshl_b32 s41, s29, 10
    s_lshl_b32 s6, s29, 13
    s_lshl_b32 s42, s28, 15
    s_mul_i32 s37, s30, 67584
    s_mul_i32 s43, s28, 1088
    s_add_u32 s43, s43, s37
    s_add_u32 s44, s40, s37
    s_add_u32 s44, s44, 8704
    s_lshl_b32 s5, s30, 13
    s_add_u32 s5, s5, s40
    s_and_b32 s38, s28, 1
    s_lshl_b32 s38, s38, 2
    v_or_b32 v237, s38, v241
    v_and_b32 v245, 7, v240
    v_xor_b32 v237, v237, v245
    v_lshlrev_b32 v237, 4, v237
    v_lshrrev_b32 v245, 3, v240
    v_lshl_add_u32 v237, v245, 10, v237
    v_or_b32 v252, s38, v241
    v_lshlrev_b32 v252, 1, v252
    v_xor_b32 v252, v242, v252
    v_lshlrev_b32 v252, 4, v252
    v_lshl_add_u32 v252, v241, 8, v252
    v_lshrrev_b32 v235, 1, v242
    v_xor_b32 v235, v235, v241
    v_lshlrev_b32 v235, 4, v235
    v_lshl_add_u32 v235, v242, 7, v235
    v_xor_b32 v236, 64, v235
    s_mul_i32 s38, s28, 6144
    v_add_u32 v233, s38, v235
    v_add_u32 v234, s38, v236
    v_xor_b32 v251, v242, v241
    v_lshlrev_b32 v251, 4, v251
    v_lshl_add_u32 v251, v241, 8, v251
    s_and_b32 s38, s28, 2
    s_lshl_b32 s38, s38, 1
    v_or_b32 v232, s38, v241
    v_lshlrev_b32 v232, 1, v232
    v_xor_b32 v232, v242, v232
    v_lshlrev_b32 v232, 4, v232
    v_lshl_add_u32 v232, v241, 13, v232
    v_and_b32 v245, 1, v241
    v_lshl_add_u32 v245, v245, 2, v243
    v_lshlrev_b32 v245, 5, v245
    v_lshl_add_u32 v245, v244, 3, v245
    v_lshl_add_u32 v245, v243, 8, v245
    v_lshl_add_u32 v238, v241, 11, v245
    s_lshl_b32 s38, s30, 13
    s_add_u32 s38, s38, 65536
    v_add_u32 v238, s38, v238
    v_lshl_add_u32 v250, v241, 10, v245
    s_add_u32 s38, s37, 8704
    v_add_u32 v250, s38, v250
    v_xor_b32 v245, v241, v244
    v_lshlrev_b32 v245, 4, v245
    v_lshl_add_u32 v245, v244, 8, v245
    v_mul_u32_u24 v249, 1088, v243
    v_add3_u32 v249, v249, v245, s37
    s_add_u32 m0, s5, 65536
    s_add_u32 s37, s42, 0
    buffer_load_dwordx4 v232, s[16:19], s37 offen lds
    s_add_u32 m0, s5, 69632
    s_add_u32 s37, s42, 131072
    buffer_load_dwordx4 v232, s[16:19], s37 offen lds
    s_add_u32 m0, s41, 0
    s_add_u32 s37, s6, 0
    buffer_load_dwordx4 v237, s[20:23], s37 offen lds
    s_add_u32 m0, s41, 8192
    s_add_u32 s37, s6, 65536
    buffer_load_dwordx4 v237, s[20:23], s37 offen lds
    s_add_u32 m0, s41, 16384
    s_add_u32 s37, s6, 131072
    buffer_load_dwordx4 v237, s[20:23], s37 offen lds
    s_add_u32 m0, s41, 24576
    s_add_u32 s37, s6, 196608
    buffer_load_dwordx4 v237, s[20:23], s37 offen lds
    s_add_u32 m0, s5, 81920
    s_add_u32 s37, s42, 262144
    buffer_load_dwordx4 v232, s[16:19], s37 offen lds
    s_add_u32 m0, s5, 86016
    s_add_u32 s37, s42, 393216
    buffer_load_dwordx4 v232, s[16:19], s37 offen lds
    s_add_u32 m0, s5, 98304
    s_add_u32 s37, s42, 524288
    buffer_load_dwordx4 v232, s[16:19], s37 offen lds
    s_add_u32 m0, s5, 102400
    s_add_u32 s37, s42, 655360
    buffer_load_dwordx4 v232, s[16:19], s37 offen lds
    s_add_u32 m0, s5, 114688
    s_add_u32 s37, s42, 786432
    buffer_load_dwordx4 v232, s[16:19], s37 offen lds
    s_add_u32 m0, s5, 118784
    s_add_u32 s37, s42, 917504
    buffer_load_dwordx4 v232, s[16:19], s37 offen lds
    s_add_u32 m0, s5, 131072
    s_add_u32 s37, s42, 1048576
    buffer_load_dwordx4 v232, s[16:19], s37 offen lds
    s_add_u32 m0, s5, 135168
    s_add_u32 s37, s42, 1179648
    buffer_load_dwordx4 v232, s[16:19], s37 offen lds
    s_add_u32 m0, s41, 32768
    s_add_u32 s37, s6, 128
    buffer_load_dwordx4 v237, s[20:23], s37 offen lds
    s_add_u32 m0, s41, 40960
    s_add_u32 s37, s6, 65664
    buffer_load_dwordx4 v237, s[20:23], s37 offen lds
    s_add_u32 m0, s41, 49152
    s_add_u32 s37, s6, 131200
    buffer_load_dwordx4 v237, s[20:23], s37 offen lds
    s_add_u32 m0, s41, 57344
    s_add_u32 s37, s6, 196736
    buffer_load_dwordx4 v237, s[20:23], s37 offen lds
    s_waitcnt vmcnt(12)
    s_barrier
    ds_read_b128 v[168:171], v233
    ds_read_b128 v[172:175], v233 offset:2048
    ds_read_b128 v[176:179], v233 offset:4096
    ds_read_b128 v[180:183], v235 offset:24576
    ds_read_b64_tr_b16 v[200:201], v238
    ds_read_b64_tr_b16 v[202:203], v238 offset:1024
    v_xor_b32 v241, 32, v238
    ds_read_b64_tr_b16 v[204:205], v241
    ds_read_b64_tr_b16 v[206:207], v241 offset:1024
    v_xor_b32 v242, 64, v238
    ds_read_b64_tr_b16 v[208:209], v242
    ds_read_b64_tr_b16 v[210:211], v242 offset:1024
    v_xor_b32 v243, 96, v238
    ds_read_b64_tr_b16 v[212:213], v243
    ds_read_b64_tr_b16 v[214:215], v243 offset:1024
    v_xor_b32 v240, 128, v238
    ds_read_b64_tr_b16 v[216:217], v240
    ds_read_b64_tr_b16 v[218:219], v240 offset:1024
    v_xor_b32 v241, 160, v238
    ds_read_b64_tr_b16 v[220:221], v241
    ds_read_b64_tr_b16 v[222:223], v241 offset:1024
    v_xor_b32 v242, 192, v238
    ds_read_b64_tr_b16 v[224:225], v242
    ds_read_b64_tr_b16 v[226:227], v242 offset:1024
    v_xor_b32 v243, 224, v238
    ds_read_b64_tr_b16 v[228:229], v243
    ds_read_b64_tr_b16 v[230:231], v243 offset:1024
    s_waitcnt lgkmcnt(15)
    s_waitcnt vmcnt(10)
    s_barrier
    ds_read_b128 v[184:187], v234
    ds_read_b128 v[188:191], v234 offset:2048
    ds_read_b128 v[192:195], v234 offset:4096
    ds_read_b128 v[196:199], v236 offset:24576
    s_waitcnt lgkmcnt(15)
    v_mfma_f32_16x16x32_bf16 v[0:3], v[200:203], v[168:171], 0
    v_mfma_f32_16x16x32_bf16 v[32:35], v[200:203], v[172:175], 0
    s_add_u32 m0, s5, 147456
    s_add_u32 s37, s42, 1310720
    buffer_load_dwordx4 v232, s[16:19], s37 offen lds
    v_mfma_f32_16x16x32_bf16 v[64:67], v[200:203], v[176:179], 0
    s_waitcnt lgkmcnt(15)
    v_mfma_f32_16x16x32_bf16 v[4:7], v[204:207], v[168:171], 0
    v_mfma_f32_16x16x32_bf16 v[36:39], v[204:207], v[172:175], 0
    s_add_u32 m0, s5, 151552
    s_add_u32 s37, s42, 1441792
    buffer_load_dwordx4 v232, s[16:19], s37 offen lds
    v_mfma_f32_16x16x32_bf16 v[68:71], v[204:207], v[176:179], 0
    s_cmp_eq_u32 s28, 0
    s_cbranch_scc0 k1_p1l_0_1
    v_mfma_f32_16x16x32_bf16 v[96:99], v[200:203], v[180:183], 0
    v_mfma_f32_16x16x32_bf16 v[100:103], v[204:207], v[180:183], 0
k1_p1l_0_1:
    ds_read_b64_tr_b16 v[200:201], v238 offset:16384
    ds_read_b64_tr_b16 v[202:203], v238 offset:17408
    v_xor_b32 v241, 32, v238
    ds_read_b64_tr_b16 v[204:205], v241 offset:16384
    ds_read_b64_tr_b16 v[206:207], v241 offset:17408
    s_waitcnt lgkmcnt(15)
    v_mfma_f32_16x16x32_bf16 v[8:11], v[208:211], v[168:171], 0
    v_mfma_f32_16x16x32_bf16 v[40:43], v[208:211], v[172:175], 0
    v_mfma_f32_16x16x32_bf16 v[72:75], v[208:211], v[176:179], 0
    s_waitcnt lgkmcnt(15)
    v_mfma_f32_16x16x32_bf16 v[12:15], v[212:215], v[168:171], 0
    v_mfma_f32_16x16x32_bf16 v[44:47], v[212:215], v[172:175], 0
    v_mfma_f32_16x16x32_bf16 v[76:79], v[212:215], v[176:179], 0
    s_cmp_eq_u32 s28, 1
    s_cbranch_scc0 k1_p1l_0_3
    v_mfma_f32_16x16x32_bf16 v[96:99], v[208:211], v[180:183], 0
    v_mfma_f32_16x16x32_bf16 v[100:103], v[212:215], v[180:183], 0
k1_p1l_0_3:
    v_xor_b32 v242, 64, v238
    ds_read_b64_tr_b16 v[208:209], v242 offset:16384
    ds_read_b64_tr_b16 v[210:211], v242 offset:17408
    v_xor_b32 v243, 96, v238
    ds_read_b64_tr_b16 v[212:213], v243 offset:16384
    ds_read_b64_tr_b16 v[214:215], v243 offset:17408
    s_waitcnt lgkmcnt(15)
    v_mfma_f32_16x16x32_bf16 v[16:19], v[216:219], v[168:171], 0
    v_mfma_f32_16x16x32_bf16 v[48:51], v[216:219], v[172:175], 0
    v_mfma_f32_16x16x32_bf16 v[80:83], v[216:219], v[176:179], 0
    s_waitcnt lgkmcnt(15)
    v_mfma_f32_16x16x32_bf16 v[20:23], v[220:223], v[168:171], 0
    v_mfma_f32_16x16x32_bf16 v[52:55], v[220:223], v[172:175], 0
    v_mfma_f32_16x16x32_bf16 v[84:87], v[220:223], v[176:179], 0
    s_cmp_eq_u32 s28, 2
    s_cbranch_scc0 k1_p1l_0_5
    v_mfma_f32_16x16x32_bf16 v[96:99], v[216:219], v[180:183], 0
    v_mfma_f32_16x16x32_bf16 v[100:103], v[220:223], v[180:183], 0
k1_p1l_0_5:
    v_xor_b32 v240, 128, v238
    ds_read_b64_tr_b16 v[216:217], v240 offset:16384
    ds_read_b64_tr_b16 v[218:219], v240 offset:17408
    v_xor_b32 v241, 160, v238
    ds_read_b64_tr_b16 v[220:221], v241 offset:16384
    ds_read_b64_tr_b16 v[222:223], v241 offset:17408
    s_waitcnt lgkmcnt(15)
    v_mfma_f32_16x16x32_bf16 v[24:27], v[224:227], v[168:171], 0
    v_mfma_f32_16x16x32_bf16 v[56:59], v[224:227], v[172:175], 0
    v_mfma_f32_16x16x32_bf16 v[88:91], v[224:227], v[176:179], 0
    s_waitcnt lgkmcnt(15)
    v_mfma_f32_16x16x32_bf16 v[28:31], v[228:231], v[168:171], 0
    v_mfma_f32_16x16x32_bf16 v[60:63], v[228:231], v[172:175], 0
    v_mfma_f32_16x16x32_bf16 v[92:95], v[228:231], v[176:179], 0
    s_cmp_eq_u32 s28, 3
    s_cbranch_scc0 k1_p1l_0_7
    v_mfma_f32_16x16x32_bf16 v[96:99], v[224:227], v[180:183], 0
    v_mfma_f32_16x16x32_bf16 v[100:103], v[228:231], v[180:183], 0
k1_p1l_0_7:
    v_xor_b32 v242, 192, v238
    ds_read_b64_tr_b16 v[224:225], v242 offset:16384
    ds_read_b64_tr_b16 v[226:227], v242 offset:17408
    v_xor_b32 v243, 224, v238
    ds_read_b64_tr_b16 v[228:229], v243 offset:16384
    ds_read_b64_tr_b16 v[230:231], v243 offset:17408
    s_waitcnt lgkmcnt(15)
    s_waitcnt vmcnt(2)
    s_barrier
    ds_read_b128 v[168:171], v233 offset:32768
    ds_read_b128 v[172:175], v233 offset:34816
    ds_read_b128 v[176:179], v233 offset:36864
    ds_read_b128 v[180:183], v235 offset:57344
    s_waitcnt lgkmcnt(15)
    v_mfma_f32_16x16x32_bf16 v[0:3], v[200:203], v[184:187], v[0:3]
    v_mfma_f32_16x16x32_bf16 v[32:35], v[200:203], v[188:191], v[32:35]
    s_add_u32 m0, s5, 65536
    s_add_u32 s37, s42, 1572864
    buffer_load_dwordx4 v232, s[16:19], s37 offen lds
    v_mfma_f32_16x16x32_bf16 v[64:67], v[200:203], v[192:195], v[64:67]
    s_waitcnt lgkmcnt(15)
    v_mfma_f32_16x16x32_bf16 v[4:7], v[204:207], v[184:187], v[4:7]
    v_mfma_f32_16x16x32_bf16 v[36:39], v[204:207], v[188:191], v[36:39]
    s_add_u32 m0, s5, 69632
    s_add_u32 s37, s42, 1703936
    buffer_load_dwordx4 v232, s[16:19], s37 offen lds
    v_mfma_f32_16x16x32_bf16 v[68:71], v[204:207], v[192:195], v[68:71]
    s_cmp_eq_u32 s28, 0
    s_cbranch_scc0 k1_p1l_1_1
    v_mfma_f32_16x16x32_bf16 v[96:99], v[200:203], v[196:199], v[96:99]
    v_mfma_f32_16x16x32_bf16 v[100:103], v[204:207], v[196:199], v[100:103]
k1_p1l_1_1:
    ds_read_b64_tr_b16 v[200:201], v238 offset:32768
    ds_read_b64_tr_b16 v[202:203], v238 offset:33792
    v_xor_b32 v241, 32, v238
    ds_read_b64_tr_b16 v[204:205], v241 offset:32768
    ds_read_b64_tr_b16 v[206:207], v241 offset:33792
    s_waitcnt lgkmcnt(15)
    v_mfma_f32_16x16x32_bf16 v[8:11], v[208:211], v[184:187], v[8:11]
    v_mfma_f32_16x16x32_bf16 v[40:43], v[208:211], v[188:191], v[40:43]
    s_add_u32 m0, s41, 0
    s_add_u32 s37, s6, 256
    buffer_load_dwordx4 v237, s[20:23], s37 offen lds
    v_mfma_f32_16x16x32_bf16 v[72:75], v[208:211], v[192:195], v[72:75]
    s_waitcnt lgkmcnt(15)
    v_mfma_f32_16x16x32_bf16 v[12:15], v[212:215], v[184:187], v[12:15]
    v_mfma_f32_16x16x32_bf16 v[44:47], v[212:215], v[188:191], v[44:47]
    s_add_u32 m0, s41, 8192
    s_add_u32 s37, s6, 65792
    buffer_load_dwordx4 v237, s[20:23], s37 offen lds
    v_mfma_f32_16x16x32_bf16 v[76:79], v[212:215], v[192:195], v[76:79]
    s_cmp_eq_u32 s28, 1
    s_cbranch_scc0 k1_p1l_1_3
    v_mfma_f32_16x16x32_bf16 v[96:99], v[208:211], v[196:199], v[96:99]
    v_mfma_f32_16x16x32_bf16 v[100:103], v[212:215], v[196:199], v[100:103]
k1_p1l_1_3:
    v_xor_b32 v242, 64, v238
    ds_read_b64_tr_b16 v[208:209], v242 offset:32768
    ds_read_b64_tr_b16 v[210:211], v242 offset:33792
    v_xor_b32 v243, 96, v238
    ds_read_b64_tr_b16 v[212:213], v243 offset:32768
    ds_read_b64_tr_b16 v[214:215], v243 offset:33792
    s_waitcnt lgkmcnt(15)
    v_mfma_f32_16x16x32_bf16 v[16:19], v[216:219], v[184:187], v[16:19]
    v_mfma_f32_16x16x32_bf16 v[48:51], v[216:219], v[188:191], v[48:51]
    s_add_u32 m0, s41, 16384
    s_add_u32 s37, s6, 131328
    buffer_load_dwordx4 v237, s[20:23], s37 offen lds
    v_mfma_f32_16x16x32_bf16 v[80:83], v[216:219], v[192:195], v[80:83]
    s_waitcnt lgkmcnt(15)
    v_mfma_f32_16x16x32_bf16 v[20:23], v[220:223], v[184:187], v[20:23]
    v_mfma_f32_16x16x32_bf16 v[52:55], v[220:223], v[188:191], v[52:55]
    s_add_u32 m0, s41, 24576
    s_add_u32 s37, s6, 196864
    buffer_load_dwordx4 v237, s[20:23], s37 offen lds
    v_mfma_f32_16x16x32_bf16 v[84:87], v[220:223], v[192:195], v[84:87]
    s_cmp_eq_u32 s28, 2
    s_cbranch_scc0 k1_p1l_1_5
    v_mfma_f32_16x16x32_bf16 v[96:99], v[216:219], v[196:199], v[96:99]
    v_mfma_f32_16x16x32_bf16 v[100:103], v[220:223], v[196:199], v[100:103]
k1_p1l_1_5:
    v_xor_b32 v240, 128, v238
    ds_read_b64_tr_b16 v[216:217], v240 offset:32768
    ds_read_b64_tr_b16 v[218:219], v240 offset:33792
    v_xor_b32 v241, 160, v238
    ds_read_b64_tr_b16 v[220:221], v241 offset:32768
    ds_read_b64_tr_b16 v[222:223], v241 offset:33792
    s_waitcnt lgkmcnt(15)
    v_mfma_f32_16x16x32_bf16 v[24:27], v[224:227], v[184:187], v[24:27]
    v_mfma_f32_16x16x32_bf16 v[56:59], v[224:227], v[188:191], v[56:59]
    v_mfma_f32_16x16x32_bf16 v[88:91], v[224:227], v[192:195], v[88:91]
    s_waitcnt lgkmcnt(15)
    v_mfma_f32_16x16x32_bf16 v[28:31], v[228:231], v[184:187], v[28:31]
    v_mfma_f32_16x16x32_bf16 v[60:63], v[228:231], v[188:191], v[60:63]
    v_mfma_f32_16x16x32_bf16 v[92:95], v[228:231], v[192:195], v[92:95]
    s_cmp_eq_u32 s28, 3
    s_cbranch_scc0 k1_p1l_1_7
    v_mfma_f32_16x16x32_bf16 v[96:99], v[224:227], v[196:199], v[96:99]
    v_mfma_f32_16x16x32_bf16 v[100:103], v[228:231], v[196:199], v[100:103]
k1_p1l_1_7:
    v_xor_b32 v242, 192, v238
    ds_read_b64_tr_b16 v[224:225], v242 offset:32768
    ds_read_b64_tr_b16 v[226:227], v242 offset:33792
    v_xor_b32 v243, 224, v238
    ds_read_b64_tr_b16 v[228:229], v243 offset:32768
    ds_read_b64_tr_b16 v[230:231], v243 offset:33792
    s_waitcnt lgkmcnt(15)
    s_waitcnt vmcnt(8)
    s_barrier
    ds_read_b128 v[184:187], v234 offset:32768
    ds_read_b128 v[188:191], v234 offset:34816
    ds_read_b128 v[192:195], v234 offset:36864
    ds_read_b128 v[196:199], v236 offset:57344
    s_waitcnt lgkmcnt(15)
    v_mfma_f32_16x16x32_bf16 v[0:3], v[200:203], v[168:171], v[0:3]
    v_mfma_f32_16x16x32_bf16 v[32:35], v[200:203], v[172:175], v[32:35]
    s_add_u32 m0, s5, 81920
    s_add_u32 s37, s42, 1835008
    buffer_load_dwordx4 v232, s[16:19], s37 offen lds
    v_mfma_f32_16x16x32_bf16 v[64:67], v[200:203], v[176:179], v[64:67]
    s_waitcnt lgkmcnt(15)
    v_mfma_f32_16x16x32_bf16 v[4:7], v[204:207], v[168:171], v[4:7]
    v_mfma_f32_16x16x32_bf16 v[36:39], v[204:207], v[172:175], v[36:39]
    s_add_u32 m0, s5, 86016
    s_add_u32 s37, s42, 1966080
    buffer_load_dwordx4 v232, s[16:19], s37 offen lds
    v_mfma_f32_16x16x32_bf16 v[68:71], v[204:207], v[176:179], v[68:71]
    s_cmp_eq_u32 s28, 0
    s_cbranch_scc0 k1_p1l_2_1
    v_mfma_f32_16x16x32_bf16 v[96:99], v[200:203], v[180:183], v[96:99]
    v_mfma_f32_16x16x32_bf16 v[100:103], v[204:207], v[180:183], v[100:103]
k1_p1l_2_1:
    ds_read_b64_tr_b16 v[200:201], v238 offset:49152
    ds_read_b64_tr_b16 v[202:203], v238 offset:50176
    v_xor_b32 v241, 32, v238
    ds_read_b64_tr_b16 v[204:205], v241 offset:49152
    ds_read_b64_tr_b16 v[206:207], v241 offset:50176
    s_waitcnt lgkmcnt(15)
    v_mfma_f32_16x16x32_bf16 v[8:11], v[208:211], v[168:171], v[8:11]
    v_mfma_f32_16x16x32_bf16 v[40:43], v[208:211], v[172:175], v[40:43]
    s_add_u32 s37, s40, 0
    buffer_load_dwordx4 v[104:107], v251, s[8:11], s37 offen nt
    v_mfma_f32_16x16x32_bf16 v[72:75], v[208:211], v[176:179], v[72:75]
    s_waitcnt lgkmcnt(15)
    v_mfma_f32_16x16x32_bf16 v[12:15], v[212:215], v[168:171], v[12:15]
    v_mfma_f32_16x16x32_bf16 v[44:47], v[212:215], v[172:175], v[44:47]
    v_mfma_f32_16x16x32_bf16 v[76:79], v[212:215], v[176:179], v[76:79]
    s_cmp_eq_u32 s28, 1
    s_cbranch_scc0 k1_p1l_2_3
    v_mfma_f32_16x16x32_bf16 v[96:99], v[208:211], v[180:183], v[96:99]
    v_mfma_f32_16x16x32_bf16 v[100:103], v[212:215], v[180:183], v[100:103]
k1_p1l_2_3:
    v_xor_b32 v242, 64, v238
    ds_read_b64_tr_b16 v[208:209], v242 offset:49152
    ds_read_b64_tr_b16 v[210:211], v242 offset:50176
    v_xor_b32 v243, 96, v238
    ds_read_b64_tr_b16 v[212:213], v243 offset:49152
    ds_read_b64_tr_b16 v[214:215], v243 offset:50176
    s_waitcnt lgkmcnt(15)
    v_mfma_f32_16x16x32_bf16 v[16:19], v[216:219], v[168:171], v[16:19]
    v_mfma_f32_16x16x32_bf16 v[48:51], v[216:219], v[172:175], v[48:51]
    v_mfma_f32_16x16x32_bf16 v[80:83], v[216:219], v[176:179], v[80:83]
    s_waitcnt lgkmcnt(15)
    v_mfma_f32_16x16x32_bf16 v[20:23], v[220:223], v[168:171], v[20:23]
    v_mfma_f32_16x16x32_bf16 v[52:55], v[220:223], v[172:175], v[52:55]
    v_mfma_f32_16x16x32_bf16 v[84:87], v[220:223], v[176:179], v[84:87]
    s_cmp_eq_u32 s28, 2
    s_cbranch_scc0 k1_p1l_2_5
    v_mfma_f32_16x16x32_bf16 v[96:99], v[216:219], v[180:183], v[96:99]
    v_mfma_f32_16x16x32_bf16 v[100:103], v[220:223], v[180:183], v[100:103]
k1_p1l_2_5:
    v_xor_b32 v240, 128, v238
    ds_read_b64_tr_b16 v[216:217], v240 offset:49152
    ds_read_b64_tr_b16 v[218:219], v240 offset:50176
    v_xor_b32 v241, 160, v238
    ds_read_b64_tr_b16 v[220:221], v241 offset:49152
    ds_read_b64_tr_b16 v[222:223], v241 offset:50176
    s_waitcnt lgkmcnt(15)
    v_mfma_f32_16x16x32_bf16 v[24:27], v[224:227], v[168:171], v[24:27]
    v_mfma_f32_16x16x32_bf16 v[56:59], v[224:227], v[172:175], v[56:59]
    v_mfma_f32_16x16x32_bf16 v[88:91], v[224:227], v[176:179], v[88:91]
    s_waitcnt lgkmcnt(15)
    v_mfma_f32_16x16x32_bf16 v[28:31], v[228:231], v[168:171], v[28:31]
    v_mfma_f32_16x16x32_bf16 v[60:63], v[228:231], v[172:175], v[60:63]
    v_mfma_f32_16x16x32_bf16 v[92:95], v[228:231], v[176:179], v[92:95]
    s_cmp_eq_u32 s28, 3
    s_cbranch_scc0 k1_p1l_2_7
    v_mfma_f32_16x16x32_bf16 v[96:99], v[224:227], v[180:183], v[96:99]
    v_mfma_f32_16x16x32_bf16 v[100:103], v[228:231], v[180:183], v[100:103]
k1_p1l_2_7:
    v_xor_b32 v242, 192, v238
    ds_read_b64_tr_b16 v[224:225], v242 offset:49152
    ds_read_b64_tr_b16 v[226:227], v242 offset:50176
    v_xor_b32 v243, 224, v238
    ds_read_b64_tr_b16 v[228:229], v243 offset:49152
    ds_read_b64_tr_b16 v[230:231], v243 offset:50176
    s_waitcnt lgkmcnt(15)
    s_waitcnt vmcnt(3)
    s_barrier
    ds_read_b128 v[168:171], v233
    ds_read_b128 v[172:175], v233 offset:2048
    ds_read_b128 v[176:179], v233 offset:4096
    ds_read_b128 v[180:183], v235 offset:24576
    s_waitcnt lgkmcnt(15)
    v_mfma_f32_16x16x32_bf16 v[0:3], v[200:203], v[184:187], v[0:3]
    v_mfma_f32_16x16x32_bf16 v[32:35], v[200:203], v[188:191], v[32:35]
    s_add_u32 m0, s5, 98304
    s_add_u32 s37, s42, 2097152
    buffer_load_dwordx4 v232, s[16:19], s37 offen lds
    v_mfma_f32_16x16x32_bf16 v[64:67], v[200:203], v[192:195], v[64:67]
    s_waitcnt lgkmcnt(15)
    v_mfma_f32_16x16x32_bf16 v[4:7], v[204:207], v[184:187], v[4:7]
    v_mfma_f32_16x16x32_bf16 v[36:39], v[204:207], v[188:191], v[36:39]
    s_add_u32 m0, s5, 102400
    s_add_u32 s37, s42, 2228224
    buffer_load_dwordx4 v232, s[16:19], s37 offen lds
    v_mfma_f32_16x16x32_bf16 v[68:71], v[204:207], v[192:195], v[68:71]
    s_cmp_eq_u32 s28, 0
    s_cbranch_scc0 k1_p1l_3_1
    v_mfma_f32_16x16x32_bf16 v[96:99], v[200:203], v[196:199], v[96:99]
    v_mfma_f32_16x16x32_bf16 v[100:103], v[204:207], v[196:199], v[100:103]
k1_p1l_3_1:
    v_add_u32 v240, 65536, v238
    ds_read_b64_tr_b16 v[200:201], v240
    ds_read_b64_tr_b16 v[202:203], v240 offset:1024
    v_xor_b32 v241, 32, v238
    v_add_u32 v241, 65536, v241
    ds_read_b64_tr_b16 v[204:205], v241
    ds_read_b64_tr_b16 v[206:207], v241 offset:1024
    s_waitcnt lgkmcnt(15)
    v_mfma_f32_16x16x32_bf16 v[8:11], v[208:211], v[184:187], v[8:11]
    v_mfma_f32_16x16x32_bf16 v[40:43], v[208:211], v[188:191], v[40:43]
    s_add_u32 m0, s41, 32768
    s_add_u32 s37, s6, 384
    buffer_load_dwordx4 v237, s[20:23], s37 offen lds
    v_mfma_f32_16x16x32_bf16 v[72:75], v[208:211], v[192:195], v[72:75]
    s_waitcnt lgkmcnt(15)
    v_mfma_f32_16x16x32_bf16 v[12:15], v[212:215], v[184:187], v[12:15]
    v_mfma_f32_16x16x32_bf16 v[44:47], v[212:215], v[188:191], v[44:47]
    s_add_u32 m0, s41, 40960
    s_add_u32 s37, s6, 65920
    buffer_load_dwordx4 v237, s[20:23], s37 offen lds
    v_mfma_f32_16x16x32_bf16 v[76:79], v[212:215], v[192:195], v[76:79]
    s_cmp_eq_u32 s28, 1
    s_cbranch_scc0 k1_p1l_3_3
    v_mfma_f32_16x16x32_bf16 v[96:99], v[208:211], v[196:199], v[96:99]
    v_mfma_f32_16x16x32_bf16 v[100:103], v[212:215], v[196:199], v[100:103]
k1_p1l_3_3:
    v_xor_b32 v242, 64, v238
    v_add_u32 v242, 65536, v242
    ds_read_b64_tr_b16 v[208:209], v242
    ds_read_b64_tr_b16 v[210:211], v242 offset:1024
    v_xor_b32 v243, 96, v238
    v_add_u32 v243, 65536, v243
    ds_read_b64_tr_b16 v[212:213], v243
    ds_read_b64_tr_b16 v[214:215], v243 offset:1024
    s_waitcnt lgkmcnt(15)
    v_mfma_f32_16x16x32_bf16 v[16:19], v[216:219], v[184:187], v[16:19]
    v_mfma_f32_16x16x32_bf16 v[48:51], v[216:219], v[188:191], v[48:51]
    s_add_u32 m0, s41, 49152
    s_add_u32 s37, s6, 131456
    buffer_load_dwordx4 v237, s[20:23], s37 offen lds
    v_mfma_f32_16x16x32_bf16 v[80:83], v[216:219], v[192:195], v[80:83]
    s_waitcnt lgkmcnt(15)
    v_mfma_f32_16x16x32_bf16 v[20:23], v[220:223], v[184:187], v[20:23]
    v_mfma_f32_16x16x32_bf16 v[52:55], v[220:223], v[188:191], v[52:55]
    s_add_u32 m0, s41, 57344
    s_add_u32 s37, s6, 196992
    buffer_load_dwordx4 v237, s[20:23], s37 offen lds
    v_mfma_f32_16x16x32_bf16 v[84:87], v[220:223], v[192:195], v[84:87]
    s_cmp_eq_u32 s28, 2
    s_cbranch_scc0 k1_p1l_3_5
    v_mfma_f32_16x16x32_bf16 v[96:99], v[216:219], v[196:199], v[96:99]
    v_mfma_f32_16x16x32_bf16 v[100:103], v[220:223], v[196:199], v[100:103]
k1_p1l_3_5:
    v_xor_b32 v240, 128, v238
    v_add_u32 v240, 65536, v240
    ds_read_b64_tr_b16 v[216:217], v240
    ds_read_b64_tr_b16 v[218:219], v240 offset:1024
    v_xor_b32 v241, 160, v238
    v_add_u32 v241, 65536, v241
    ds_read_b64_tr_b16 v[220:221], v241
    ds_read_b64_tr_b16 v[222:223], v241 offset:1024
    s_waitcnt lgkmcnt(15)
    v_mfma_f32_16x16x32_bf16 v[24:27], v[224:227], v[184:187], v[24:27]
    v_mfma_f32_16x16x32_bf16 v[56:59], v[224:227], v[188:191], v[56:59]
    s_add_u32 s37, s40, 4096
    buffer_load_dwordx4 v[108:111], v251, s[8:11], s37 offen nt
    v_mfma_f32_16x16x32_bf16 v[88:91], v[224:227], v[192:195], v[88:91]
    s_waitcnt lgkmcnt(15)
    v_mfma_f32_16x16x32_bf16 v[28:31], v[228:231], v[184:187], v[28:31]
    v_mfma_f32_16x16x32_bf16 v[60:63], v[228:231], v[188:191], v[60:63]
    v_mfma_f32_16x16x32_bf16 v[92:95], v[228:231], v[192:195], v[92:95]
    s_cmp_eq_u32 s28, 3
    s_cbranch_scc0 k1_p1l_3_7
    v_mfma_f32_16x16x32_bf16 v[96:99], v[224:227], v[196:199], v[96:99]
    v_mfma_f32_16x16x32_bf16 v[100:103], v[228:231], v[196:199], v[100:103]
k1_p1l_3_7:
    v_xor_b32 v242, 192, v238
    v_add_u32 v242, 65536, v242
    ds_read_b64_tr_b16 v[224:225], v242
    ds_read_b64_tr_b16 v[226:227], v242 offset:1024
    v_xor_b32 v243, 224, v238
    v_add_u32 v243, 65536, v243
    ds_read_b64_tr_b16 v[228:229], v243
    ds_read_b64_tr_b16 v[230:231], v243 offset:1024
    s_waitcnt lgkmcnt(15)
    s_waitcnt vmcnt(10)
    s_barrier
    ds_read_b128 v[184:187], v234
    ds_read_b128 v[188:191], v234 offset:2048
    ds_read_b128 v[192:195], v234 offset:4096
    ds_read_b128 v[196:199], v236 offset:24576
    s_waitcnt lgkmcnt(15)
    v_mfma_f32_16x16x32_bf16 v[0:3], v[200:203], v[168:171], v[0:3]
    v_mfma_f32_16x16x32_bf16 v[32:35], v[200:203], v[172:175], v[32:35]
    s_add_u32 m0, s5, 114688
    s_add_u32 s37, s42, 2359296
    buffer_load_dwordx4 v232, s[16:19], s37 offen lds
    v_mfma_f32_16x16x32_bf16 v[64:67], v[200:203], v[176:179], v[64:67]
    s_waitcnt lgkmcnt(15)
    v_mfma_f32_16x16x32_bf16 v[4:7], v[204:207], v[168:171], v[4:7]
    v_mfma_f32_16x16x32_bf16 v[36:39], v[204:207], v[172:175], v[36:39]
    s_add_u32 m0, s5, 118784
    s_add_u32 s37, s42, 2490368
    buffer_load_dwordx4 v232, s[16:19], s37 offen lds
    v_mfma_f32_16x16x32_bf16 v[68:71], v[204:207], v[176:179], v[68:71]
    s_cmp_eq_u32 s28, 0
    s_cbranch_scc0 k1_p1l_4_1
    v_mfma_f32_16x16x32_bf16 v[96:99], v[200:203], v[180:183], v[96:99]
    v_mfma_f32_16x16x32_bf16 v[100:103], v[204:207], v[180:183], v[100:103]
k1_p1l_4_1:
    v_add_u32 v240, 65536, v238
    ds_read_b64_tr_b16 v[200:201], v240 offset:16384
    ds_read_b64_tr_b16 v[202:203], v240 offset:17408
    v_xor_b32 v241, 32, v238
    v_add_u32 v241, 65536, v241
    ds_read_b64_tr_b16 v[204:205], v241 offset:16384
    ds_read_b64_tr_b16 v[206:207], v241 offset:17408
    s_waitcnt lgkmcnt(15)
    v_mfma_f32_16x16x32_bf16 v[8:11], v[208:211], v[168:171], v[8:11]
    v_mfma_f32_16x16x32_bf16 v[40:43], v[208:211], v[172:175], v[40:43]
    s_add_u32 s37, s40, 0
    buffer_load_dwordx4 v[112:115], v252, s[12:15], s37 offen nt
    v_mfma_f32_16x16x32_bf16 v[72:75], v[208:211], v[176:179], v[72:75]
    s_waitcnt lgkmcnt(15)
    v_mfma_f32_16x16x32_bf16 v[12:15], v[212:215], v[168:171], v[12:15]
    v_mfma_f32_16x16x32_bf16 v[44:47], v[212:215], v[172:175], v[44:47]
    v_mfma_f32_16x16x32_bf16 v[76:79], v[212:215], v[176:179], v[76:79]
    s_cmp_eq_u32 s28, 1
    s_cbranch_scc0 k1_p1l_4_3
    v_mfma_f32_16x16x32_bf16 v[96:99], v[208:211], v[180:183], v[96:99]
    v_mfma_f32_16x16x32_bf16 v[100:103], v[212:215], v[180:183], v[100:103]
k1_p1l_4_3:
    v_xor_b32 v242, 64, v238
    v_add_u32 v242, 65536, v242
    ds_read_b64_tr_b16 v[208:209], v242 offset:16384
    ds_read_b64_tr_b16 v[210:211], v242 offset:17408
    v_xor_b32 v243, 96, v238
    v_add_u32 v243, 65536, v243
    ds_read_b64_tr_b16 v[212:213], v243 offset:16384
    ds_read_b64_tr_b16 v[214:215], v243 offset:17408
    s_waitcnt lgkmcnt(15)
    v_mfma_f32_16x16x32_bf16 v[16:19], v[216:219], v[168:171], v[16:19]
    v_mfma_f32_16x16x32_bf16 v[48:51], v[216:219], v[172:175], v[48:51]
    v_mfma_f32_16x16x32_bf16 v[80:83], v[216:219], v[176:179], v[80:83]
    s_waitcnt lgkmcnt(15)
    v_mfma_f32_16x16x32_bf16 v[20:23], v[220:223], v[168:171], v[20:23]
    v_mfma_f32_16x16x32_bf16 v[52:55], v[220:223], v[172:175], v[52:55]
    v_mfma_f32_16x16x32_bf16 v[84:87], v[220:223], v[176:179], v[84:87]
    s_cmp_eq_u32 s28, 2
    s_cbranch_scc0 k1_p1l_4_5
    v_mfma_f32_16x16x32_bf16 v[96:99], v[216:219], v[180:183], v[96:99]
    v_mfma_f32_16x16x32_bf16 v[100:103], v[220:223], v[180:183], v[100:103]
k1_p1l_4_5:
    v_xor_b32 v240, 128, v238
    v_add_u32 v240, 65536, v240
    ds_read_b64_tr_b16 v[216:217], v240 offset:16384
    ds_read_b64_tr_b16 v[218:219], v240 offset:17408
    v_xor_b32 v241, 160, v238
    v_add_u32 v241, 65536, v241
    ds_read_b64_tr_b16 v[220:221], v241 offset:16384
    ds_read_b64_tr_b16 v[222:223], v241 offset:17408
    s_waitcnt lgkmcnt(15)
    v_mfma_f32_16x16x32_bf16 v[24:27], v[224:227], v[168:171], v[24:27]
    v_mfma_f32_16x16x32_bf16 v[56:59], v[224:227], v[172:175], v[56:59]
    v_mfma_f32_16x16x32_bf16 v[88:91], v[224:227], v[176:179], v[88:91]
    s_waitcnt lgkmcnt(15)
    v_mfma_f32_16x16x32_bf16 v[28:31], v[228:231], v[168:171], v[28:31]
    v_mfma_f32_16x16x32_bf16 v[60:63], v[228:231], v[172:175], v[60:63]
    v_mfma_f32_16x16x32_bf16 v[92:95], v[228:231], v[176:179], v[92:95]
    s_cmp_eq_u32 s28, 3
    s_cbranch_scc0 k1_p1l_4_7
    v_mfma_f32_16x16x32_bf16 v[96:99], v[224:227], v[180:183], v[96:99]
    v_mfma_f32_16x16x32_bf16 v[100:103], v[228:231], v[180:183], v[100:103]
k1_p1l_4_7:
    v_xor_b32 v242, 192, v238
    v_add_u32 v242, 65536, v242
    ds_read_b64_tr_b16 v[224:225], v242 offset:16384
    ds_read_b64_tr_b16 v[226:227], v242 offset:17408
    v_xor_b32 v243, 224, v238
    v_add_u32 v243, 65536, v243
    ds_read_b64_tr_b16 v[228:229], v243 offset:16384
    ds_read_b64_tr_b16 v[230:231], v243 offset:17408
    s_waitcnt lgkmcnt(15)
    s_waitcnt vmcnt(4)
    s_barrier
    ds_read_b128 v[168:171], v233 offset:32768
    ds_read_b128 v[172:175], v233 offset:34816
    ds_read_b128 v[176:179], v233 offset:36864
    ds_read_b128 v[180:183], v235 offset:57344
    s_waitcnt lgkmcnt(15)
    v_mfma_f32_16x16x32_bf16 v[0:3], v[200:203], v[184:187], v[0:3]
    v_mfma_f32_16x16x32_bf16 v[32:35], v[200:203], v[188:191], v[32:35]
    s_add_u32 m0, s5, 131072
    s_add_u32 s37, s42, 2621440
    buffer_load_dwordx4 v232, s[16:19], s37 offen lds
    v_mfma_f32_16x16x32_bf16 v[64:67], v[200:203], v[192:195], v[64:67]
    s_waitcnt lgkmcnt(15)
    v_mfma_f32_16x16x32_bf16 v[4:7], v[204:207], v[184:187], v[4:7]
    v_mfma_f32_16x16x32_bf16 v[36:39], v[204:207], v[188:191], v[36:39]
    s_add_u32 m0, s5, 135168
    s_add_u32 s37, s42, 2752512
    buffer_load_dwordx4 v232, s[16:19], s37 offen lds
    v_mfma_f32_16x16x32_bf16 v[68:71], v[204:207], v[192:195], v[68:71]
    s_cmp_eq_u32 s28, 0
    s_cbranch_scc0 k1_p1l_5_1
    v_mfma_f32_16x16x32_bf16 v[96:99], v[200:203], v[196:199], v[96:99]
    v_mfma_f32_16x16x32_bf16 v[100:103], v[204:207], v[196:199], v[100:103]
k1_p1l_5_1:
    ds_read_b64_tr_b16 v[200:201], v238
    ds_read_b64_tr_b16 v[202:203], v238 offset:1024
    v_xor_b32 v241, 32, v238
    ds_read_b64_tr_b16 v[204:205], v241
    ds_read_b64_tr_b16 v[206:207], v241 offset:1024
    s_waitcnt lgkmcnt(15)
    v_mfma_f32_16x16x32_bf16 v[8:11], v[208:211], v[184:187], v[8:11]
    v_mfma_f32_16x16x32_bf16 v[40:43], v[208:211], v[188:191], v[40:43]
    s_add_u32 m0, s41, 0
    s_add_u32 s37, s6, 512
    buffer_load_dwordx4 v237, s[20:23], s37 offen lds
    v_mfma_f32_16x16x32_bf16 v[72:75], v[208:211], v[192:195], v[72:75]
    s_waitcnt lgkmcnt(15)
    v_mfma_f32_16x16x32_bf16 v[12:15], v[212:215], v[184:187], v[12:15]
    v_mfma_f32_16x16x32_bf16 v[44:47], v[212:215], v[188:191], v[44:47]
    s_add_u32 m0, s41, 8192
    s_add_u32 s37, s6, 66048
    buffer_load_dwordx4 v237, s[20:23], s37 offen lds
    v_mfma_f32_16x16x32_bf16 v[76:79], v[212:215], v[192:195], v[76:79]
    s_cmp_eq_u32 s28, 1
    s_cbranch_scc0 k1_p1l_5_3
    v_mfma_f32_16x16x32_bf16 v[96:99], v[208:211], v[196:199], v[96:99]
    v_mfma_f32_16x16x32_bf16 v[100:103], v[212:215], v[196:199], v[100:103]
k1_p1l_5_3:
    v_xor_b32 v242, 64, v238
    ds_read_b64_tr_b16 v[208:209], v242
    ds_read_b64_tr_b16 v[210:211], v242 offset:1024
    v_xor_b32 v243, 96, v238
    ds_read_b64_tr_b16 v[212:213], v243
    ds_read_b64_tr_b16 v[214:215], v243 offset:1024
    s_waitcnt lgkmcnt(15)
    v_mfma_f32_16x16x32_bf16 v[16:19], v[216:219], v[184:187], v[16:19]
    v_mfma_f32_16x16x32_bf16 v[48:51], v[216:219], v[188:191], v[48:51]
    s_add_u32 m0, s41, 16384
    s_add_u32 s37, s6, 131584
    buffer_load_dwordx4 v237, s[20:23], s37 offen lds
    v_mfma_f32_16x16x32_bf16 v[80:83], v[216:219], v[192:195], v[80:83]
    s_waitcnt lgkmcnt(15)
    v_mfma_f32_16x16x32_bf16 v[20:23], v[220:223], v[184:187], v[20:23]
    v_mfma_f32_16x16x32_bf16 v[52:55], v[220:223], v[188:191], v[52:55]
    s_add_u32 m0, s41, 24576
    s_add_u32 s37, s6, 197120
    buffer_load_dwordx4 v237, s[20:23], s37 offen lds
    v_mfma_f32_16x16x32_bf16 v[84:87], v[220:223], v[192:195], v[84:87]
    s_cmp_eq_u32 s28, 2
    s_cbranch_scc0 k1_p1l_5_5
    v_mfma_f32_16x16x32_bf16 v[96:99], v[216:219], v[196:199], v[96:99]
    v_mfma_f32_16x16x32_bf16 v[100:103], v[220:223], v[196:199], v[100:103]
k1_p1l_5_5:
    v_xor_b32 v240, 128, v238
    ds_read_b64_tr_b16 v[216:217], v240
    ds_read_b64_tr_b16 v[218:219], v240 offset:1024
    v_xor_b32 v241, 160, v238
    ds_read_b64_tr_b16 v[220:221], v241
    ds_read_b64_tr_b16 v[222:223], v241 offset:1024
    s_waitcnt lgkmcnt(15)
    v_mfma_f32_16x16x32_bf16 v[24:27], v[224:227], v[184:187], v[24:27]
    v_mfma_f32_16x16x32_bf16 v[56:59], v[224:227], v[188:191], v[56:59]
    s_add_u32 s37, s40, 4096
    buffer_load_dwordx4 v[116:119], v252, s[12:15], s37 offen nt
    v_mfma_f32_16x16x32_bf16 v[88:91], v[224:227], v[192:195], v[88:91]
    s_waitcnt lgkmcnt(15)
    v_mfma_f32_16x16x32_bf16 v[28:31], v[228:231], v[184:187], v[28:31]
    v_mfma_f32_16x16x32_bf16 v[60:63], v[228:231], v[188:191], v[60:63]
    v_mfma_f32_16x16x32_bf16 v[92:95], v[228:231], v[192:195], v[92:95]
    s_cmp_eq_u32 s28, 3
    s_cbranch_scc0 k1_p1l_5_7
    v_mfma_f32_16x16x32_bf16 v[96:99], v[224:227], v[196:199], v[96:99]
    v_mfma_f32_16x16x32_bf16 v[100:103], v[228:231], v[196:199], v[100:103]
k1_p1l_5_7:
    v_xor_b32 v242, 192, v238
    ds_read_b64_tr_b16 v[224:225], v242
    ds_read_b64_tr_b16 v[226:227], v242 offset:1024
    v_xor_b32 v243, 224, v238
    ds_read_b64_tr_b16 v[228:229], v243
    ds_read_b64_tr_b16 v[230:231], v243 offset:1024
    s_waitcnt lgkmcnt(15)
    s_waitcnt vmcnt(11)
    s_barrier
    ds_read_b128 v[184:187], v234 offset:32768
    ds_read_b128 v[188:191], v234 offset:34816
    ds_read_b128 v[192:195], v234 offset:36864
    ds_read_b128 v[196:199], v236 offset:57344
    s_waitcnt lgkmcnt(15)
    v_mfma_f32_16x16x32_bf16 v[0:3], v[200:203], v[168:171], v[0:3]
    v_mfma_f32_16x16x32_bf16 v[32:35], v[200:203], v[172:175], v[32:35]
    s_add_u32 m0, s5, 147456
    s_add_u32 s37, s42, 2883584
    buffer_load_dwordx4 v232, s[16:19], s37 offen lds
    v_mfma_f32_16x16x32_bf16 v[64:67], v[200:203], v[176:179], v[64:67]
    s_waitcnt lgkmcnt(15)
    v_mfma_f32_16x16x32_bf16 v[4:7], v[204:207], v[168:171], v[4:7]
    v_mfma_f32_16x16x32_bf16 v[36:39], v[204:207], v[172:175], v[36:39]
    s_add_u32 m0, s5, 151552
    s_add_u32 s37, s42, 3014656
    buffer_load_dwordx4 v232, s[16:19], s37 offen lds
    v_mfma_f32_16x16x32_bf16 v[68:71], v[204:207], v[176:179], v[68:71]
    s_cmp_eq_u32 s28, 0
    s_cbranch_scc0 k1_p1l_6_1
    v_mfma_f32_16x16x32_bf16 v[96:99], v[200:203], v[180:183], v[96:99]
    v_mfma_f32_16x16x32_bf16 v[100:103], v[204:207], v[180:183], v[100:103]
k1_p1l_6_1:
    ds_read_b64_tr_b16 v[200:201], v238 offset:16384
    ds_read_b64_tr_b16 v[202:203], v238 offset:17408
    v_xor_b32 v241, 32, v238
    ds_read_b64_tr_b16 v[204:205], v241 offset:16384
    ds_read_b64_tr_b16 v[206:207], v241 offset:17408
    s_waitcnt lgkmcnt(15)
    v_mfma_f32_16x16x32_bf16 v[8:11], v[208:211], v[168:171], v[8:11]
    v_mfma_f32_16x16x32_bf16 v[40:43], v[208:211], v[172:175], v[40:43]
    s_add_u32 s37, s40, 8192
    buffer_load_dwordx4 v[120:123], v251, s[8:11], s37 offen nt
    v_mfma_f32_16x16x32_bf16 v[72:75], v[208:211], v[176:179], v[72:75]
    s_waitcnt lgkmcnt(15)
    v_mfma_f32_16x16x32_bf16 v[12:15], v[212:215], v[168:171], v[12:15]
    v_mfma_f32_16x16x32_bf16 v[44:47], v[212:215], v[172:175], v[44:47]
    v_mfma_f32_16x16x32_bf16 v[76:79], v[212:215], v[176:179], v[76:79]
    s_cmp_eq_u32 s28, 1
    s_cbranch_scc0 k1_p1l_6_3
    v_mfma_f32_16x16x32_bf16 v[96:99], v[208:211], v[180:183], v[96:99]
    v_mfma_f32_16x16x32_bf16 v[100:103], v[212:215], v[180:183], v[100:103]
k1_p1l_6_3:
    v_xor_b32 v242, 64, v238
    ds_read_b64_tr_b16 v[208:209], v242 offset:16384
    ds_read_b64_tr_b16 v[210:211], v242 offset:17408
    v_xor_b32 v243, 96, v238
    ds_read_b64_tr_b16 v[212:213], v243 offset:16384
    ds_read_b64_tr_b16 v[214:215], v243 offset:17408
    s_waitcnt lgkmcnt(15)
    v_mfma_f32_16x16x32_bf16 v[16:19], v[216:219], v[168:171], v[16:19]
    v_mfma_f32_16x16x32_bf16 v[48:51], v[216:219], v[172:175], v[48:51]
    v_mfma_f32_16x16x32_bf16 v[80:83], v[216:219], v[176:179], v[80:83]
    s_waitcnt lgkmcnt(15)
    v_mfma_f32_16x16x32_bf16 v[20:23], v[220:223], v[168:171], v[20:23]
    v_mfma_f32_16x16x32_bf16 v[52:55], v[220:223], v[172:175], v[52:55]
    v_mfma_f32_16x16x32_bf16 v[84:87], v[220:223], v[176:179], v[84:87]
    s_cmp_eq_u32 s28, 2
    s_cbranch_scc0 k1_p1l_6_5
    v_mfma_f32_16x16x32_bf16 v[96:99], v[216:219], v[180:183], v[96:99]
    v_mfma_f32_16x16x32_bf16 v[100:103], v[220:223], v[180:183], v[100:103]
k1_p1l_6_5:
    v_xor_b32 v240, 128, v238
    ds_read_b64_tr_b16 v[216:217], v240 offset:16384
    ds_read_b64_tr_b16 v[218:219], v240 offset:17408
    v_xor_b32 v241, 160, v238
    ds_read_b64_tr_b16 v[220:221], v241 offset:16384
    ds_read_b64_tr_b16 v[222:223], v241 offset:17408
    s_waitcnt lgkmcnt(15)
    v_mfma_f32_16x16x32_bf16 v[24:27], v[224:227], v[168:171], v[24:27]
    v_mfma_f32_16x16x32_bf16 v[56:59], v[224:227], v[172:175], v[56:59]
    v_mfma_f32_16x16x32_bf16 v[88:91], v[224:227], v[176:179], v[88:91]
    s_waitcnt lgkmcnt(15)
    v_mfma_f32_16x16x32_bf16 v[28:31], v[228:231], v[168:171], v[28:31]
    v_mfma_f32_16x16x32_bf16 v[60:63], v[228:231], v[172:175], v[60:63]
    v_mfma_f32_16x16x32_bf16 v[92:95], v[228:231], v[176:179], v[92:95]
    s_cmp_eq_u32 s28, 3
    s_cbranch_scc0 k1_p1l_6_7
    v_mfma_f32_16x16x32_bf16 v[96:99], v[224:227], v[180:183], v[96:99]
    v_mfma_f32_16x16x32_bf16 v[100:103], v[228:231], v[180:183], v[100:103]
k1_p1l_6_7:
    v_xor_b32 v242, 192, v238
    ds_read_b64_tr_b16 v[224:225], v242 offset:16384
    ds_read_b64_tr_b16 v[226:227], v242 offset:17408
    v_xor_b32 v243, 224, v238
    ds_read_b64_tr_b16 v[228:229], v243 offset:16384
    ds_read_b64_tr_b16 v[230:231], v243 offset:17408
    s_waitcnt lgkmcnt(15)
    s_waitcnt vmcnt(4)
    s_barrier
    ds_read_b128 v[168:171], v233
    ds_read_b128 v[172:175], v233 offset:2048
    ds_read_b128 v[176:179], v233 offset:4096
    ds_read_b128 v[180:183], v235 offset:24576
    s_waitcnt lgkmcnt(15)
    v_mfma_f32_16x16x32_bf16 v[0:3], v[200:203], v[184:187], v[0:3]
    v_mfma_f32_16x16x32_bf16 v[32:35], v[200:203], v[188:191], v[32:35]
    s_add_u32 m0, s5, 65536
    s_add_u32 s37, s42, 3145728
    buffer_load_dwordx4 v232, s[16:19], s37 offen lds
    v_mfma_f32_16x16x32_bf16 v[64:67], v[200:203], v[192:195], v[64:67]
    s_waitcnt lgkmcnt(15)
    v_mfma_f32_16x16x32_bf16 v[4:7], v[204:207], v[184:187], v[4:7]
    v_mfma_f32_16x16x32_bf16 v[36:39], v[204:207], v[188:191], v[36:39]
    s_add_u32 m0, s5, 69632
    s_add_u32 s37, s42, 3276800
    buffer_load_dwordx4 v232, s[16:19], s37 offen lds
    v_mfma_f32_16x16x32_bf16 v[68:71], v[204:207], v[192:195], v[68:71]
    s_cmp_eq_u32 s28, 0
    s_cbranch_scc0 k1_p1l_7_1
    v_mfma_f32_16x16x32_bf16 v[96:99], v[200:203], v[196:199], v[96:99]
    v_mfma_f32_16x16x32_bf16 v[100:103], v[204:207], v[196:199], v[100:103]
k1_p1l_7_1:
    ds_read_b64_tr_b16 v[200:201], v238 offset:32768
    ds_read_b64_tr_b16 v[202:203], v238 offset:33792
    v_xor_b32 v241, 32, v238
    ds_read_b64_tr_b16 v[204:205], v241 offset:32768
    ds_read_b64_tr_b16 v[206:207], v241 offset:33792
    s_waitcnt lgkmcnt(15)
    v_mfma_f32_16x16x32_bf16 v[8:11], v[208:211], v[184:187], v[8:11]
    v_mfma_f32_16x16x32_bf16 v[40:43], v[208:211], v[188:191], v[40:43]
    s_add_u32 m0, s41, 32768
    s_add_u32 s37, s6, 640
    buffer_load_dwordx4 v237, s[20:23], s37 offen lds
    v_mfma_f32_16x16x32_bf16 v[72:75], v[208:211], v[192:195], v[72:75]
    s_waitcnt lgkmcnt(15)
    v_mfma_f32_16x16x32_bf16 v[12:15], v[212:215], v[184:187], v[12:15]
    v_mfma_f32_16x16x32_bf16 v[44:47], v[212:215], v[188:191], v[44:47]
    s_add_u32 m0, s41, 40960
    s_add_u32 s37, s6, 66176
    buffer_load_dwordx4 v237, s[20:23], s37 offen lds
    v_mfma_f32_16x16x32_bf16 v[76:79], v[212:215], v[192:195], v[76:79]
    s_cmp_eq_u32 s28, 1
    s_cbranch_scc0 k1_p1l_7_3
    v_mfma_f32_16x16x32_bf16 v[96:99], v[208:211], v[196:199], v[96:99]
    v_mfma_f32_16x16x32_bf16 v[100:103], v[212:215], v[196:199], v[100:103]
k1_p1l_7_3:
    v_xor_b32 v242, 64, v238
    ds_read_b64_tr_b16 v[208:209], v242 offset:32768
    ds_read_b64_tr_b16 v[210:211], v242 offset:33792
    v_xor_b32 v243, 96, v238
    ds_read_b64_tr_b16 v[212:213], v243 offset:32768
    ds_read_b64_tr_b16 v[214:215], v243 offset:33792
    s_waitcnt lgkmcnt(15)
    v_mfma_f32_16x16x32_bf16 v[16:19], v[216:219], v[184:187], v[16:19]
    v_mfma_f32_16x16x32_bf16 v[48:51], v[216:219], v[188:191], v[48:51]
    s_add_u32 m0, s41, 49152
    s_add_u32 s37, s6, 131712
    buffer_load_dwordx4 v237, s[20:23], s37 offen lds
    v_mfma_f32_16x16x32_bf16 v[80:83], v[216:219], v[192:195], v[80:83]
    s_waitcnt lgkmcnt(15)
    v_mfma_f32_16x16x32_bf16 v[20:23], v[220:223], v[184:187], v[20:23]
    v_mfma_f32_16x16x32_bf16 v[52:55], v[220:223], v[188:191], v[52:55]
    s_add_u32 m0, s41, 57344
    s_add_u32 s37, s6, 197248
    buffer_load_dwordx4 v237, s[20:23], s37 offen lds
    v_mfma_f32_16x16x32_bf16 v[84:87], v[220:223], v[192:195], v[84:87]
    s_cmp_eq_u32 s28, 2
    s_cbranch_scc0 k1_p1l_7_5
    v_mfma_f32_16x16x32_bf16 v[96:99], v[216:219], v[196:199], v[96:99]
    v_mfma_f32_16x16x32_bf16 v[100:103], v[220:223], v[196:199], v[100:103]
k1_p1l_7_5:
    v_xor_b32 v240, 128, v238
    ds_read_b64_tr_b16 v[216:217], v240 offset:32768
    ds_read_b64_tr_b16 v[218:219], v240 offset:33792
    v_xor_b32 v241, 160, v238
    ds_read_b64_tr_b16 v[220:221], v241 offset:32768
    ds_read_b64_tr_b16 v[222:223], v241 offset:33792
    s_waitcnt lgkmcnt(15)
    v_mfma_f32_16x16x32_bf16 v[24:27], v[224:227], v[184:187], v[24:27]
    v_mfma_f32_16x16x32_bf16 v[56:59], v[224:227], v[188:191], v[56:59]
    s_add_u32 s37, s40, 12288
    buffer_load_dwordx4 v[124:127], v251, s[8:11], s37 offen nt
    v_mfma_f32_16x16x32_bf16 v[88:91], v[224:227], v[192:195], v[88:91]
    s_waitcnt lgkmcnt(15)
    v_mfma_f32_16x16x32_bf16 v[28:31], v[228:231], v[184:187], v[28:31]
    v_mfma_f32_16x16x32_bf16 v[60:63], v[228:231], v[188:191], v[60:63]
    v_mfma_f32_16x16x32_bf16 v[92:95], v[228:231], v[192:195], v[92:95]
    s_cmp_eq_u32 s28, 3
    s_cbranch_scc0 k1_p1l_7_7
    v_mfma_f32_16x16x32_bf16 v[96:99], v[224:227], v[196:199], v[96:99]
    v_mfma_f32_16x16x32_bf16 v[100:103], v[228:231], v[196:199], v[100:103]
k1_p1l_7_7:
    v_xor_b32 v242, 192, v238
    ds_read_b64_tr_b16 v[224:225], v242 offset:32768
    ds_read_b64_tr_b16 v[226:227], v242 offset:33792
    v_xor_b32 v243, 224, v238
    ds_read_b64_tr_b16 v[228:229], v243 offset:32768
    ds_read_b64_tr_b16 v[230:231], v243 offset:33792
    s_waitcnt lgkmcnt(15)
    s_waitcnt vmcnt(11)
    s_barrier
    ds_read_b128 v[184:187], v234
    ds_read_b128 v[188:191], v234 offset:2048
    ds_read_b128 v[192:195], v234 offset:4096
    ds_read_b128 v[196:199], v236 offset:24576
    s_waitcnt lgkmcnt(15)
    v_mfma_f32_16x16x32_bf16 v[0:3], v[200:203], v[168:171], v[0:3]
    v_mfma_f32_16x16x32_bf16 v[32:35], v[200:203], v[172:175], v[32:35]
    s_add_u32 m0, s5, 81920
    s_add_u32 s37, s42, 3407872
    buffer_load_dwordx4 v232, s[16:19], s37 offen lds
    v_mfma_f32_16x16x32_bf16 v[64:67], v[200:203], v[176:179], v[64:67]
    s_waitcnt lgkmcnt(15)
    v_mfma_f32_16x16x32_bf16 v[4:7], v[204:207], v[168:171], v[4:7]
    v_mfma_f32_16x16x32_bf16 v[36:39], v[204:207], v[172:175], v[36:39]
    s_add_u32 m0, s5, 86016
    s_add_u32 s37, s42, 3538944
    buffer_load_dwordx4 v232, s[16:19], s37 offen lds
    v_mfma_f32_16x16x32_bf16 v[68:71], v[204:207], v[176:179], v[68:71]
    s_cmp_eq_u32 s28, 0
    s_cbranch_scc0 k1_p1l_8_1
    v_mfma_f32_16x16x32_bf16 v[96:99], v[200:203], v[180:183], v[96:99]
    v_mfma_f32_16x16x32_bf16 v[100:103], v[204:207], v[180:183], v[100:103]
k1_p1l_8_1:
    ds_read_b64_tr_b16 v[200:201], v238 offset:49152
    ds_read_b64_tr_b16 v[202:203], v238 offset:50176
    v_xor_b32 v241, 32, v238
    ds_read_b64_tr_b16 v[204:205], v241 offset:49152
    ds_read_b64_tr_b16 v[206:207], v241 offset:50176
    s_waitcnt lgkmcnt(15)
    v_mfma_f32_16x16x32_bf16 v[8:11], v[208:211], v[168:171], v[8:11]
    v_mfma_f32_16x16x32_bf16 v[40:43], v[208:211], v[172:175], v[40:43]
    s_add_u32 s37, s40, 8192
    buffer_load_dwordx4 v[128:131], v252, s[12:15], s37 offen nt
    v_mfma_f32_16x16x32_bf16 v[72:75], v[208:211], v[176:179], v[72:75]
    s_waitcnt lgkmcnt(15)
    v_mfma_f32_16x16x32_bf16 v[12:15], v[212:215], v[168:171], v[12:15]
    v_mfma_f32_16x16x32_bf16 v[44:47], v[212:215], v[172:175], v[44:47]
    v_mfma_f32_16x16x32_bf16 v[76:79], v[212:215], v[176:179], v[76:79]
    s_cmp_eq_u32 s28, 1
    s_cbranch_scc0 k1_p1l_8_3
    v_mfma_f32_16x16x32_bf16 v[96:99], v[208:211], v[180:183], v[96:99]
    v_mfma_f32_16x16x32_bf16 v[100:103], v[212:215], v[180:183], v[100:103]
k1_p1l_8_3:
    v_xor_b32 v242, 64, v238
    ds_read_b64_tr_b16 v[208:209], v242 offset:49152
    ds_read_b64_tr_b16 v[210:211], v242 offset:50176
    v_xor_b32 v243, 96, v238
    ds_read_b64_tr_b16 v[212:213], v243 offset:49152
    ds_read_b64_tr_b16 v[214:215], v243 offset:50176
    s_waitcnt lgkmcnt(15)
    v_mfma_f32_16x16x32_bf16 v[16:19], v[216:219], v[168:171], v[16:19]
    v_mfma_f32_16x16x32_bf16 v[48:51], v[216:219], v[172:175], v[48:51]
    v_mfma_f32_16x16x32_bf16 v[80:83], v[216:219], v[176:179], v[80:83]
    s_waitcnt lgkmcnt(15)
    v_mfma_f32_16x16x32_bf16 v[20:23], v[220:223], v[168:171], v[20:23]
    v_mfma_f32_16x16x32_bf16 v[52:55], v[220:223], v[172:175], v[52:55]
    v_mfma_f32_16x16x32_bf16 v[84:87], v[220:223], v[176:179], v[84:87]
    s_cmp_eq_u32 s28, 2
    s_cbranch_scc0 k1_p1l_8_5
    v_mfma_f32_16x16x32_bf16 v[96:99], v[216:219], v[180:183], v[96:99]
    v_mfma_f32_16x16x32_bf16 v[100:103], v[220:223], v[180:183], v[100:103]
k1_p1l_8_5:
    v_xor_b32 v240, 128, v238
    ds_read_b64_tr_b16 v[216:217], v240 offset:49152
    ds_read_b64_tr_b16 v[218:219], v240 offset:50176
    v_xor_b32 v241, 160, v238
    ds_read_b64_tr_b16 v[220:221], v241 offset:49152
    ds_read_b64_tr_b16 v[222:223], v241 offset:50176
    s_waitcnt lgkmcnt(15)
    v_mfma_f32_16x16x32_bf16 v[24:27], v[224:227], v[168:171], v[24:27]
    v_mfma_f32_16x16x32_bf16 v[56:59], v[224:227], v[172:175], v[56:59]
    v_mfma_f32_16x16x32_bf16 v[88:91], v[224:227], v[176:179], v[88:91]
    s_waitcnt lgkmcnt(15)
    v_mfma_f32_16x16x32_bf16 v[28:31], v[228:231], v[168:171], v[28:31]
    v_mfma_f32_16x16x32_bf16 v[60:63], v[228:231], v[172:175], v[60:63]
    v_mfma_f32_16x16x32_bf16 v[92:95], v[228:231], v[176:179], v[92:95]
    s_cmp_eq_u32 s28, 3
    s_cbranch_scc0 k1_p1l_8_7
    v_mfma_f32_16x16x32_bf16 v[96:99], v[224:227], v[180:183], v[96:99]
    v_mfma_f32_16x16x32_bf16 v[100:103], v[228:231], v[180:183], v[100:103]
k1_p1l_8_7:
    v_xor_b32 v242, 192, v238
    ds_read_b64_tr_b16 v[224:225], v242 offset:49152
    ds_read_b64_tr_b16 v[226:227], v242 offset:50176
    v_xor_b32 v243, 224, v238
    ds_read_b64_tr_b16 v[228:229], v243 offset:49152
    ds_read_b64_tr_b16 v[230:231], v243 offset:50176
    s_waitcnt lgkmcnt(15)
    s_waitcnt vmcnt(4)
    s_barrier
    ds_read_b128 v[168:171], v233 offset:32768
    ds_read_b128 v[172:175], v233 offset:34816
    ds_read_b128 v[176:179], v233 offset:36864
    ds_read_b128 v[180:183], v235 offset:57344
    s_waitcnt lgkmcnt(15)
    v_mfma_f32_16x16x32_bf16 v[0:3], v[200:203], v[184:187], v[0:3]
    v_mfma_f32_16x16x32_bf16 v[32:35], v[200:203], v[188:191], v[32:35]
    s_add_u32 m0, s5, 98304
    s_add_u32 s37, s42, 3670016
    buffer_load_dwordx4 v232, s[16:19], s37 offen lds
    v_mfma_f32_16x16x32_bf16 v[64:67], v[200:203], v[192:195], v[64:67]
    s_waitcnt lgkmcnt(15)
    v_mfma_f32_16x16x32_bf16 v[4:7], v[204:207], v[184:187], v[4:7]
    v_mfma_f32_16x16x32_bf16 v[36:39], v[204:207], v[188:191], v[36:39]
    s_add_u32 m0, s5, 102400
    s_add_u32 s37, s42, 3801088
    buffer_load_dwordx4 v232, s[16:19], s37 offen lds
    v_mfma_f32_16x16x32_bf16 v[68:71], v[204:207], v[192:195], v[68:71]
    s_cmp_eq_u32 s28, 0
    s_cbranch_scc0 k1_p1l_9_1
    v_mfma_f32_16x16x32_bf16 v[96:99], v[200:203], v[196:199], v[96:99]
    v_mfma_f32_16x16x32_bf16 v[100:103], v[204:207], v[196:199], v[100:103]
k1_p1l_9_1:
    v_add_u32 v240, 65536, v238
    ds_read_b64_tr_b16 v[200:201], v240
    ds_read_b64_tr_b16 v[202:203], v240 offset:1024
    v_xor_b32 v241, 32, v238
    v_add_u32 v241, 65536, v241
    ds_read_b64_tr_b16 v[204:205], v241
    ds_read_b64_tr_b16 v[206:207], v241 offset:1024
    s_waitcnt lgkmcnt(15)
    v_mfma_f32_16x16x32_bf16 v[8:11], v[208:211], v[184:187], v[8:11]
    v_mfma_f32_16x16x32_bf16 v[40:43], v[208:211], v[188:191], v[40:43]
    s_add_u32 m0, s41, 0
    s_add_u32 s37, s6, 768
    buffer_load_dwordx4 v237, s[20:23], s37 offen lds
    v_mfma_f32_16x16x32_bf16 v[72:75], v[208:211], v[192:195], v[72:75]
    s_waitcnt lgkmcnt(15)
    v_mfma_f32_16x16x32_bf16 v[12:15], v[212:215], v[184:187], v[12:15]
    v_mfma_f32_16x16x32_bf16 v[44:47], v[212:215], v[188:191], v[44:47]
    s_add_u32 m0, s41, 8192
    s_add_u32 s37, s6, 66304
    buffer_load_dwordx4 v237, s[20:23], s37 offen lds
    v_mfma_f32_16x16x32_bf16 v[76:79], v[212:215], v[192:195], v[76:79]
    s_cmp_eq_u32 s28, 1
    s_cbranch_scc0 k1_p1l_9_3
    v_mfma_f32_16x16x32_bf16 v[96:99], v[208:211], v[196:199], v[96:99]
    v_mfma_f32_16x16x32_bf16 v[100:103], v[212:215], v[196:199], v[100:103]
k1_p1l_9_3:
    v_xor_b32 v242, 64, v238
    v_add_u32 v242, 65536, v242
    ds_read_b64_tr_b16 v[208:209], v242
    ds_read_b64_tr_b16 v[210:211], v242 offset:1024
    v_xor_b32 v243, 96, v238
    v_add_u32 v243, 65536, v243
    ds_read_b64_tr_b16 v[212:213], v243
    ds_read_b64_tr_b16 v[214:215], v243 offset:1024
    s_waitcnt lgkmcnt(15)
    v_mfma_f32_16x16x32_bf16 v[16:19], v[216:219], v[184:187], v[16:19]
    v_mfma_f32_16x16x32_bf16 v[48:51], v[216:219], v[188:191], v[48:51]
    s_add_u32 m0, s41, 16384
    s_add_u32 s37, s6, 131840
    buffer_load_dwordx4 v237, s[20:23], s37 offen lds
    v_mfma_f32_16x16x32_bf16 v[80:83], v[216:219], v[192:195], v[80:83]
    s_waitcnt lgkmcnt(15)
    v_mfma_f32_16x16x32_bf16 v[20:23], v[220:223], v[184:187], v[20:23]
    v_mfma_f32_16x16x32_bf16 v[52:55], v[220:223], v[188:191], v[52:55]
    s_add_u32 m0, s41, 24576
    s_add_u32 s37, s6, 197376
    buffer_load_dwordx4 v237, s[20:23], s37 offen lds
    v_mfma_f32_16x16x32_bf16 v[84:87], v[220:223], v[192:195], v[84:87]
    s_cmp_eq_u32 s28, 2
    s_cbranch_scc0 k1_p1l_9_5
    v_mfma_f32_16x16x32_bf16 v[96:99], v[216:219], v[196:199], v[96:99]
    v_mfma_f32_16x16x32_bf16 v[100:103], v[220:223], v[196:199], v[100:103]
k1_p1l_9_5:
    v_xor_b32 v240, 128, v238
    v_add_u32 v240, 65536, v240
    ds_read_b64_tr_b16 v[216:217], v240
    ds_read_b64_tr_b16 v[218:219], v240 offset:1024
    v_xor_b32 v241, 160, v238
    v_add_u32 v241, 65536, v241
    ds_read_b64_tr_b16 v[220:221], v241
    ds_read_b64_tr_b16 v[222:223], v241 offset:1024
    s_waitcnt lgkmcnt(15)
    v_mfma_f32_16x16x32_bf16 v[24:27], v[224:227], v[184:187], v[24:27]
    v_mfma_f32_16x16x32_bf16 v[56:59], v[224:227], v[188:191], v[56:59]
    s_add_u32 s37, s40, 12288
    buffer_load_dwordx4 v[132:135], v252, s[12:15], s37 offen nt
    v_mfma_f32_16x16x32_bf16 v[88:91], v[224:227], v[192:195], v[88:91]
    s_waitcnt lgkmcnt(15)
    v_mfma_f32_16x16x32_bf16 v[28:31], v[228:231], v[184:187], v[28:31]
    v_mfma_f32_16x16x32_bf16 v[60:63], v[228:231], v[188:191], v[60:63]
    v_mfma_f32_16x16x32_bf16 v[92:95], v[228:231], v[192:195], v[92:95]
    s_cmp_eq_u32 s28, 3
    s_cbranch_scc0 k1_p1l_9_7
    v_mfma_f32_16x16x32_bf16 v[96:99], v[224:227], v[196:199], v[96:99]
    v_mfma_f32_16x16x32_bf16 v[100:103], v[228:231], v[196:199], v[100:103]
k1_p1l_9_7:
    v_xor_b32 v242, 192, v238
    v_add_u32 v242, 65536, v242
    ds_read_b64_tr_b16 v[224:225], v242
    ds_read_b64_tr_b16 v[226:227], v242 offset:1024
    v_xor_b32 v243, 224, v238
    v_add_u32 v243, 65536, v243
    ds_read_b64_tr_b16 v[228:229], v243
    ds_read_b64_tr_b16 v[230:231], v243 offset:1024
    s_waitcnt lgkmcnt(15)
    s_waitcnt vmcnt(11)
    s_barrier
    ds_read_b128 v[184:187], v234 offset:32768
    ds_read_b128 v[188:191], v234 offset:34816
    ds_read_b128 v[192:195], v234 offset:36864
    ds_read_b128 v[196:199], v236 offset:57344
    s_waitcnt lgkmcnt(15)
    v_mfma_f32_16x16x32_bf16 v[0:3], v[200:203], v[168:171], v[0:3]
    v_mfma_f32_16x16x32_bf16 v[32:35], v[200:203], v[172:175], v[32:35]
    s_add_u32 m0, s5, 114688
    s_add_u32 s37, s42, 3932160
    buffer_load_dwordx4 v232, s[16:19], s37 offen lds
    v_mfma_f32_16x16x32_bf16 v[64:67], v[200:203], v[176:179], v[64:67]
    s_waitcnt lgkmcnt(15)
    v_mfma_f32_16x16x32_bf16 v[4:7], v[204:207], v[168:171], v[4:7]
    v_mfma_f32_16x16x32_bf16 v[36:39], v[204:207], v[172:175], v[36:39]
    s_add_u32 m0, s5, 118784
    s_add_u32 s37, s42, 4063232
    buffer_load_dwordx4 v232, s[16:19], s37 offen lds
    v_mfma_f32_16x16x32_bf16 v[68:71], v[204:207], v[176:179], v[68:71]
    s_cmp_eq_u32 s28, 0
    s_cbranch_scc0 k1_p1l_10_1
    v_mfma_f32_16x16x32_bf16 v[96:99], v[200:203], v[180:183], v[96:99]
    v_mfma_f32_16x16x32_bf16 v[100:103], v[204:207], v[180:183], v[100:103]
k1_p1l_10_1:
    v_add_u32 v240, 65536, v238
    ds_read_b64_tr_b16 v[200:201], v240 offset:16384
    ds_read_b64_tr_b16 v[202:203], v240 offset:17408
    v_xor_b32 v241, 32, v238
    v_add_u32 v241, 65536, v241
    ds_read_b64_tr_b16 v[204:205], v241 offset:16384
    ds_read_b64_tr_b16 v[206:207], v241 offset:17408
    s_waitcnt lgkmcnt(15)
    v_mfma_f32_16x16x32_bf16 v[8:11], v[208:211], v[168:171], v[8:11]
    v_mfma_f32_16x16x32_bf16 v[40:43], v[208:211], v[172:175], v[40:43]
    v_mfma_f32_16x16x32_bf16 v[72:75], v[208:211], v[176:179], v[72:75]
    s_waitcnt lgkmcnt(15)
    v_mfma_f32_16x16x32_bf16 v[12:15], v[212:215], v[168:171], v[12:15]
    v_mfma_f32_16x16x32_bf16 v[44:47], v[212:215], v[172:175], v[44:47]
    v_mfma_f32_16x16x32_bf16 v[76:79], v[212:215], v[176:179], v[76:79]
    s_cmp_eq_u32 s28, 1
    s_cbranch_scc0 k1_p1l_10_3
    v_mfma_f32_16x16x32_bf16 v[96:99], v[208:211], v[180:183], v[96:99]
    v_mfma_f32_16x16x32_bf16 v[100:103], v[212:215], v[180:183], v[100:103]
k1_p1l_10_3:
    v_xor_b32 v242, 64, v238
    v_add_u32 v242, 65536, v242
    ds_read_b64_tr_b16 v[208:209], v242 offset:16384
    ds_read_b64_tr_b16 v[210:211], v242 offset:17408
    v_xor_b32 v243, 96, v238
    v_add_u32 v243, 65536, v243
    ds_read_b64_tr_b16 v[212:213], v243 offset:16384
    ds_read_b64_tr_b16 v[214:215], v243 offset:17408
    s_waitcnt lgkmcnt(15)
    v_mfma_f32_16x16x32_bf16 v[16:19], v[216:219], v[168:171], v[16:19]
    v_mfma_f32_16x16x32_bf16 v[48:51], v[216:219], v[172:175], v[48:51]
    v_mfma_f32_16x16x32_bf16 v[80:83], v[216:219], v[176:179], v[80:83]
    s_waitcnt lgkmcnt(15)
    v_mfma_f32_16x16x32_bf16 v[20:23], v[220:223], v[168:171], v[20:23]
    v_mfma_f32_16x16x32_bf16 v[52:55], v[220:223], v[172:175], v[52:55]
    v_mfma_f32_16x16x32_bf16 v[84:87], v[220:223], v[176:179], v[84:87]
    s_cmp_eq_u32 s28, 2
    s_cbranch_scc0 k1_p1l_10_5
    v_mfma_f32_16x16x32_bf16 v[96:99], v[216:219], v[180:183], v[96:99]
    v_mfma_f32_16x16x32_bf16 v[100:103], v[220:223], v[180:183], v[100:103]
k1_p1l_10_5:
    v_xor_b32 v240, 128, v238
    v_add_u32 v240, 65536, v240
    ds_read_b64_tr_b16 v[216:217], v240 offset:16384
    ds_read_b64_tr_b16 v[218:219], v240 offset:17408
    v_xor_b32 v241, 160, v238
    v_add_u32 v241, 65536, v241
    ds_read_b64_tr_b16 v[220:221], v241 offset:16384
    ds_read_b64_tr_b16 v[222:223], v241 offset:17408
    s_waitcnt lgkmcnt(15)
    v_mfma_f32_16x16x32_bf16 v[24:27], v[224:227], v[168:171], v[24:27]
    v_mfma_f32_16x16x32_bf16 v[56:59], v[224:227], v[172:175], v[56:59]
    v_mfma_f32_16x16x32_bf16 v[88:91], v[224:227], v[176:179], v[88:91]
    s_waitcnt lgkmcnt(15)
    v_mfma_f32_16x16x32_bf16 v[28:31], v[228:231], v[168:171], v[28:31]
    v_mfma_f32_16x16x32_bf16 v[60:63], v[228:231], v[172:175], v[60:63]
    v_mfma_f32_16x16x32_bf16 v[92:95], v[228:231], v[176:179], v[92:95]
    s_cmp_eq_u32 s28, 3
    s_cbranch_scc0 k1_p1l_10_7
    v_mfma_f32_16x16x32_bf16 v[96:99], v[224:227], v[180:183], v[96:99]
    v_mfma_f32_16x16x32_bf16 v[100:103], v[228:231], v[180:183], v[100:103]
k1_p1l_10_7:
    v_xor_b32 v242, 192, v238
    v_add_u32 v242, 65536, v242
    ds_read_b64_tr_b16 v[224:225], v242 offset:16384
    ds_read_b64_tr_b16 v[226:227], v242 offset:17408
    v_xor_b32 v243, 224, v238
    v_add_u32 v243, 65536, v243
    ds_read_b64_tr_b16 v[228:229], v243 offset:16384
    ds_read_b64_tr_b16 v[230:231], v243 offset:17408
    s_waitcnt lgkmcnt(15)
    s_waitcnt vmcnt(3)
    s_barrier
    ds_read_b128 v[168:171], v233
    ds_read_b128 v[172:175], v233 offset:2048
    ds_read_b128 v[176:179], v233 offset:4096
    ds_read_b128 v[180:183], v235 offset:24576
    s_waitcnt lgkmcnt(15)
    v_mfma_f32_16x16x32_bf16 v[0:3], v[200:203], v[184:187], v[0:3]
    v_mfma_f32_16x16x32_bf16 v[32:35], v[200:203], v[188:191], v[32:35]
    s_add_u32 m0, s41, 32768
    s_add_u32 s37, s6, 896
    buffer_load_dwordx4 v237, s[20:23], s37 offen lds
    v_mfma_f32_16x16x32_bf16 v[64:67], v[200:203], v[192:195], v[64:67]
    s_waitcnt lgkmcnt(15)
    v_mfma_f32_16x16x32_bf16 v[4:7], v[204:207], v[184:187], v[4:7]
    v_mfma_f32_16x16x32_bf16 v[36:39], v[204:207], v[188:191], v[36:39]
    s_add_u32 m0, s41, 40960
    s_add_u32 s37, s6, 66432
    buffer_load_dwordx4 v237, s[20:23], s37 offen lds
    v_mfma_f32_16x16x32_bf16 v[68:71], v[204:207], v[192:195], v[68:71]
    s_cmp_eq_u32 s28, 0
    s_cbranch_scc0 k1_p1l_11_1
    v_mfma_f32_16x16x32_bf16 v[96:99], v[200:203], v[196:199], v[96:99]
    v_mfma_f32_16x16x32_bf16 v[100:103], v[204:207], v[196:199], v[100:103]
k1_p1l_11_1:
    ds_read_b64_tr_b16 v[200:201], v238
    ds_read_b64_tr_b16 v[202:203], v238 offset:1024
    v_xor_b32 v241, 32, v238
    ds_read_b64_tr_b16 v[204:205], v241
    ds_read_b64_tr_b16 v[206:207], v241 offset:1024
    s_waitcnt lgkmcnt(15)
    v_mfma_f32_16x16x32_bf16 v[8:11], v[208:211], v[184:187], v[8:11]
    v_mfma_f32_16x16x32_bf16 v[40:43], v[208:211], v[188:191], v[40:43]
    s_add_u32 m0, s41, 49152
    s_add_u32 s37, s6, 131968
    buffer_load_dwordx4 v237, s[20:23], s37 offen lds
    v_mfma_f32_16x16x32_bf16 v[72:75], v[208:211], v[192:195], v[72:75]
    s_waitcnt lgkmcnt(15)
    v_mfma_f32_16x16x32_bf16 v[12:15], v[212:215], v[184:187], v[12:15]
    v_mfma_f32_16x16x32_bf16 v[44:47], v[212:215], v[188:191], v[44:47]
    s_add_u32 m0, s41, 57344
    s_add_u32 s37, s6, 197504
    buffer_load_dwordx4 v237, s[20:23], s37 offen lds
    v_mfma_f32_16x16x32_bf16 v[76:79], v[212:215], v[192:195], v[76:79]
    s_cmp_eq_u32 s28, 1
    s_cbranch_scc0 k1_p1l_11_3
    v_mfma_f32_16x16x32_bf16 v[96:99], v[208:211], v[196:199], v[96:99]
    v_mfma_f32_16x16x32_bf16 v[100:103], v[212:215], v[196:199], v[100:103]
k1_p1l_11_3:
    v_xor_b32 v242, 64, v238
    ds_read_b64_tr_b16 v[208:209], v242
    ds_read_b64_tr_b16 v[210:211], v242 offset:1024
    v_xor_b32 v243, 96, v238
    ds_read_b64_tr_b16 v[212:213], v243
    ds_read_b64_tr_b16 v[214:215], v243 offset:1024
    s_waitcnt lgkmcnt(15)
    v_mfma_f32_16x16x32_bf16 v[16:19], v[216:219], v[184:187], v[16:19]
    v_mfma_f32_16x16x32_bf16 v[48:51], v[216:219], v[188:191], v[48:51]
    v_mfma_f32_16x16x32_bf16 v[80:83], v[216:219], v[192:195], v[80:83]
    s_waitcnt lgkmcnt(15)
    v_mfma_f32_16x16x32_bf16 v[20:23], v[220:223], v[184:187], v[20:23]
    v_mfma_f32_16x16x32_bf16 v[52:55], v[220:223], v[188:191], v[52:55]
    v_mfma_f32_16x16x32_bf16 v[84:87], v[220:223], v[192:195], v[84:87]
    s_cmp_eq_u32 s28, 2
    s_cbranch_scc0 k1_p1l_11_5
    v_mfma_f32_16x16x32_bf16 v[96:99], v[216:219], v[196:199], v[96:99]
    v_mfma_f32_16x16x32_bf16 v[100:103], v[220:223], v[196:199], v[100:103]
k1_p1l_11_5:
    v_xor_b32 v240, 128, v238
    ds_read_b64_tr_b16 v[216:217], v240
    ds_read_b64_tr_b16 v[218:219], v240 offset:1024
    v_xor_b32 v241, 160, v238
    ds_read_b64_tr_b16 v[220:221], v241
    ds_read_b64_tr_b16 v[222:223], v241 offset:1024
    s_waitcnt lgkmcnt(15)
    v_mfma_f32_16x16x32_bf16 v[24:27], v[224:227], v[184:187], v[24:27]
    v_mfma_f32_16x16x32_bf16 v[56:59], v[224:227], v[188:191], v[56:59]
    v_mfma_f32_16x16x32_bf16 v[88:91], v[224:227], v[192:195], v[88:91]
    s_waitcnt lgkmcnt(15)
    v_mfma_f32_16x16x32_bf16 v[28:31], v[228:231], v[184:187], v[28:31]
    v_mfma_f32_16x16x32_bf16 v[60:63], v[228:231], v[188:191], v[60:63]
    v_mfma_f32_16x16x32_bf16 v[92:95], v[228:231], v[192:195], v[92:95]
    s_cmp_eq_u32 s28, 3
    s_cbranch_scc0 k1_p1l_11_7
    v_mfma_f32_16x16x32_bf16 v[96:99], v[224:227], v[196:199], v[96:99]
    v_mfma_f32_16x16x32_bf16 v[100:103], v[228:231], v[196:199], v[100:103]
k1_p1l_11_7:
    v_xor_b32 v242, 192, v238
    ds_read_b64_tr_b16 v[224:225], v242
    ds_read_b64_tr_b16 v[226:227], v242 offset:1024
    v_xor_b32 v243, 224, v238
    ds_read_b64_tr_b16 v[228:229], v243
    ds_read_b64_tr_b16 v[230:231], v243 offset:1024
    s_waitcnt lgkmcnt(15)
    s_waitcnt vmcnt(7)
    s_barrier
    ds_read_b128 v[184:187], v234
    ds_read_b128 v[188:191], v234 offset:2048
    ds_read_b128 v[192:195], v234 offset:4096
    ds_read_b128 v[196:199], v236 offset:24576
    s_waitcnt lgkmcnt(15)
    v_mfma_f32_16x16x32_bf16 v[0:3], v[200:203], v[168:171], v[0:3]
    v_mfma_f32_16x16x32_bf16 v[32:35], v[200:203], v[172:175], v[32:35]
    v_mfma_f32_16x16x32_bf16 v[64:67], v[200:203], v[176:179], v[64:67]
    s_waitcnt lgkmcnt(15)
    v_mfma_f32_16x16x32_bf16 v[4:7], v[204:207], v[168:171], v[4:7]
    v_mfma_f32_16x16x32_bf16 v[36:39], v[204:207], v[172:175], v[36:39]
    v_mfma_f32_16x16x32_bf16 v[68:71], v[204:207], v[176:179], v[68:71]
    s_cmp_eq_u32 s28, 0
    s_cbranch_scc0 k1_p1l_12_1
    v_mfma_f32_16x16x32_bf16 v[96:99], v[200:203], v[180:183], v[96:99]
    v_mfma_f32_16x16x32_bf16 v[100:103], v[204:207], v[180:183], v[100:103]
k1_p1l_12_1:
    ds_read_b64_tr_b16 v[200:201], v238 offset:16384
    ds_read_b64_tr_b16 v[202:203], v238 offset:17408
    v_xor_b32 v241, 32, v238
    ds_read_b64_tr_b16 v[204:205], v241 offset:16384
    ds_read_b64_tr_b16 v[206:207], v241 offset:17408
    s_waitcnt lgkmcnt(15)
    v_mfma_f32_16x16x32_bf16 v[8:11], v[208:211], v[168:171], v[8:11]
    v_mfma_f32_16x16x32_bf16 v[40:43], v[208:211], v[172:175], v[40:43]
    v_mfma_f32_16x16x32_bf16 v[72:75], v[208:211], v[176:179], v[72:75]
    s_waitcnt lgkmcnt(15)
    v_mfma_f32_16x16x32_bf16 v[12:15], v[212:215], v[168:171], v[12:15]
    v_mfma_f32_16x16x32_bf16 v[44:47], v[212:215], v[172:175], v[44:47]
    v_mfma_f32_16x16x32_bf16 v[76:79], v[212:215], v[176:179], v[76:79]
    s_cmp_eq_u32 s28, 1
    s_cbranch_scc0 k1_p1l_12_3
    v_mfma_f32_16x16x32_bf16 v[96:99], v[208:211], v[180:183], v[96:99]
    v_mfma_f32_16x16x32_bf16 v[100:103], v[212:215], v[180:183], v[100:103]
k1_p1l_12_3:
    v_xor_b32 v242, 64, v238
    ds_read_b64_tr_b16 v[208:209], v242 offset:16384
    ds_read_b64_tr_b16 v[210:211], v242 offset:17408
    v_xor_b32 v243, 96, v238
    ds_read_b64_tr_b16 v[212:213], v243 offset:16384
    ds_read_b64_tr_b16 v[214:215], v243 offset:17408
    s_waitcnt lgkmcnt(15)
    v_mfma_f32_16x16x32_bf16 v[16:19], v[216:219], v[168:171], v[16:19]
    v_mfma_f32_16x16x32_bf16 v[48:51], v[216:219], v[172:175], v[48:51]
    v_mfma_f32_16x16x32_bf16 v[80:83], v[216:219], v[176:179], v[80:83]
    s_waitcnt lgkmcnt(15)
    v_mfma_f32_16x16x32_bf16 v[20:23], v[220:223], v[168:171], v[20:23]
    v_mfma_f32_16x16x32_bf16 v[52:55], v[220:223], v[172:175], v[52:55]
    v_mfma_f32_16x16x32_bf16 v[84:87], v[220:223], v[176:179], v[84:87]
    s_cmp_eq_u32 s28, 2
    s_cbranch_scc0 k1_p1l_12_5
    v_mfma_f32_16x16x32_bf16 v[96:99], v[216:219], v[180:183], v[96:99]
    v_mfma_f32_16x16x32_bf16 v[100:103], v[220:223], v[180:183], v[100:103]
k1_p1l_12_5:
    v_xor_b32 v240, 128, v238
    ds_read_b64_tr_b16 v[216:217], v240 offset:16384
    ds_read_b64_tr_b16 v[218:219], v240 offset:17408
    v_xor_b32 v241, 160, v238
    ds_read_b64_tr_b16 v[220:221], v241 offset:16384
    ds_read_b64_tr_b16 v[222:223], v241 offset:17408
    s_waitcnt lgkmcnt(15)
    v_mfma_f32_16x16x32_bf16 v[24:27], v[224:227], v[168:171], v[24:27]
    v_mfma_f32_16x16x32_bf16 v[56:59], v[224:227], v[172:175], v[56:59]
    v_mfma_f32_16x16x32_bf16 v[88:91], v[224:227], v[176:179], v[88:91]
    s_waitcnt lgkmcnt(15)
    v_mfma_f32_16x16x32_bf16 v[28:31], v[228:231], v[168:171], v[28:31]
    v_mfma_f32_16x16x32_bf16 v[60:63], v[228:231], v[172:175], v[60:63]
    v_mfma_f32_16x16x32_bf16 v[92:95], v[228:231], v[176:179], v[92:95]
    s_cmp_eq_u32 s28, 3
    s_cbranch_scc0 k1_p1l_12_7
    v_mfma_f32_16x16x32_bf16 v[96:99], v[224:227], v[180:183], v[96:99]
    v_mfma_f32_16x16x32_bf16 v[100:103], v[228:231], v[180:183], v[100:103]
k1_p1l_12_7:
    v_xor_b32 v242, 192, v238
    ds_read_b64_tr_b16 v[224:225], v242 offset:16384
    ds_read_b64_tr_b16 v[226:227], v242 offset:17408
    v_xor_b32 v243, 224, v238
    ds_read_b64_tr_b16 v[228:229], v243 offset:16384
    ds_read_b64_tr_b16 v[230:231], v243 offset:17408
    s_waitcnt lgkmcnt(15)
    s_waitcnt vmcnt(0)
    s_barrier
    ds_read_b128 v[168:171], v233 offset:32768
    ds_read_b128 v[172:175], v233 offset:34816
    ds_read_b128 v[176:179], v233 offset:36864
    ds_read_b128 v[180:183], v235 offset:57344
    s_waitcnt lgkmcnt(15)
    v_mfma_f32_16x16x32_bf16 v[0:3], v[200:203], v[184:187], v[0:3]
    v_mfma_f32_16x16x32_bf16 v[32:35], v[200:203], v[188:191], v[32:35]
    v_mfma_f32_16x16x32_bf16 v[64:67], v[200:203], v[192:195], v[64:67]
    s_waitcnt lgkmcnt(15)
    v_mfma_f32_16x16x32_bf16 v[4:7], v[204:207], v[184:187], v[4:7]
    v_mfma_f32_16x16x32_bf16 v[36:39], v[204:207], v[188:191], v[36:39]
    v_mfma_f32_16x16x32_bf16 v[68:71], v[204:207], v[192:195], v[68:71]
    s_cmp_eq_u32 s28, 0
    s_cbranch_scc0 k1_p1l_13_1
    v_mfma_f32_16x16x32_bf16 v[96:99], v[200:203], v[196:199], v[96:99]
    v_mfma_f32_16x16x32_bf16 v[100:103], v[204:207], v[196:199], v[100:103]
k1_p1l_13_1:
    ds_read_b64_tr_b16 v[200:201], v238 offset:32768
    ds_read_b64_tr_b16 v[202:203], v238 offset:33792
    v_xor_b32 v241, 32, v238
    ds_read_b64_tr_b16 v[204:205], v241 offset:32768
    ds_read_b64_tr_b16 v[206:207], v241 offset:33792
    s_waitcnt lgkmcnt(15)
    v_mfma_f32_16x16x32_bf16 v[8:11], v[208:211], v[184:187], v[8:11]
    v_mfma_f32_16x16x32_bf16 v[40:43], v[208:211], v[188:191], v[40:43]
    v_mfma_f32_16x16x32_bf16 v[72:75], v[208:211], v[192:195], v[72:75]
    s_waitcnt lgkmcnt(15)
    v_mfma_f32_16x16x32_bf16 v[12:15], v[212:215], v[184:187], v[12:15]
    v_mfma_f32_16x16x32_bf16 v[44:47], v[212:215], v[188:191], v[44:47]
    v_mfma_f32_16x16x32_bf16 v[76:79], v[212:215], v[192:195], v[76:79]
    s_cmp_eq_u32 s28, 1
    s_cbranch_scc0 k1_p1l_13_3
    v_mfma_f32_16x16x32_bf16 v[96:99], v[208:211], v[196:199], v[96:99]
    v_mfma_f32_16x16x32_bf16 v[100:103], v[212:215], v[196:199], v[100:103]
k1_p1l_13_3:
    v_xor_b32 v242, 64, v238
    ds_read_b64_tr_b16 v[208:209], v242 offset:32768
    ds_read_b64_tr_b16 v[210:211], v242 offset:33792
    v_xor_b32 v243, 96, v238
    ds_read_b64_tr_b16 v[212:213], v243 offset:32768
    ds_read_b64_tr_b16 v[214:215], v243 offset:33792
    s_waitcnt lgkmcnt(15)
    v_mfma_f32_16x16x32_bf16 v[16:19], v[216:219], v[184:187], v[16:19]
    v_mfma_f32_16x16x32_bf16 v[48:51], v[216:219], v[188:191], v[48:51]
    v_mfma_f32_16x16x32_bf16 v[80:83], v[216:219], v[192:195], v[80:83]
    s_waitcnt lgkmcnt(15)
    v_mfma_f32_16x16x32_bf16 v[20:23], v[220:223], v[184:187], v[20:23]
    v_mfma_f32_16x16x32_bf16 v[52:55], v[220:223], v[188:191], v[52:55]
    v_mfma_f32_16x16x32_bf16 v[84:87], v[220:223], v[192:195], v[84:87]
    s_cmp_eq_u32 s28, 2
    s_cbranch_scc0 k1_p1l_13_5
    v_mfma_f32_16x16x32_bf16 v[96:99], v[216:219], v[196:199], v[96:99]
    v_mfma_f32_16x16x32_bf16 v[100:103], v[220:223], v[196:199], v[100:103]
k1_p1l_13_5:
    v_xor_b32 v240, 128, v238
    ds_read_b64_tr_b16 v[216:217], v240 offset:32768
    ds_read_b64_tr_b16 v[218:219], v240 offset:33792
    v_xor_b32 v241, 160, v238
    ds_read_b64_tr_b16 v[220:221], v241 offset:32768
    ds_read_b64_tr_b16 v[222:223], v241 offset:33792
    s_waitcnt lgkmcnt(15)
    v_mfma_f32_16x16x32_bf16 v[24:27], v[224:227], v[184:187], v[24:27]
    v_mfma_f32_16x16x32_bf16 v[56:59], v[224:227], v[188:191], v[56:59]
    v_mfma_f32_16x16x32_bf16 v[88:91], v[224:227], v[192:195], v[88:91]
    s_waitcnt lgkmcnt(15)
    v_mfma_f32_16x16x32_bf16 v[28:31], v[228:231], v[184:187], v[28:31]
    v_mfma_f32_16x16x32_bf16 v[60:63], v[228:231], v[188:191], v[60:63]
    v_mfma_f32_16x16x32_bf16 v[92:95], v[228:231], v[192:195], v[92:95]
    s_cmp_eq_u32 s28, 3
    s_cbranch_scc0 k1_p1l_13_7
    v_mfma_f32_16x16x32_bf16 v[96:99], v[224:227], v[196:199], v[96:99]
    v_mfma_f32_16x16x32_bf16 v[100:103], v[228:231], v[196:199], v[100:103]
k1_p1l_13_7:
    v_xor_b32 v242, 192, v238
    ds_read_b64_tr_b16 v[224:225], v242 offset:32768
    ds_read_b64_tr_b16 v[226:227], v242 offset:33792
    v_xor_b32 v243, 224, v238
    ds_read_b64_tr_b16 v[228:229], v243 offset:32768
    ds_read_b64_tr_b16 v[230:231], v243 offset:33792
    s_waitcnt lgkmcnt(15)
    s_waitcnt vmcnt(0)
    s_barrier
    ds_read_b128 v[184:187], v234 offset:32768
    ds_read_b128 v[188:191], v234 offset:34816
    ds_read_b128 v[192:195], v234 offset:36864
    ds_read_b128 v[196:199], v236 offset:57344
    s_waitcnt lgkmcnt(15)
    v_mfma_f32_16x16x32_bf16 v[0:3], v[200:203], v[168:171], v[0:3]
    v_mfma_f32_16x16x32_bf16 v[32:35], v[200:203], v[172:175], v[32:35]
    v_mfma_f32_16x16x32_bf16 v[64:67], v[200:203], v[176:179], v[64:67]
    s_waitcnt lgkmcnt(15)
    v_mfma_f32_16x16x32_bf16 v[4:7], v[204:207], v[168:171], v[4:7]
    v_mfma_f32_16x16x32_bf16 v[36:39], v[204:207], v[172:175], v[36:39]
    v_mfma_f32_16x16x32_bf16 v[68:71], v[204:207], v[176:179], v[68:71]
    s_cmp_eq_u32 s28, 0
    s_cbranch_scc0 k1_p1l_14_1
    v_mfma_f32_16x16x32_bf16 v[96:99], v[200:203], v[180:183], v[96:99]
    v_mfma_f32_16x16x32_bf16 v[100:103], v[204:207], v[180:183], v[100:103]
k1_p1l_14_1:
    ds_read_b64_tr_b16 v[200:201], v238 offset:49152
    ds_read_b64_tr_b16 v[202:203], v238 offset:50176
    v_xor_b32 v241, 32, v238
    ds_read_b64_tr_b16 v[204:205], v241 offset:49152
    ds_read_b64_tr_b16 v[206:207], v241 offset:50176
    s_waitcnt lgkmcnt(15)
    v_mfma_f32_16x16x32_bf16 v[8:11], v[208:211], v[168:171], v[8:11]
    v_mfma_f32_16x16x32_bf16 v[40:43], v[208:211], v[172:175], v[40:43]
    v_mfma_f32_16x16x32_bf16 v[72:75], v[208:211], v[176:179], v[72:75]
    s_waitcnt lgkmcnt(15)
    v_mfma_f32_16x16x32_bf16 v[12:15], v[212:215], v[168:171], v[12:15]
    v_mfma_f32_16x16x32_bf16 v[44:47], v[212:215], v[172:175], v[44:47]
    v_mfma_f32_16x16x32_bf16 v[76:79], v[212:215], v[176:179], v[76:79]
    s_cmp_eq_u32 s28, 1
    s_cbranch_scc0 k1_p1l_14_3
    v_mfma_f32_16x16x32_bf16 v[96:99], v[208:211], v[180:183], v[96:99]
    v_mfma_f32_16x16x32_bf16 v[100:103], v[212:215], v[180:183], v[100:103]
k1_p1l_14_3:
    v_xor_b32 v242, 64, v238
    ds_read_b64_tr_b16 v[208:209], v242 offset:49152
    ds_read_b64_tr_b16 v[210:211], v242 offset:50176
    v_xor_b32 v243, 96, v238
    ds_read_b64_tr_b16 v[212:213], v243 offset:49152
    ds_read_b64_tr_b16 v[214:215], v243 offset:50176
    s_waitcnt lgkmcnt(15)
    v_mfma_f32_16x16x32_bf16 v[16:19], v[216:219], v[168:171], v[16:19]
    v_mfma_f32_16x16x32_bf16 v[48:51], v[216:219], v[172:175], v[48:51]
    v_mfma_f32_16x16x32_bf16 v[80:83], v[216:219], v[176:179], v[80:83]
    s_waitcnt lgkmcnt(15)
    v_mfma_f32_16x16x32_bf16 v[20:23], v[220:223], v[168:171], v[20:23]
    v_mfma_f32_16x16x32_bf16 v[52:55], v[220:223], v[172:175], v[52:55]
    v_mfma_f32_16x16x32_bf16 v[84:87], v[220:223], v[176:179], v[84:87]
    s_cmp_eq_u32 s28, 2
    s_cbranch_scc0 k1_p1l_14_5
    v_mfma_f32_16x16x32_bf16 v[96:99], v[216:219], v[180:183], v[96:99]
    v_mfma_f32_16x16x32_bf16 v[100:103], v[220:223], v[180:183], v[100:103]
k1_p1l_14_5:
    v_xor_b32 v240, 128, v238
    ds_read_b64_tr_b16 v[216:217], v240 offset:49152
    ds_read_b64_tr_b16 v[218:219], v240 offset:50176
    v_xor_b32 v241, 160, v238
    ds_read_b64_tr_b16 v[220:221], v241 offset:49152
    ds_read_b64_tr_b16 v[222:223], v241 offset:50176
    s_waitcnt lgkmcnt(15)
    v_mfma_f32_16x16x32_bf16 v[24:27], v[224:227], v[168:171], v[24:27]
    v_mfma_f32_16x16x32_bf16 v[56:59], v[224:227], v[172:175], v[56:59]
    v_mfma_f32_16x16x32_bf16 v[88:91], v[224:227], v[176:179], v[88:91]
    s_waitcnt lgkmcnt(15)
    v_mfma_f32_16x16x32_bf16 v[28:31], v[228:231], v[168:171], v[28:31]
    v_mfma_f32_16x16x32_bf16 v[60:63], v[228:231], v[172:175], v[60:63]
    v_mfma_f32_16x16x32_bf16 v[92:95], v[228:231], v[176:179], v[92:95]
    s_cmp_eq_u32 s28, 3
    s_cbranch_scc0 k1_p1l_14_7
    v_mfma_f32_16x16x32_bf16 v[96:99], v[224:227], v[180:183], v[96:99]
    v_mfma_f32_16x16x32_bf16 v[100:103], v[228:231], v[180:183], v[100:103]
k1_p1l_14_7:
    v_xor_b32 v242, 192, v238
    ds_read_b64_tr_b16 v[224:225], v242 offset:49152
    ds_read_b64_tr_b16 v[226:227], v242 offset:50176
    v_xor_b32 v243, 224, v238
    ds_read_b64_tr_b16 v[228:229], v243 offset:49152
    ds_read_b64_tr_b16 v[230:231], v243 offset:50176
    s_waitcnt lgkmcnt(15)
    s_waitcnt lgkmcnt(14)
    v_mfma_f32_16x16x32_bf16 v[0:3], v[200:203], v[184:187], v[0:3]
    v_mfma_f32_16x16x32_bf16 v[32:35], v[200:203], v[188:191], v[32:35]
    v_mfma_f32_16x16x32_bf16 v[64:67], v[200:203], v[192:195], v[64:67]
    s_waitcnt lgkmcnt(12)
    v_mfma_f32_16x16x32_bf16 v[4:7], v[204:207], v[184:187], v[4:7]
    v_mfma_f32_16x16x32_bf16 v[36:39], v[204:207], v[188:191], v[36:39]
    v_mfma_f32_16x16x32_bf16 v[68:71], v[204:207], v[192:195], v[68:71]
    s_cmp_eq_u32 s28, 0
    s_cbranch_scc0 k1_p1l_15_1
    v_mfma_f32_16x16x32_bf16 v[96:99], v[200:203], v[196:199], v[96:99]
    v_mfma_f32_16x16x32_bf16 v[100:103], v[204:207], v[196:199], v[100:103]
k1_p1l_15_1:
    s_waitcnt lgkmcnt(10)
    v_mfma_f32_16x16x32_bf16 v[8:11], v[208:211], v[184:187], v[8:11]
    v_mfma_f32_16x16x32_bf16 v[40:43], v[208:211], v[188:191], v[40:43]
    v_mfma_f32_16x16x32_bf16 v[72:75], v[208:211], v[192:195], v[72:75]
    s_waitcnt lgkmcnt(8)
    v_mfma_f32_16x16x32_bf16 v[12:15], v[212:215], v[184:187], v[12:15]
    v_mfma_f32_16x16x32_bf16 v[44:47], v[212:215], v[188:191], v[44:47]
    v_mfma_f32_16x16x32_bf16 v[76:79], v[212:215], v[192:195], v[76:79]
    s_cmp_eq_u32 s28, 1
    s_cbranch_scc0 k1_p1l_15_3
    v_mfma_f32_16x16x32_bf16 v[96:99], v[208:211], v[196:199], v[96:99]
    v_mfma_f32_16x16x32_bf16 v[100:103], v[212:215], v[196:199], v[100:103]
k1_p1l_15_3:
    s_waitcnt lgkmcnt(6)
    v_mfma_f32_16x16x32_bf16 v[16:19], v[216:219], v[184:187], v[16:19]
    v_mfma_f32_16x16x32_bf16 v[48:51], v[216:219], v[188:191], v[48:51]
    v_mfma_f32_16x16x32_bf16 v[80:83], v[216:219], v[192:195], v[80:83]
    s_waitcnt lgkmcnt(4)
    v_mfma_f32_16x16x32_bf16 v[20:23], v[220:223], v[184:187], v[20:23]
    v_mfma_f32_16x16x32_bf16 v[52:55], v[220:223], v[188:191], v[52:55]
    v_mfma_f32_16x16x32_bf16 v[84:87], v[220:223], v[192:195], v[84:87]
    s_cmp_eq_u32 s28, 2
    s_cbranch_scc0 k1_p1l_15_5
    v_mfma_f32_16x16x32_bf16 v[96:99], v[216:219], v[196:199], v[96:99]
    v_mfma_f32_16x16x32_bf16 v[100:103], v[220:223], v[196:199], v[100:103]
k1_p1l_15_5:
    s_waitcnt lgkmcnt(2)
    v_mfma_f32_16x16x32_bf16 v[24:27], v[224:227], v[184:187], v[24:27]
    v_mfma_f32_16x16x32_bf16 v[56:59], v[224:227], v[188:191], v[56:59]
    v_mfma_f32_16x16x32_bf16 v[88:91], v[224:227], v[192:195], v[88:91]
    s_waitcnt lgkmcnt(0)
    v_mfma_f32_16x16x32_bf16 v[28:31], v[228:231], v[184:187], v[28:31]
    v_mfma_f32_16x16x32_bf16 v[60:63], v[228:231], v[188:191], v[60:63]
    v_mfma_f32_16x16x32_bf16 v[92:95], v[228:231], v[192:195], v[92:95]
    s_cmp_eq_u32 s28, 3
    s_cbranch_scc0 k1_p1l_15_7
    v_mfma_f32_16x16x32_bf16 v[96:99], v[224:227], v[196:199], v[96:99]
    v_mfma_f32_16x16x32_bf16 v[100:103], v[228:231], v[196:199], v[100:103]
k1_p1l_15_7:
    s_barrier
    s_add_u32 s33, s40, 16384
    s_add_u32 m0, s43, 33792
    s_nop 0
    buffer_load_dwordx4 v251, s[8:11], s33 offen nt lds
    s_add_u32 m0, s43, 38144
    s_add_u32 s37, s33, 4096
    buffer_load_dwordx4 v251, s[8:11], s37 offen nt lds
    s_add_u32 m0, s44, 33792
    s_nop 0
    buffer_load_dwordx4 v252, s[12:15], s33 offen nt lds
    s_add_u32 m0, s44, 37888
    s_add_u32 s37, s33, 4096
    buffer_load_dwordx4 v252, s[12:15], s37 offen nt lds
    s_add_u32 s33, s33, 8192
    s_add_u32 m0, s43, 50688
    s_nop 0
    buffer_load_dwordx4 v251, s[8:11], s33 offen nt lds
    s_add_u32 m0, s43, 55040
    s_add_u32 s37, s33, 4096
    buffer_load_dwordx4 v251, s[8:11], s37 offen nt lds
    s_add_u32 m0, s44, 50688
    s_nop 0
    buffer_load_dwordx4 v252, s[12:15], s33 offen nt lds
    s_add_u32 m0, s44, 54784
    s_add_u32 s37, s33, 4096
    buffer_load_dwordx4 v252, s[12:15], s37 offen nt lds
    s_add_u32 s33, s33, 8192
    s_waitcnt vmcnt(8)
    v_add_u32 v240, s43, v239
    v_add_u32 v241, s44, v239
    ds_write_b128 v240, v[104:107]
    ds_write_b128 v240, v[108:111] offset:4352
    ds_write_b128 v241, v[112:115]
    ds_write_b128 v241, v[116:119] offset:4096
    ds_write_b128 v240, v[120:123] offset:16896
    ds_write_b128 v240, v[124:127] offset:21248
    ds_write_b128 v241, v[128:131] offset:16896
    ds_write_b128 v241, v[132:135] offset:20992
    s_and_b32 s37, s3, 127
    s_lshl_b32 s37, s37, 15
    s_lshl_b32 s38, s29, 12
    s_add_u32 s7, s37, s38
    v_mov_b32 v244, s46
    v_mov_b32 v245, s46
    v_pk_mul_f32 v[0:1], v[0:1], v[244:245]
    v_pk_mul_f32 v[2:3], v[2:3], v[244:245]
    v_pk_mul_f32 v[4:5], v[4:5], v[244:245]
    v_pk_mul_f32 v[6:7], v[6:7], v[244:245]
    v_pk_mul_f32 v[8:9], v[8:9], v[244:245]
    v_pk_mul_f32 v[10:11], v[10:11], v[244:245]
    v_pk_mul_f32 v[12:13], v[12:13], v[244:245]
    v_pk_mul_f32 v[14:15], v[14:15], v[244:245]
    v_pk_mul_f32 v[16:17], v[16:17], v[244:245]
    v_pk_mul_f32 v[18:19], v[18:19], v[244:245]
    v_pk_mul_f32 v[20:21], v[20:21], v[244:245]
    v_pk_mul_f32 v[22:23], v[22:23], v[244:245]
    v_pk_mul_f32 v[24:25], v[24:25], v[244:245]
    v_pk_mul_f32 v[26:27], v[26:27], v[244:245]
    v_pk_mul_f32 v[28:29], v[28:29], v[244:245]
    v_pk_mul_f32 v[30:31], v[30:31], v[244:245]
    v_pk_mul_f32 v[32:33], v[32:33], v[244:245]
    v_pk_mul_f32 v[34:35], v[34:35], v[244:245]
    v_pk_mul_f32 v[36:37], v[36:37], v[244:245]
    v_pk_mul_f32 v[38:39], v[38:39], v[244:245]
    v_pk_mul_f32 v[40:41], v[40:41], v[244:245]
    v_pk_mul_f32 v[42:43], v[42:43], v[244:245]
    v_pk_mul_f32 v[44:45], v[44:45], v[244:245]
    v_pk_mul_f32 v[46:47], v[46:47], v[244:245]
    v_pk_mul_f32 v[48:49], v[48:49], v[244:245]
    v_pk_mul_f32 v[50:51], v[50:51], v[244:245]
    v_pk_mul_f32 v[52:53], v[52:53], v[244:245]
    v_pk_mul_f32 v[54:55], v[54:55], v[244:245]
    v_pk_mul_f32 v[56:57], v[56:57], v[244:245]
    v_pk_mul_f32 v[58:59], v[58:59], v[244:245]
    v_pk_mul_f32 v[60:61], v[60:61], v[244:245]
    v_pk_mul_f32 v[62:63], v[62:63], v[244:245]
    v_pk_mul_f32 v[64:65], v[64:65], v[244:245]
    v_pk_mul_f32 v[66:67], v[66:67], v[244:245]
    v_pk_mul_f32 v[68:69], v[68:69], v[244:245]
    v_pk_mul_f32 v[70:71], v[70:71], v[244:245]
    v_pk_mul_f32 v[72:73], v[72:73], v[244:245]
    v_pk_mul_f32 v[74:75], v[74:75], v[244:245]
    v_pk_mul_f32 v[76:77], v[76:77], v[244:245]
    v_pk_mul_f32 v[78:79], v[78:79], v[244:245]
    v_pk_mul_f32 v[80:81], v[80:81], v[244:245]
    v_pk_mul_f32 v[82:83], v[82:83], v[244:245]
    v_pk_mul_f32 v[84:85], v[84:85], v[244:245]
    v_pk_mul_f32 v[86:87], v[86:87], v[244:245]
    v_pk_mul_f32 v[88:89], v[88:89], v[244:245]
    v_pk_mul_f32 v[90:91], v[90:91], v[244:245]
    v_pk_mul_f32 v[92:93], v[92:93], v[244:245]
    v_pk_mul_f32 v[94:95], v[94:95], v[244:245]
    v_pk_mul_f32 v[96:97], v[96:97], v[244:245]
    v_pk_mul_f32 v[98:99], v[98:99], v[244:245]
    v_pk_mul_f32 v[100:101], v[100:101], v[244:245]
    v_pk_mul_f32 v[102:103], v[102:103], v[244:245]
    v_cvt_pk_bf16_f32 v176, v96, v97
    v_cvt_pk_bf16_f32 v177, v98, v99
    v_cvt_pk_bf16_f32 v178, v100, v101
    v_cvt_pk_bf16_f32 v179, v102, v103
    s_lshl_b32 s37, s30, 12
    s_add_u32 s37, s37, 135168
    v_add_u32 v242, s37, v239
    v_add_u32 v243, s40, v242
    v_permlane32_swap_b32 v176, v178
    v_permlane32_swap_b32 v177, v179
    s_nop 1
    v_permlane16_swap_b32 v176, v178
    v_permlane16_swap_b32 v177, v179
    ds_write_b128 v243, v[176:179]
    s_waitcnt lgkmcnt(0)
    v_cvt_pk_bf16_f32 v128, v0, v1
    v_cvt_pk_bf16_f32 v129, v2, v3
    v_cvt_pk_bf16_f32 v130, v4, v5
    v_cvt_pk_bf16_f32 v131, v6, v7
    v_cvt_pk_bf16_f32 v132, v8, v9
    v_cvt_pk_bf16_f32 v133, v10, v11
    v_cvt_pk_bf16_f32 v134, v12, v13
    v_cvt_pk_bf16_f32 v135, v14, v15
    v_cvt_pk_bf16_f32 v136, v16, v17
    v_cvt_pk_bf16_f32 v137, v18, v19
    v_cvt_pk_bf16_f32 v138, v20, v21
    v_cvt_pk_bf16_f32 v139, v22, v23
    v_cvt_pk_bf16_f32 v140, v24, v25
    v_cvt_pk_bf16_f32 v141, v26, v27
    v_cvt_pk_bf16_f32 v142, v28, v29
    v_cvt_pk_bf16_f32 v143, v30, v31
    v_cvt_pk_bf16_f32 v144, v32, v33
    v_cvt_pk_bf16_f32 v145, v34, v35
    v_cvt_pk_bf16_f32 v146, v36, v37
    v_cvt_pk_bf16_f32 v147, v38, v39
    v_cvt_pk_bf16_f32 v148, v40, v41
    v_cvt_pk_bf16_f32 v149, v42, v43
    v_cvt_pk_bf16_f32 v150, v44, v45
    v_cvt_pk_bf16_f32 v151, v46, v47
    v_cvt_pk_bf16_f32 v152, v48, v49
    v_cvt_pk_bf16_f32 v153, v50, v51
    v_cvt_pk_bf16_f32 v154, v52, v53
    v_cvt_pk_bf16_f32 v155, v54, v55
    v_cvt_pk_bf16_f32 v156, v56, v57
    v_cvt_pk_bf16_f32 v157, v58, v59
    v_cvt_pk_bf16_f32 v158, v60, v61
    v_cvt_pk_bf16_f32 v159, v62, v63
    v_cvt_pk_bf16_f32 v160, v64, v65
    v_cvt_pk_bf16_f32 v161, v66, v67
    v_cvt_pk_bf16_f32 v162, v68, v69
    v_cvt_pk_bf16_f32 v163, v70, v71
    v_cvt_pk_bf16_f32 v164, v72, v73
    v_cvt_pk_bf16_f32 v165, v74, v75
    v_cvt_pk_bf16_f32 v166, v76, v77
    v_cvt_pk_bf16_f32 v167, v78, v79
    v_cvt_pk_bf16_f32 v168, v80, v81
    v_cvt_pk_bf16_f32 v169, v82, v83
    v_cvt_pk_bf16_f32 v170, v84, v85
    v_cvt_pk_bf16_f32 v171, v86, v87
    v_cvt_pk_bf16_f32 v172, v88, v89
    v_cvt_pk_bf16_f32 v173, v90, v91
    v_cvt_pk_bf16_f32 v174, v92, v93
    v_cvt_pk_bf16_f32 v175, v94, v95
    v_permlane32_swap_b32 v128, v130
    v_permlane32_swap_b32 v129, v131
    v_permlane32_swap_b32 v132, v134
    v_permlane32_swap_b32 v133, v135
    v_permlane32_swap_b32 v136, v138
    v_permlane32_swap_b32 v137, v139
    v_permlane32_swap_b32 v140, v142
    v_permlane32_swap_b32 v141, v143
    v_permlane32_swap_b32 v144, v146
    v_permlane32_swap_b32 v145, v147
    v_permlane32_swap_b32 v148, v150
    v_permlane32_swap_b32 v149, v151
    v_permlane32_swap_b32 v152, v154
    v_permlane32_swap_b32 v153, v155
    v_permlane32_swap_b32 v156, v158
    v_permlane32_swap_b32 v157, v159
    v_permlane32_swap_b32 v160, v162
    v_permlane32_swap_b32 v161, v163
    v_permlane32_swap_b32 v164, v166
    v_permlane32_swap_b32 v165, v167
    v_permlane32_swap_b32 v168, v170
    v_permlane32_swap_b32 v169, v171
    v_permlane32_swap_b32 v172, v174
    v_permlane32_swap_b32 v173, v175
    v_permlane16_swap_b32 v128, v130
    v_permlane16_swap_b32 v129, v131
    v_permlane16_swap_b32 v132, v134
    v_permlane16_swap_b32 v133, v135
    v_permlane16_swap_b32 v136, v138
    v_permlane16_swap_b32 v137, v139
    v_permlane16_swap_b32 v140, v142
    v_permlane16_swap_b32 v141, v143
    v_permlane16_swap_b32 v144, v146
    v_permlane16_swap_b32 v145, v147
    v_permlane16_swap_b32 v148, v150
    v_permlane16_swap_b32 v149, v151
    v_permlane16_swap_b32 v152, v154
    v_permlane16_swap_b32 v153, v155
    v_permlane16_swap_b32 v156, v158
    v_permlane16_swap_b32 v157, v159
    v_permlane16_swap_b32 v160, v162
    v_permlane16_swap_b32 v161, v163
    v_permlane16_swap_b32 v164, v166
    v_permlane16_swap_b32 v165, v167
    v_permlane16_swap_b32 v168, v170
    v_permlane16_swap_b32 v169, v171
    v_permlane16_swap_b32 v172, v174
    v_permlane16_swap_b32 v173, v175
    s_mov_b32 s55, s37
    s_lshl_b32 s52, s30, 1
    s_add_u32 s52, s52, s28
    s_and_b32 s52, s52, 3
    s_mov_b32 s53, 0xff800000
    s_mov_b32 s54, 0xff800000
    v_mov_b32 v96, 0
    v_mov_b32 v97, 0
    v_mov_b32 v98, 0
    v_mov_b32 v99, 0
    v_mov_b32 v100, 0
    v_mov_b32 v101, 0
    v_mov_b32 v102, 0
    v_mov_b32 v103, 0
    v_mov_b32 v104, 0
    v_mov_b32 v105, 0
    v_mov_b32 v106, 0
    v_mov_b32 v107, 0
    v_mov_b32 v108, 0
    v_mov_b32 v109, 0
    v_mov_b32 v110, 0
    v_mov_b32 v111, 0
    v_mov_b32 v112, 0
    v_mov_b32 v113, 0
    v_mov_b32 v114, 0
    v_mov_b32 v115, 0
    v_mov_b32 v116, 0
    v_mov_b32 v117, 0
    v_mov_b32 v118, 0
    v_mov_b32 v119, 0
    v_mov_b32 v120, 0
    v_mov_b32 v121, 0
    v_mov_b32 v122, 0
    v_mov_b32 v123, 0
    v_mov_b32 v124, 0
    v_mov_b32 v125, 0
    v_mov_b32 v126, 0
    v_mov_b32 v127, 0
    v_mov_b32 v244, 0
    v_mov_b32 v248, 0
    s_barrier
    ds_read_b128 v[200:203], v249
    ds_read_b128 v[204:207], v249 offset:64
    ds_read_b128 v[208:211], v249 offset:128
    ds_read_b128 v[212:215], v249 offset:192
    ds_read_b128 v[216:219], v249 offset:4352
    ds_read_b128 v[220:223], v249 offset:4416
    ds_read_b128 v[224:227], v249 offset:4480
    ds_read_b128 v[228:231], v249 offset:4544
    s_cmp_eq_u32 s52, 0
    s_cbranch_scc1 k1_sth_p0
    s_waitcnt lgkmcnt(7)
    v_mfma_f32_16x16x32_bf16 v[176:179], v[200:203], v[128:131], 0
    v_mbcnt_lo_u32_b32 v255, -1, 0
    v_mbcnt_hi_u32_b32 v255, -1, v255
    v_lshlrev_b32 v255, 4, v255
    s_add_u32 m0, s41, 143360
    s_nop 0
    buffer_load_dwordx4 v255, s[48:51], s7 offen lds
    s_add_u32 s7, s7, 1024
    v_mbcnt_lo_u32_b32 v255, -1, 0
    v_mbcnt_hi_u32_b32 v255, -1, v255
    v_lshlrev_b32 v255, 4, v255
    s_add_u32 m0, s41, 143360
    s_nop 0
    buffer_load_dwordx4 v255, s[48:51], s7 offen lds
    s_add_u32 s7, s7, 1024
    v_mbcnt_lo_u32_b32 v255, -1, 0
    v_mbcnt_hi_u32_b32 v255, -1, v255
    v_lshlrev_b32 v255, 4, v255
    s_add_u32 m0, s41, 143360
    s_nop 0
    buffer_load_dwordx4 v255, s[48:51], s7 offen lds
    s_add_u32 s7, s7, 1024
    v_mbcnt_lo_u32_b32 v255, -1, 0
    v_mbcnt_hi_u32_b32 v255, -1, v255
    v_lshlrev_b32 v255, 4, v255
    s_add_u32 m0, s41, 143360
    s_nop 0
    buffer_load_dwordx4 v255, s[48:51], s7 offen lds
    s_add_u32 s7, s7, 1024
    s_waitcnt lgkmcnt(6)
    v_mfma_f32_16x16x32_bf16 v[176:179], v[204:207], v[132:135], v[176:179]
    s_waitcnt lgkmcnt(5)
    v_mfma_f32_16x16x32_bf16 v[176:179], v[208:211], v[136:139], v[176:179]
    s_waitcnt lgkmcnt(4)
    v_mfma_f32_16x16x32_bf16 v[176:179], v[212:215], v[140:143], v[176:179]
    s_waitcnt lgkmcnt(3)
    v_mfma_f32_16x16x32_bf16 v[180:183], v[216:219], v[128:131], 0
    s_waitcnt lgkmcnt(2)
    v_mfma_f32_16x16x32_bf16 v[180:183], v[220:223], v[132:135], v[180:183]
    s_waitcnt lgkmcnt(1)
    v_mfma_f32_16x16x32_bf16 v[180:183], v[224:227], v[136:139], v[180:183]
    s_waitcnt lgkmcnt(0)
    v_mfma_f32_16x16x32_bf16 v[180:183], v[228:231], v[140:143], v[180:183]
    v_mfma_f32_16x16x32_bf16 v[184:187], v[200:203], v[144:147], 0
    v_mfma_f32_16x16x32_bf16 v[184:187], v[204:207], v[148:151], v[184:187]
    v_mfma_f32_16x16x32_bf16 v[184:187], v[208:211], v[152:155], v[184:187]
    v_max3_f32 v253, v176, v177, v178
    s_nop 3
    v_max3_f32 v253, v253, v179, v180
    v_mfma_f32_16x16x32_bf16 v[184:187], v[212:215], v[156:159], v[184:187]
    v_max3_f32 v253, v253, v181, v182
    v_max_f32 v253, v253, v183
    v_mfma_f32_16x16x32_bf16 v[188:191], v[216:219], v[144:147], 0
    v_mov_b32 v245, v253
    s_nop 1
    v_permlane32_swap_b32 v253, v245
    v_max_f32 v253, v253, v245
    v_mov_b32 v245, v253
    s_nop 1
    v_permlane16_swap_b32 v253, v245
    v_max_f32 v253, v253, v245
    v_sub_f32 v176, v176, v253
    v_sub_f32 v177, v177, v253
    v_sub_f32 v178, v178, v253
    v_sub_f32 v179, v179, v253
    v_sub_f32 v180, v180, v253
    v_sub_f32 v181, v181, v253
    v_sub_f32 v182, v182, v253
    v_sub_f32 v183, v183, v253
    v_sub_f32 v232, 0, v253
    v_sub_f32 v233, 0, v253
    v_sub_f32 v234, 0, v253
    v_sub_f32 v235, 0, v253
    v_exp_f32 v176, v176
    v_mfma_f32_16x16x32_bf16 v[188:191], v[220:223], v[148:151], v[188:191]
    v_exp_f32 v177, v177
    v_exp_f32 v178, v178
    v_mfma_f32_16x16x32_bf16 v[188:191], v[224:227], v[152:155], v[188:191]
    v_exp_f32 v179, v179
    v_exp_f32 v180, v180
    v_mfma_f32_16x16x32_bf16 v[188:191], v[228:231], v[156:159], v[188:191]
    v_exp_f32 v181, v181
    v_exp_f32 v182, v182
    v_mfma_f32_16x16x32_bf16 v[192:195], v[200:203], v[160:163], 0
    ds_read_b64_tr_b16 v[200:201], v250
    ds_read_b64_tr_b16 v[202:203], v250 offset:4096
    v_exp_f32 v183, v183
    v_add_f32 v245, v176, v177
    v_mfma_f32_16x16x32_bf16 v[192:195], v[204:207], v[164:167], v[192:195]
    v_xor_b32 v254, 32, v250
    ds_read_b64_tr_b16 v[204:205], v254
    ds_read_b64_tr_b16 v[206:207], v254 offset:4096
    v_add_f32 v245, v245, v178
    v_add_f32 v245, v245, v179
    v_mfma_f32_16x16x32_bf16 v[192:195], v[208:211], v[168:171], v[192:195]
    v_xor_b32 v255, 64, v250
    ds_read_b64_tr_b16 v[208:209], v255
    ds_read_b64_tr_b16 v[210:211], v255 offset:4096
    v_add_f32 v245, v245, v180
    v_add_f32 v245, v245, v181
    v_mfma_f32_16x16x32_bf16 v[192:195], v[212:215], v[172:175], v[192:195]
    v_xor_b32 v254, 96, v250
    ds_read_b64_tr_b16 v[212:213], v254
    ds_read_b64_tr_b16 v[214:215], v254 offset:4096
    v_add_f32 v245, v245, v182
    v_add_f32 v245, v245, v183
    v_max3_f32 v253, v184, v185, v186
    v_max3_f32 v253, v253, v187, v188
    v_mfma_f32_16x16x32_bf16 v[196:199], v[216:219], v[160:163], 0
    v_xor_b32 v255, 128, v250
    ds_read_b64_tr_b16 v[216:217], v255
    ds_read_b64_tr_b16 v[218:219], v255 offset:4096
    v_cvt_pk_bf16_f32 v176, v176, v177
    v_cvt_pk_bf16_f32 v177, v178, v179
    v_max3_f32 v253, v253, v189, v190
    v_max_f32 v253, v253, v191
    v_mfma_f32_16x16x32_bf16 v[196:199], v[220:223], v[164:167], v[196:199]
    v_xor_b32 v254, 160, v250
    ds_read_b64_tr_b16 v[220:221], v254
    ds_read_b64_tr_b16 v[222:223], v254 offset:4096
    v_cvt_pk_bf16_f32 v178, v180, v181
    v_cvt_pk_bf16_f32 v179, v182, v183
    v_mov_b32 v246, v253
    s_nop 1
    v_permlane32_swap_b32 v253, v246
    v_max_f32 v253, v253, v246
    v_mov_b32 v246, v253
    s_nop 1
    v_permlane16_swap_b32 v253, v246
    v_max_f32 v253, v253, v246
    v_sub_f32 v184, v184, v253
    v_sub_f32 v185, v185, v253
    v_sub_f32 v186, v186, v253
    v_sub_f32 v187, v187, v253
    v_sub_f32 v188, v188, v253
    v_sub_f32 v189, v189, v253
    v_sub_f32 v190, v190, v253
    v_sub_f32 v191, v191, v253
    v_sub_f32 v236, 0, v253
    v_sub_f32 v237, 0, v253
    v_sub_f32 v238, 0, v253
    v_sub_f32 v239, 0, v253
    v_exp_f32 v184, v184
    v_mfma_f32_16x16x32_bf16 v[196:199], v[224:227], v[168:171], v[196:199]
    v_xor_b32 v255, 192, v250
    ds_read_b64_tr_b16 v[224:225], v255
    ds_read_b64_tr_b16 v[226:227], v255 offset:4096
    v_exp_f32 v185, v185
    v_exp_f32 v186, v186
    v_mfma_f32_16x16x32_bf16 v[196:199], v[228:231], v[172:175], v[196:199]
    v_xor_b32 v254, 224, v250
    ds_read_b64_tr_b16 v[228:229], v254
    ds_read_b64_tr_b16 v[230:231], v254 offset:4096
    v_exp_f32 v187, v187
    v_exp_f32 v188, v188
    s_waitcnt lgkmcnt(14)
    v_mfma_f32_16x16x32_bf16 v[0:3], v[200:203], v[176:179], 0
    v_exp_f32 v189, v189
    v_exp_f32 v190, v190
    s_waitcnt lgkmcnt(12)
    v_mfma_f32_16x16x32_bf16 v[4:7], v[204:207], v[176:179], 0
    v_exp_f32 v191, v191
    v_add_f32 v246, v184, v185
    s_waitcnt lgkmcnt(10)
    v_mfma_f32_16x16x32_bf16 v[8:11], v[208:211], v[176:179], 0
    v_add_f32 v246, v246, v186
    v_add_f32 v246, v246, v187
    s_waitcnt lgkmcnt(8)
    v_mfma_f32_16x16x32_bf16 v[12:15], v[212:215], v[176:179], 0
    v_add_f32 v246, v246, v188
    v_add_f32 v246, v246, v189
    v_max3_f32 v253, v192, v193, v194
    v_max3_f32 v253, v253, v195, v196
    s_waitcnt lgkmcnt(6)
    v_mfma_f32_16x16x32_bf16 v[16:19], v[216:219], v[176:179], 0
    v_add_f32 v246, v246, v190
    v_add_f32 v246, v246, v191
    v_max3_f32 v253, v253, v197, v198
    v_max_f32 v253, v253, v199
    s_waitcnt lgkmcnt(4)
    v_mfma_f32_16x16x32_bf16 v[20:23], v[220:223], v[176:179], 0
    v_cvt_pk_bf16_f32 v184, v184, v185
    v_cvt_pk_bf16_f32 v185, v186, v187
    v_mov_b32 v247, v253
    s_nop 1
    v_permlane32_swap_b32 v253, v247
    v_max_f32 v253, v253, v247
    v_mov_b32 v247, v253
    s_nop 1
    v_permlane16_swap_b32 v253, v247
    v_max_f32 v253, v253, v247
    v_sub_f32 v192, v192, v253
    v_sub_f32 v193, v193, v253
    v_sub_f32 v194, v194, v253
    v_sub_f32 v195, v195, v253
    v_sub_f32 v196, v196, v253
    v_sub_f32 v197, v197, v253
    v_sub_f32 v198, v198, v253
    v_sub_f32 v199, v199, v253
    v_sub_f32 v240, 0, v253
    v_sub_f32 v241, 0, v253
    v_sub_f32 v242, 0, v253
    v_sub_f32 v243, 0, v253
    v_exp_f32 v192, v192
    s_waitcnt lgkmcnt(2)
    v_mfma_f32_16x16x32_bf16 v[24:27], v[224:227], v[176:179], 0
    v_cvt_pk_bf16_f32 v186, v188, v189
    v_cvt_pk_bf16_f32 v187, v190, v191
    v_exp_f32 v193, v193
    v_exp_f32 v194, v194
    s_waitcnt lgkmcnt(0)
    v_mfma_f32_16x16x32_bf16 v[28:31], v[228:231], v[176:179], 0
    v_exp_f32 v195, v195
    v_exp_f32 v196, v196
    v_mfma_f32_16x16x32_bf16 v[32:35], v[200:203], v[184:187], 0
    v_exp_f32 v197, v197
    v_exp_f32 v198, v198
    v_mfma_f32_16x16x32_bf16 v[36:39], v[204:207], v[184:187], 0
    v_exp_f32 v199, v199
    v_add_f32 v247, v192, v193
    v_mfma_f32_16x16x32_bf16 v[40:43], v[208:211], v[184:187], 0
    v_add_f32 v247, v247, v194
    v_add_f32 v247, v247, v195
    v_mfma_f32_16x16x32_bf16 v[44:47], v[212:215], v[184:187], 0
    v_add_f32 v247, v247, v196
    v_add_f32 v247, v247, v197
    v_mfma_f32_16x16x32_bf16 v[48:51], v[216:219], v[184:187], 0
    v_add_f32 v247, v247, v198
    v_add_f32 v247, v247, v199
    v_mfma_f32_16x16x32_bf16 v[52:55], v[220:223], v[184:187], 0
    v_cvt_pk_bf16_f32 v192, v192, v193
    v_cvt_pk_bf16_f32 v193, v194, v195
    v_mfma_f32_16x16x32_bf16 v[56:59], v[224:227], v[184:187], 0
    v_cvt_pk_bf16_f32 v194, v196, v197
    v_cvt_pk_bf16_f32 v195, v198, v199
    v_mfma_f32_16x16x32_bf16 v[60:63], v[228:231], v[184:187], 0
    s_nop 0
    v_mfma_f32_16x16x32_bf16 v[64:67], v[200:203], v[192:195], 0
    ds_read_b128 v[200:203], v249 offset:16896
    v_mfma_f32_16x16x32_bf16 v[68:71], v[204:207], v[192:195], 0
    ds_read_b128 v[204:207], v249 offset:16960
    v_mfma_f32_16x16x32_bf16 v[72:75], v[208:211], v[192:195], 0
    ds_read_b128 v[208:211], v249 offset:17024
    v_mfma_f32_16x16x32_bf16 v[76:79], v[212:215], v[192:195], 0
    ds_read_b128 v[212:215], v249 offset:17088
    v_mfma_f32_16x16x32_bf16 v[80:83], v[216:219], v[192:195], 0
    ds_read_b128 v[216:219], v249 offset:21248
    v_mfma_f32_16x16x32_bf16 v[84:87], v[220:223], v[192:195], 0
    ds_read_b128 v[220:223], v249 offset:21312
    v_mfma_f32_16x16x32_bf16 v[88:91], v[224:227], v[192:195], 0
    ds_read_b128 v[224:227], v249 offset:21376
    v_mfma_f32_16x16x32_bf16 v[92:95], v[228:231], v[192:195], 0
    ds_read_b128 v[228:231], v249 offset:21440
    s_branch k1_ste_p0
k1_sth_p0:
    s_waitcnt lgkmcnt(7)
    v_mfma_f32_16x16x32_bf16 v[176:179], v[200:203], v[128:131], 0
    v_mbcnt_lo_u32_b32 v255, -1, 0
    v_mbcnt_hi_u32_b32 v255, -1, v255
    v_lshlrev_b32 v255, 4, v255
    s_add_u32 m0, s41, 143360
    s_nop 0
    buffer_load_dwordx4 v255, s[48:51], s7 offen lds
    s_add_u32 s7, s7, 1024
    v_mbcnt_lo_u32_b32 v255, -1, 0
    v_mbcnt_hi_u32_b32 v255, -1, v255
    v_lshlrev_b32 v255, 4, v255
    s_add_u32 m0, s41, 143360
    s_nop 0
    buffer_load_dwordx4 v255, s[48:51], s7 offen lds
    s_add_u32 s7, s7, 1024
    v_mbcnt_lo_u32_b32 v255, -1, 0
    v_mbcnt_hi_u32_b32 v255, -1, v255
    v_lshlrev_b32 v255, 4, v255
    s_add_u32 m0, s41, 143360
    s_nop 0
    buffer_load_dwordx4 v255, s[48:51], s7 offen lds
    s_add_u32 s7, s7, 1024
    v_mbcnt_lo_u32_b32 v255, -1, 0
    v_mbcnt_hi_u32_b32 v255, -1, v255
    v_lshlrev_b32 v255, 4, v255
    s_add_u32 m0, s41, 143360
    s_nop 0
    buffer_load_dwordx4 v255, s[48:51], s7 offen lds
    s_add_u32 s7, s7, 1024
    s_waitcnt lgkmcnt(6)
    v_mfma_f32_16x16x32_bf16 v[176:179], v[204:207], v[132:135], v[176:179]
    s_waitcnt lgkmcnt(5)
    v_mfma_f32_16x16x32_bf16 v[176:179], v[208:211], v[136:139], v[176:179]
    s_waitcnt lgkmcnt(4)
    v_mfma_f32_16x16x32_bf16 v[176:179], v[212:215], v[140:143], v[176:179]
    s_waitcnt lgkmcnt(3)
    v_mfma_f32_16x16x32_bf16 v[180:183], v[216:219], v[128:131], 0
    s_waitcnt lgkmcnt(2)
    v_mfma_f32_16x16x32_bf16 v[180:183], v[220:223], v[132:135], v[180:183]
    s_waitcnt lgkmcnt(1)
    v_mfma_f32_16x16x32_bf16 v[180:183], v[224:227], v[136:139], v[180:183]
    s_waitcnt lgkmcnt(0)
    v_mfma_f32_16x16x32_bf16 v[180:183], v[228:231], v[140:143], v[180:183]
    v_mfma_f32_16x16x32_bf16 v[184:187], v[200:203], v[144:147], 0
    v_mfma_f32_16x16x32_bf16 v[184:187], v[204:207], v[148:151], v[184:187]
    v_mfma_f32_16x16x32_bf16 v[184:187], v[208:211], v[152:155], v[184:187]
    v_max3_f32 v253, v176, v177, v178
    s_nop 3
    v_max3_f32 v253, v253, v179, v180
    v_mfma_f32_16x16x32_bf16 v[184:187], v[212:215], v[156:159], v[184:187]
    v_max3_f32 v253, v253, v181, v182
    v_max_f32 v253, v253, v183
    v_mfma_f32_16x16x32_bf16 v[188:191], v[216:219], v[144:147], 0
    v_mov_b32 v245, v253
    s_nop 1
    v_permlane32_swap_b32 v253, v245
    v_max_f32 v253, v253, v245
    v_mov_b32 v245, v253
    s_nop 1
    v_permlane16_swap_b32 v253, v245
    v_max_f32 v253, v253, v245
    v_sub_f32 v176, v176, v253
    v_sub_f32 v177, v177, v253
    v_sub_f32 v178, v178, v253
    v_sub_f32 v179, v179, v253
    v_sub_f32 v180, v180, v253
    v_sub_f32 v181, v181, v253
    v_sub_f32 v182, v182, v253
    v_sub_f32 v183, v183, v253
    v_sub_f32 v232, 0, v253
    v_sub_f32 v233, 0, v253
    v_sub_f32 v234, 0, v253
    v_sub_f32 v235, 0, v253
    v_exp_f32 v176, v176
    v_mfma_f32_16x16x32_bf16 v[188:191], v[220:223], v[148:151], v[188:191]
    v_exp_f32 v177, v177
    v_exp_f32 v178, v178
    v_mfma_f32_16x16x32_bf16 v[188:191], v[224:227], v[152:155], v[188:191]
    v_exp_f32 v179, v179
    v_exp_f32 v180, v180
    v_mfma_f32_16x16x32_bf16 v[188:191], v[228:231], v[156:159], v[188:191]
    v_exp_f32 v181, v181
    v_exp_f32 v182, v182
    v_mfma_f32_16x16x32_bf16 v[192:195], v[200:203], v[160:163], 0
    ds_read_b64_tr_b16 v[200:201], v250
    ds_read_b64_tr_b16 v[202:203], v250 offset:4096
    v_exp_f32 v183, v183
    v_add_f32 v245, v176, v177
    v_mfma_f32_16x16x32_bf16 v[192:195], v[204:207], v[164:167], v[192:195]
    v_xor_b32 v254, 32, v250
    ds_read_b64_tr_b16 v[204:205], v254
    ds_read_b64_tr_b16 v[206:207], v254 offset:4096
    v_add_f32 v245, v245, v178
    v_add_f32 v245, v245, v179
    v_mfma_f32_16x16x32_bf16 v[192:195], v[208:211], v[168:171], v[192:195]
    v_xor_b32 v255, 64, v250
    ds_read_b64_tr_b16 v[208:209], v255
    ds_read_b64_tr_b16 v[210:211], v255 offset:4096
    v_add_f32 v245, v245, v180
    v_add_f32 v245, v245, v181
    v_mfma_f32_16x16x32_bf16 v[192:195], v[212:215], v[172:175], v[192:195]
    v_xor_b32 v254, 96, v250
    ds_read_b64_tr_b16 v[212:213], v254
    ds_read_b64_tr_b16 v[214:215], v254 offset:4096
    v_add_f32 v245, v245, v182
    v_add_f32 v245, v245, v183
    v_max3_f32 v253, v184, v185, v186
    v_max3_f32 v253, v253, v187, v188
    v_mfma_f32_16x16x32_bf16 v[196:199], v[216:219], v[160:163], 0
    v_xor_b32 v255, 128, v250
    ds_read_b64_tr_b16 v[216:217], v255
    ds_read_b64_tr_b16 v[218:219], v255 offset:4096
    v_cvt_pk_bf16_f32 v176, v176, v177
    v_cvt_pk_bf16_f32 v177, v178, v179
    v_max3_f32 v253, v253, v189, v190
    v_max_f32 v253, v253, v191
    v_mfma_f32_16x16x32_bf16 v[196:199], v[220:223], v[164:167], v[196:199]
    v_xor_b32 v254, 160, v250
    ds_read_b64_tr_b16 v[220:221], v254
    ds_read_b64_tr_b16 v[222:223], v254 offset:4096
    v_cvt_pk_bf16_f32 v178, v180, v181
    v_cvt_pk_bf16_f32 v179, v182, v183
    v_mov_b32 v246, v253
    s_nop 1
    v_permlane32_swap_b32 v253, v246
    v_max_f32 v253, v253, v246
    v_mov_b32 v246, v253
    s_nop 1
    v_permlane16_swap_b32 v253, v246
    v_max_f32 v253, v253, v246
    v_sub_f32 v184, v184, v253
    v_sub_f32 v185, v185, v253
    v_sub_f32 v186, v186, v253
    v_sub_f32 v187, v187, v253
    v_sub_f32 v188, v188, v253
    v_sub_f32 v189, v189, v253
    v_sub_f32 v190, v190, v253
    v_sub_f32 v191, v191, v253
    v_sub_f32 v236, 0, v253
    v_sub_f32 v237, 0, v253
    v_sub_f32 v238, 0, v253
    v_sub_f32 v239, 0, v253
    v_exp_f32 v184, v184
    v_mfma_f32_16x16x32_bf16 v[196:199], v[224:227], v[168:171], v[196:199]
    v_xor_b32 v255, 192, v250
    ds_read_b64_tr_b16 v[224:225], v255
    ds_read_b64_tr_b16 v[226:227], v255 offset:4096
    v_exp_f32 v185, v185
    v_exp_f32 v186, v186
    v_mfma_f32_16x16x32_bf16 v[196:199], v[228:231], v[172:175], v[196:199]
    v_xor_b32 v254, 224, v250
    ds_read_b64_tr_b16 v[228:229], v254
    ds_read_b64_tr_b16 v[230:231], v254 offset:4096
    v_exp_f32 v187, v187
    v_exp_f32 v188, v188
    s_waitcnt lgkmcnt(14)
    v_mfma_f32_16x16x32_bf16 v[0:3], v[200:203], v[176:179], 0
    v_exp_f32 v189, v189
    v_exp_f32 v190, v190
    s_waitcnt lgkmcnt(12)
    v_mfma_f32_16x16x32_bf16 v[4:7], v[204:207], v[176:179], 0
    v_exp_f32 v191, v191
    v_add_f32 v246, v184, v185
    s_waitcnt lgkmcnt(10)
    v_mfma_f32_16x16x32_bf16 v[8:11], v[208:211], v[176:179], 0
    v_add_f32 v246, v246, v186
    v_add_f32 v246, v246, v187
    s_waitcnt lgkmcnt(8)
    v_mfma_f32_16x16x32_bf16 v[12:15], v[212:215], v[176:179], 0
    v_add_f32 v246, v246, v188
    v_add_f32 v246, v246, v189
    v_max3_f32 v253, v192, v193, v194
    v_max3_f32 v253, v253, v195, v196
    s_waitcnt lgkmcnt(6)
    v_mfma_f32_16x16x32_bf16 v[16:19], v[216:219], v[176:179], 0
    v_add_f32 v246, v246, v190
    v_add_f32 v246, v246, v191
    v_max3_f32 v253, v253, v197, v198
    v_max_f32 v253, v253, v199
    s_waitcnt lgkmcnt(4)
    v_mfma_f32_16x16x32_bf16 v[20:23], v[220:223], v[176:179], 0
    v_cvt_pk_bf16_f32 v184, v184, v185
    v_cvt_pk_bf16_f32 v185, v186, v187
    v_mov_b32 v247, v253
    s_nop 1
    v_permlane32_swap_b32 v253, v247
    v_max_f32 v253, v253, v247
    v_mov_b32 v247, v253
    s_nop 1
    v_permlane16_swap_b32 v253, v247
    v_max_f32 v253, v253, v247
    v_sub_f32 v192, v192, v253
    v_sub_f32 v193, v193, v253
    v_sub_f32 v194, v194, v253
    v_sub_f32 v195, v195, v253
    v_sub_f32 v196, v196, v253
    v_sub_f32 v197, v197, v253
    v_sub_f32 v198, v198, v253
    v_sub_f32 v199, v199, v253
    v_sub_f32 v240, 0, v253
    v_sub_f32 v241, 0, v253
    v_sub_f32 v242, 0, v253
    v_sub_f32 v243, 0, v253
    v_exp_f32 v192, v192
    s_waitcnt lgkmcnt(2)
    v_mfma_f32_16x16x32_bf16 v[24:27], v[224:227], v[176:179], 0
    v_cvt_pk_bf16_f32 v186, v188, v189
    v_cvt_pk_bf16_f32 v187, v190, v191
    v_exp_f32 v193, v193
    v_exp_f32 v194, v194
    s_waitcnt lgkmcnt(0)
    v_mfma_f32_16x16x32_bf16 v[28:31], v[228:231], v[176:179], 0
    v_exp_f32 v195, v195
    v_exp_f32 v196, v196
    v_mfma_f32_16x16x32_bf16 v[32:35], v[200:203], v[184:187], 0
    v_exp_f32 v197, v197
    v_exp_f32 v198, v198
    v_mfma_f32_16x16x32_bf16 v[36:39], v[204:207], v[184:187], 0
    v_exp_f32 v199, v199
    v_add_f32 v247, v192, v193
    v_mfma_f32_16x16x32_bf16 v[40:43], v[208:211], v[184:187], 0
    v_add_f32 v247, v247, v194
    v_add_f32 v247, v247, v195
    v_mfma_f32_16x16x32_bf16 v[44:47], v[212:215], v[184:187], 0
    v_add_f32 v247, v247, v196
    v_add_f32 v247, v247, v197
    v_mfma_f32_16x16x32_bf16 v[48:51], v[216:219], v[184:187], 0
    v_add_f32 v247, v247, v198
    v_add_f32 v247, v247, v199
    v_mfma_f32_16x16x32_bf16 v[52:55], v[220:223], v[184:187], 0
    v_cvt_pk_bf16_f32 v192, v192, v193
    v_cvt_pk_bf16_f32 v193, v194, v195
    v_mfma_f32_16x16x32_bf16 v[56:59], v[224:227], v[184:187], 0
    v_cvt_pk_bf16_f32 v194, v196, v197
    v_cvt_pk_bf16_f32 v195, v198, v199
    v_mfma_f32_16x16x32_bf16 v[60:63], v[228:231], v[184:187], 0
    s_nop 0
    v_mfma_f32_16x16x32_bf16 v[64:67], v[200:203], v[192:195], 0
    ds_read_b128 v[200:203], v249
    v_mfma_f32_16x16x32_bf16 v[68:71], v[204:207], v[192:195], 0
    ds_read_b128 v[204:207], v249 offset:64
    v_mfma_f32_16x16x32_bf16 v[72:75], v[208:211], v[192:195], 0
    ds_read_b128 v[208:211], v249 offset:128
    v_mfma_f32_16x16x32_bf16 v[76:79], v[212:215], v[192:195], 0
    ds_read_b128 v[212:215], v249 offset:192
    v_mfma_f32_16x16x32_bf16 v[80:83], v[216:219], v[192:195], 0
    ds_read_b128 v[216:219], v249 offset:4352
    v_mfma_f32_16x16x32_bf16 v[84:87], v[220:223], v[192:195], 0
    ds_read_b128 v[220:223], v249 offset:4416
    v_mfma_f32_16x16x32_bf16 v[88:91], v[224:227], v[192:195], 0
    ds_read_b128 v[224:227], v249 offset:4480
    v_mfma_f32_16x16x32_bf16 v[92:95], v[228:231], v[192:195], 0
    ds_read_b128 v[228:231], v249 offset:4544
    v_mbcnt_lo_u32_b32 v255, -1, 0
    v_mbcnt_hi_u32_b32 v255, -1, v255
    v_lshl_add_u32 v255, v255, 4, s55
    ds_read_b128 v[184:187], v255
    ds_read_b128 v[188:191], v255 offset:1024
    ds_read_b128 v[192:195], v255 offset:2048
    ds_read_b128 v[196:199], v255 offset:3072
    v_mov_b32 v176, v244
    v_mov_b32 v177, v244
    v_mov_b32 v178, v244
    v_mov_b32 v179, v244
    v_mov_b32 v180, v244
    v_mov_b32 v181, v244
    v_mov_b32 v182, v244
    v_mov_b32 v183, v244
    s_waitcnt lgkmcnt(0)
    v_mfma_f32_16x16x32_bf16 v[176:179], v[200:203], v[184:187], v[176:179]
    ds_read_b64_tr_b16 v[200:201], v250
    ds_read_b64_tr_b16 v[202:203], v250 offset:4096
    v_mfma_f32_16x16x32_bf16 v[176:179], v[204:207], v[188:191], v[176:179]
    v_xor_b32 v254, 32, v250
    ds_read_b64_tr_b16 v[204:205], v254
    ds_read_b64_tr_b16 v[206:207], v254 offset:4096
    v_mfma_f32_16x16x32_bf16 v[176:179], v[208:211], v[192:195], v[176:179]
    v_xor_b32 v255, 64, v250
    ds_read_b64_tr_b16 v[208:209], v255
    ds_read_b64_tr_b16 v[210:211], v255 offset:4096
    v_mfma_f32_16x16x32_bf16 v[176:179], v[212:215], v[196:199], v[176:179]
    v_xor_b32 v254, 96, v250
    ds_read_b64_tr_b16 v[212:213], v254
    ds_read_b64_tr_b16 v[214:215], v254 offset:4096
    v_mfma_f32_16x16x32_bf16 v[180:183], v[216:219], v[184:187], v[180:183]
    v_xor_b32 v255, 128, v250
    ds_read_b64_tr_b16 v[216:217], v255
    ds_read_b64_tr_b16 v[218:219], v255 offset:4096
    v_mfma_f32_16x16x32_bf16 v[180:183], v[220:223], v[188:191], v[180:183]
    v_xor_b32 v254, 160, v250
    ds_read_b64_tr_b16 v[220:221], v254
    ds_read_b64_tr_b16 v[222:223], v254 offset:4096
    v_mfma_f32_16x16x32_bf16 v[180:183], v[224:227], v[192:195], v[180:183]
    v_xor_b32 v255, 192, v250
    ds_read_b64_tr_b16 v[224:225], v255
    ds_read_b64_tr_b16 v[226:227], v255 offset:4096
    v_mfma_f32_16x16x32_bf16 v[180:183], v[228:231], v[196:199], v[180:183]
    v_xor_b32 v254, 224, v250
    ds_read_b64_tr_b16 v[228:229], v254
    ds_read_b64_tr_b16 v[230:231], v254 offset:4096
    v_max3_f32 v253, v176, v177, v178
    s_nop 3
    v_max3_f32 v253, v253, v179, v180
    v_max3_f32 v253, v253, v181, v182
    v_max_f32 v253, v253, v183
    v_cmp_lt_f32 vcc, s53, v253
    s_nop 1
    s_cbranch_vccnz k1_rare_p0b_L
k1_ok_p0b_L:
    v_exp_f32 v176, v176
    v_exp_f32 v177, v177
    v_exp_f32 v178, v178
    v_exp_f32 v179, v179
    v_exp_f32 v180, v180
    v_exp_f32 v181, v181
    v_exp_f32 v182, v182
    v_exp_f32 v183, v183
    v_add_f32 v248, v248, v176
    v_add_f32 v248, v248, v177
    v_add_f32 v248, v248, v178
    v_add_f32 v248, v248, v179
    v_add_f32 v248, v248, v180
    v_add_f32 v248, v248, v181
    v_add_f32 v248, v248, v182
    v_add_f32 v248, v248, v183
    v_cvt_pk_bf16_f32 v176, v176, v177
    v_cvt_pk_bf16_f32 v177, v178, v179
    v_cvt_pk_bf16_f32 v178, v180, v181
    v_cvt_pk_bf16_f32 v179, v182, v183
    s_mov_b32 s53, 0x41800000
    s_mov_b32 s54, 0
    s_waitcnt lgkmcnt(0)
    v_mfma_f32_16x16x32_bf16 v[96:99], v[200:203], v[176:179], v[96:99]
    ds_read_b128 v[200:203], v249 offset:16896
    v_mfma_f32_16x16x32_bf16 v[100:103], v[204:207], v[176:179], v[100:103]
    ds_read_b128 v[204:207], v249 offset:16960
    v_mfma_f32_16x16x32_bf16 v[104:107], v[208:211], v[176:179], v[104:107]
    ds_read_b128 v[208:211], v249 offset:17024
    v_mfma_f32_16x16x32_bf16 v[108:111], v[212:215], v[176:179], v[108:111]
    ds_read_b128 v[212:215], v249 offset:17088
    v_mfma_f32_16x16x32_bf16 v[112:115], v[216:219], v[176:179], v[112:115]
    ds_read_b128 v[216:219], v249 offset:21248
    v_mfma_f32_16x16x32_bf16 v[116:119], v[220:223], v[176:179], v[116:119]
    ds_read_b128 v[220:223], v249 offset:21312
    v_mfma_f32_16x16x32_bf16 v[120:123], v[224:227], v[176:179], v[120:123]
    ds_read_b128 v[224:227], v249 offset:21376
    v_mfma_f32_16x16x32_bf16 v[124:127], v[228:231], v[176:179], v[124:127]
    ds_read_b128 v[228:231], v249 offset:21440
k1_ste_p0:
    s_mov_b32 s36, 0
    s_branch k1_loop1
k1_loop:
    s_cmp_eq_u32 s52, 0
    s_cbranch_scc1 k1_sth_q0
    s_waitcnt lgkmcnt(7)
    v_mfma_f32_16x16x32_bf16 v[176:179], v[200:203], v[128:131], v[232:235]
    s_add_u32 m0, s43, 33792
    s_nop 0
    buffer_load_dwordx4 v251, s[8:11], s33 offen nt lds
    s_waitcnt lgkmcnt(6)
    v_mfma_f32_16x16x32_bf16 v[176:179], v[204:207], v[132:135], v[176:179]
    s_waitcnt lgkmcnt(5)
    v_mfma_f32_16x16x32_bf16 v[176:179], v[208:211], v[136:139], v[176:179]
    s_add_u32 m0, s43, 38144
    s_add_u32 s37, s33, 4096
    buffer_load_dwordx4 v251, s[8:11], s37 offen nt lds
    s_waitcnt lgkmcnt(4)
    v_mfma_f32_16x16x32_bf16 v[176:179], v[212:215], v[140:143], v[176:179]
    s_waitcnt lgkmcnt(3)
    v_mfma_f32_16x16x32_bf16 v[180:183], v[216:219], v[128:131], v[232:235]
    s_add_u32 m0, s44, 33792
    s_nop 0
    buffer_load_dwordx4 v252, s[12:15], s33 offen nt lds
    s_waitcnt lgkmcnt(2)
    v_mfma_f32_16x16x32_bf16 v[180:183], v[220:223], v[132:135], v[180:183]
    s_waitcnt lgkmcnt(1)
    v_mfma_f32_16x16x32_bf16 v[180:183], v[224:227], v[136:139], v[180:183]
    s_add_u32 m0, s44, 37888
    s_add_u32 s37, s33, 4096
    buffer_load_dwordx4 v252, s[12:15], s37 offen nt lds
    s_add_u32 s33, s33, 8192
    s_waitcnt lgkmcnt(0)
    v_mfma_f32_16x16x32_bf16 v[180:183], v[228:231], v[140:143], v[180:183]
    v_mfma_f32_16x16x32_bf16 v[184:187], v[200:203], v[144:147], v[236:239]
    s_add_u32 m0, s43, 50688
    s_nop 0
    buffer_load_dwordx4 v251, s[8:11], s33 offen nt lds
    v_mfma_f32_16x16x32_bf16 v[184:187], v[204:207], v[148:151], v[184:187]
    v_mfma_f32_16x16x32_bf16 v[184:187], v[208:211], v[152:155], v[184:187]
    s_add_u32 m0, s43, 55040
    s_add_u32 s37, s33, 4096
    buffer_load_dwordx4 v251, s[8:11], s37 offen nt lds
    v_max3_f32 v253, v176, v177, v178
    v_max3_f32 v253, v253, v179, v180
    v_max3_f32 v253, v253, v181, v182
    v_mfma_f32_16x16x32_bf16 v[184:187], v[212:215], v[156:159], v[184:187]
    v_max_f32 v253, v253, v183
    v_cmp_lt_f32 vcc, s31, v253
    v_mfma_f32_16x16x32_bf16 v[188:191], v[216:219], v[144:147], v[236:239]
    s_add_u32 m0, s44, 50688
    s_nop 0
    buffer_load_dwordx4 v252, s[12:15], s33 offen nt lds
    s_cbranch_vccnz k1_rare_q0a_0
k1_ok_q0a_0:
    v_mfma_f32_16x16x32_bf16 v[188:191], v[220:223], v[148:151], v[188:191]
    v_exp_f32 v176, v176
    v_exp_f32 v177, v177
    v_mfma_f32_16x16x32_bf16 v[188:191], v[224:227], v[152:155], v[188:191]
    s_add_u32 m0, s44, 54784
    s_add_u32 s37, s33, 4096
    buffer_load_dwordx4 v252, s[12:15], s37 offen nt lds
    s_add_u32 s33, s33, 8192
    v_exp_f32 v178, v178
    v_exp_f32 v179, v179
    v_exp_f32 v180, v180
    v_mfma_f32_16x16x32_bf16 v[188:191], v[228:231], v[156:159], v[188:191]
    v_exp_f32 v181, v181
    v_exp_f32 v182, v182
    v_mfma_f32_16x16x32_bf16 v[192:195], v[200:203], v[160:163], v[240:243]
    ds_read_b64_tr_b16 v[200:201], v250
    ds_read_b64_tr_b16 v[202:203], v250 offset:4096
    v_exp_f32 v183, v183
    v_add_f32 v245, v245, v176
    v_mfma_f32_16x16x32_bf16 v[192:195], v[204:207], v[164:167], v[192:195]
    v_xor_b32 v254, 32, v250
    ds_read_b64_tr_b16 v[204:205], v254
    ds_read_b64_tr_b16 v[206:207], v254 offset:4096
    v_add_f32 v245, v245, v177
    v_add_f32 v245, v245, v178
    v_mfma_f32_16x16x32_bf16 v[192:195], v[208:211], v[168:171], v[192:195]
    v_xor_b32 v255, 64, v250
    ds_read_b64_tr_b16 v[208:209], v255
    ds_read_b64_tr_b16 v[210:211], v255 offset:4096
    v_add_f32 v245, v245, v179
    v_add_f32 v245, v245, v180
    v_add_f32 v245, v245, v181
    v_mfma_f32_16x16x32_bf16 v[192:195], v[212:215], v[172:175], v[192:195]
    v_xor_b32 v254, 96, v250
    ds_read_b64_tr_b16 v[212:213], v254
    ds_read_b64_tr_b16 v[214:215], v254 offset:4096
    v_add_f32 v245, v245, v182
    v_add_f32 v245, v245, v183
    v_max3_f32 v253, v184, v185, v186
    v_max3_f32 v253, v253, v187, v188
    v_max3_f32 v253, v253, v189, v190
    v_mfma_f32_16x16x32_bf16 v[196:199], v[216:219], v[160:163], v[240:243]
    v_xor_b32 v255, 128, v250
    ds_read_b64_tr_b16 v[216:217], v255
    ds_read_b64_tr_b16 v[218:219], v255 offset:4096
    v_cvt_pk_bf16_f32 v176, v176, v177
    v_cvt_pk_bf16_f32 v177, v178, v179
    v_max_f32 v253, v253, v191
    v_cmp_lt_f32 vcc, s31, v253
    v_mfma_f32_16x16x32_bf16 v[196:199], v[220:223], v[164:167], v[196:199]
    v_xor_b32 v254, 160, v250
    ds_read_b64_tr_b16 v[220:221], v254
    ds_read_b64_tr_b16 v[222:223], v254 offset:4096
    v_cvt_pk_bf16_f32 v178, v180, v181
    v_cvt_pk_bf16_f32 v179, v182, v183
    s_cbranch_vccnz k1_rare_q0a_1
k1_ok_q0a_1:
    v_mfma_f32_16x16x32_bf16 v[196:199], v[224:227], v[168:171], v[196:199]
    v_xor_b32 v255, 192, v250
    ds_read_b64_tr_b16 v[224:225], v255
    ds_read_b64_tr_b16 v[226:227], v255 offset:4096
    v_exp_f32 v184, v184
    v_exp_f32 v185, v185
    v_mfma_f32_16x16x32_bf16 v[196:199], v[228:231], v[172:175], v[196:199]
    v_xor_b32 v254, 224, v250
    ds_read_b64_tr_b16 v[228:229], v254
    ds_read_b64_tr_b16 v[230:231], v254 offset:4096
    v_exp_f32 v186, v186
    v_exp_f32 v187, v187
    v_exp_f32 v188, v188
    s_waitcnt lgkmcnt(14)
    v_mfma_f32_16x16x32_bf16 v[0:3], v[200:203], v[176:179], v[0:3]
    v_exp_f32 v189, v189
    v_exp_f32 v190, v190
    s_waitcnt lgkmcnt(12)
    v_mfma_f32_16x16x32_bf16 v[4:7], v[204:207], v[176:179], v[4:7]
    v_exp_f32 v191, v191
    v_add_f32 v246, v246, v184
    s_waitcnt lgkmcnt(10)
    v_mfma_f32_16x16x32_bf16 v[8:11], v[208:211], v[176:179], v[8:11]
    v_add_f32 v246, v246, v185
    v_add_f32 v246, v246, v186
    s_waitcnt lgkmcnt(8)
    v_mfma_f32_16x16x32_bf16 v[12:15], v[212:215], v[176:179], v[12:15]
    v_add_f32 v246, v246, v187
    v_add_f32 v246, v246, v188
    v_add_f32 v246, v246, v189
    v_max3_f32 v253, v192, v193, v194
    v_max3_f32 v253, v253, v195, v196
    v_max3_f32 v253, v253, v197, v198
    s_waitcnt lgkmcnt(6)
    v_mfma_f32_16x16x32_bf16 v[16:19], v[216:219], v[176:179], v[16:19]
    v_add_f32 v246, v246, v190
    v_add_f32 v246, v246, v191
    v_max_f32 v253, v253, v199
    v_cmp_lt_f32 vcc, s31, v253
    s_waitcnt lgkmcnt(4)
    v_mfma_f32_16x16x32_bf16 v[20:23], v[220:223], v[176:179], v[20:23]
    v_cvt_pk_bf16_f32 v184, v184, v185
    v_cvt_pk_bf16_f32 v185, v186, v187
    s_cbranch_vccnz k1_rare_q0a_2
k1_ok_q0a_2:
    s_waitcnt lgkmcnt(2)
    v_mfma_f32_16x16x32_bf16 v[24:27], v[224:227], v[176:179], v[24:27]
    v_cvt_pk_bf16_f32 v186, v188, v189
    v_cvt_pk_bf16_f32 v187, v190, v191
    v_exp_f32 v192, v192
    v_exp_f32 v193, v193
    s_waitcnt lgkmcnt(0)
    v_mfma_f32_16x16x32_bf16 v[28:31], v[228:231], v[176:179], v[28:31]
    v_exp_f32 v194, v194
    v_exp_f32 v195, v195
    v_exp_f32 v196, v196
    v_mfma_f32_16x16x32_bf16 v[32:35], v[200:203], v[184:187], v[32:35]
    v_exp_f32 v197, v197
    v_exp_f32 v198, v198
    v_mfma_f32_16x16x32_bf16 v[36:39], v[204:207], v[184:187], v[36:39]
    v_exp_f32 v199, v199
    v_add_f32 v247, v247, v192
    v_mfma_f32_16x16x32_bf16 v[40:43], v[208:211], v[184:187], v[40:43]
    v_add_f32 v247, v247, v193
    v_add_f32 v247, v247, v194
    v_mfma_f32_16x16x32_bf16 v[44:47], v[212:215], v[184:187], v[44:47]
    v_add_f32 v247, v247, v195
    v_add_f32 v247, v247, v196
    v_add_f32 v247, v247, v197
    v_mfma_f32_16x16x32_bf16 v[48:51], v[216:219], v[184:187], v[48:51]
    v_add_f32 v247, v247, v198
    v_add_f32 v247, v247, v199
    v_mfma_f32_16x16x32_bf16 v[52:55], v[220:223], v[184:187], v[52:55]
    v_cvt_pk_bf16_f32 v192, v192, v193
    v_cvt_pk_bf16_f32 v193, v194, v195
    v_mfma_f32_16x16x32_bf16 v[56:59], v[224:227], v[184:187], v[56:59]
    v_cvt_pk_bf16_f32 v194, v196, v197
    v_cvt_pk_bf16_f32 v195, v198, v199
    v_mfma_f32_16x16x32_bf16 v[60:63], v[228:231], v[184:187], v[60:63]
    s_nop 0
    v_mfma_f32_16x16x32_bf16 v[64:67], v[200:203], v[192:195], v[64:67]
    ds_read_b128 v[200:203], v249 offset:16896
    v_mfma_f32_16x16x32_bf16 v[68:71], v[204:207], v[192:195], v[68:71]
    ds_read_b128 v[204:207], v249 offset:16960
    v_mfma_f32_16x16x32_bf16 v[72:75], v[208:211], v[192:195], v[72:75]
    ds_read_b128 v[208:211], v249 offset:17024
    v_mfma_f32_16x16x32_bf16 v[76:79], v[212:215], v[192:195], v[76:79]
    ds_read_b128 v[212:215], v249 offset:17088
    v_mfma_f32_16x16x32_bf16 v[80:83], v[216:219], v[192:195], v[80:83]
    ds_read_b128 v[216:219], v249 offset:21248
    v_mfma_f32_16x16x32_bf16 v[84:87], v[220:223], v[192:195], v[84:87]
    ds_read_b128 v[220:223], v249 offset:21312
    v_mfma_f32_16x16x32_bf16 v[88:91], v[224:227], v[192:195], v[88:91]
    ds_read_b128 v[224:227], v249 offset:21376
    v_mfma_f32_16x16x32_bf16 v[92:95], v[228:231], v[192:195], v[92:95]
    ds_read_b128 v[228:231], v249 offset:21440
    s_branch k1_ste_q0
k1_sth_q0:
    s_waitcnt lgkmcnt(7)
    v_mfma_f32_16x16x32_bf16 v[176:179], v[200:203], v[128:131], v[232:235]
    s_add_u32 m0, s43, 33792
    s_nop 0
    buffer_load_dwordx4 v251, s[8:11], s33 offen nt lds
    s_waitcnt lgkmcnt(6)
    v_mfma_f32_16x16x32_bf16 v[176:179], v[204:207], v[132:135], v[176:179]
    s_waitcnt lgkmcnt(5)
    v_mfma_f32_16x16x32_bf16 v[176:179], v[208:211], v[136:139], v[176:179]
    s_add_u32 m0, s43, 38144
    s_add_u32 s37, s33, 4096
    buffer_load_dwordx4 v251, s[8:11], s37 offen nt lds
    s_waitcnt lgkmcnt(4)
    v_mfma_f32_16x16x32_bf16 v[176:179], v[212:215], v[140:143], v[176:179]
    s_waitcnt lgkmcnt(3)
    v_mfma_f32_16x16x32_bf16 v[180:183], v[216:219], v[128:131], v[232:235]
    s_add_u32 m0, s44, 33792
    s_nop 0
    buffer_load_dwordx4 v252, s[12:15], s33 offen nt lds
    s_waitcnt lgkmcnt(2)
    v_mfma_f32_16x16x32_bf16 v[180:183], v[220:223], v[132:135], v[180:183]
    s_waitcnt lgkmcnt(1)
    v_mfma_f32_16x16x32_bf16 v[180:183], v[224:227], v[136:139], v[180:183]
    s_add_u32 m0, s44, 37888
    s_add_u32 s37, s33, 4096
    buffer_load_dwordx4 v252, s[12:15], s37 offen nt lds
    s_add_u32 s33, s33, 8192
    s_waitcnt lgkmcnt(0)
    v_mfma_f32_16x16x32_bf16 v[180:183], v[228:231], v[140:143], v[180:183]
    v_mfma_f32_16x16x32_bf16 v[184:187], v[200:203], v[144:147], v[236:239]
    s_add_u32 m0, s43, 50688
    s_nop 0
    buffer_load_dwordx4 v251, s[8:11], s33 offen nt lds
    v_mfma_f32_16x16x32_bf16 v[184:187], v[204:207], v[148:151], v[184:187]
    v_mfma_f32_16x16x32_bf16 v[184:187], v[208:211], v[152:155], v[184:187]
    s_add_u32 m0, s43, 55040
    s_add_u32 s37, s33, 4096
    buffer_load_dwordx4 v251, s[8:11], s37 offen nt lds
    v_max3_f32 v253, v176, v177, v178
    v_max3_f32 v253, v253, v179, v180
    v_max3_f32 v253, v253, v181, v182
    v_mfma_f32_16x16x32_bf16 v[184:187], v[212:215], v[156:159], v[184:187]
    v_max_f32 v253, v253, v183
    v_cmp_lt_f32 vcc, s31, v253
    v_mfma_f32_16x16x32_bf16 v[188:191], v[216:219], v[144:147], v[236:239]
    s_add_u32 m0, s44, 50688
    s_nop 0
    buffer_load_dwordx4 v252, s[12:15], s33 offen nt lds
    s_cbranch_vccnz k1_rare_q0b_0
k1_ok_q0b_0:
    v_mfma_f32_16x16x32_bf16 v[188:191], v[220:223], v[148:151], v[188:191]
    v_exp_f32 v176, v176
    v_exp_f32 v177, v177
    v_mfma_f32_16x16x32_bf16 v[188:191], v[224:227], v[152:155], v[188:191]
    s_add_u32 m0, s44, 54784
    s_add_u32 s37, s33, 4096
    buffer_load_dwordx4 v252, s[12:15], s37 offen nt lds
    s_add_u32 s33, s33, 8192
    v_exp_f32 v178, v178
    v_exp_f32 v179, v179
    v_exp_f32 v180, v180
    v_mfma_f32_16x16x32_bf16 v[188:191], v[228:231], v[156:159], v[188:191]
    v_exp_f32 v181, v181
    v_exp_f32 v182, v182
    v_mfma_f32_16x16x32_bf16 v[192:195], v[200:203], v[160:163], v[240:243]
    ds_read_b64_tr_b16 v[200:201], v250
    ds_read_b64_tr_b16 v[202:203], v250 offset:4096
    v_exp_f32 v183, v183
    v_add_f32 v245, v245, v176
    v_mfma_f32_16x16x32_bf16 v[192:195], v[204:207], v[164:167], v[192:195]
    v_xor_b32 v254, 32, v250
    ds_read_b64_tr_b16 v[204:205], v254
    ds_read_b64_tr_b16 v[206:207], v254 offset:4096
    v_add_f32 v245, v245, v177
    v_add_f32 v245, v245, v178
    v_mfma_f32_16x16x32_bf16 v[192:195], v[208:211], v[168:171], v[192:195]
    v_xor_b32 v255, 64, v250
    ds_read_b64_tr_b16 v[208:209], v255
    ds_read_b64_tr_b16 v[210:211], v255 offset:4096
    v_add_f32 v245, v245, v179
    v_add_f32 v245, v245, v180
    v_add_f32 v245, v245, v181
    v_mfma_f32_16x16x32_bf16 v[192:195], v[212:215], v[172:175], v[192:195]
    v_xor_b32 v254, 96, v250
    ds_read_b64_tr_b16 v[212:213], v254
    ds_read_b64_tr_b16 v[214:215], v254 offset:4096
    v_add_f32 v245, v245, v182
    v_add_f32 v245, v245, v183
    v_max3_f32 v253, v184, v185, v186
    v_max3_f32 v253, v253, v187, v188
    v_max3_f32 v253, v253, v189, v190
    v_mfma_f32_16x16x32_bf16 v[196:199], v[216:219], v[160:163], v[240:243]
    v_xor_b32 v255, 128, v250
    ds_read_b64_tr_b16 v[216:217], v255
    ds_read_b64_tr_b16 v[218:219], v255 offset:4096
    v_cvt_pk_bf16_f32 v176, v176, v177
    v_cvt_pk_bf16_f32 v177, v178, v179
    v_max_f32 v253, v253, v191
    v_cmp_lt_f32 vcc, s31, v253
    v_mfma_f32_16x16x32_bf16 v[196:199], v[220:223], v[164:167], v[196:199]
    v_xor_b32 v254, 160, v250
    ds_read_b64_tr_b16 v[220:221], v254
    ds_read_b64_tr_b16 v[222:223], v254 offset:4096
    v_cvt_pk_bf16_f32 v178, v180, v181
    v_cvt_pk_bf16_f32 v179, v182, v183
    s_cbranch_vccnz k1_rare_q0b_1
k1_ok_q0b_1:
    v_mfma_f32_16x16x32_bf16 v[196:199], v[224:227], v[168:171], v[196:199]
    v_xor_b32 v255, 192, v250
    ds_read_b64_tr_b16 v[224:225], v255
    ds_read_b64_tr_b16 v[226:227], v255 offset:4096
    v_exp_f32 v184, v184
    v_exp_f32 v185, v185
    v_mfma_f32_16x16x32_bf16 v[196:199], v[228:231], v[172:175], v[196:199]
    v_xor_b32 v254, 224, v250
    ds_read_b64_tr_b16 v[228:229], v254
    ds_read_b64_tr_b16 v[230:231], v254 offset:4096
    v_exp_f32 v186, v186
    v_exp_f32 v187, v187
    v_exp_f32 v188, v188
    s_waitcnt lgkmcnt(14)
    v_mfma_f32_16x16x32_bf16 v[0:3], v[200:203], v[176:179], v[0:3]
    v_exp_f32 v189, v189
    v_exp_f32 v190, v190
    s_waitcnt lgkmcnt(12)
    v_mfma_f32_16x16x32_bf16 v[4:7], v[204:207], v[176:179], v[4:7]
    v_exp_f32 v191, v191
    v_add_f32 v246, v246, v184
    s_waitcnt lgkmcnt(10)
    v_mfma_f32_16x16x32_bf16 v[8:11], v[208:211], v[176:179], v[8:11]
    v_add_f32 v246, v246, v185
    v_add_f32 v246, v246, v186
    s_waitcnt lgkmcnt(8)
    v_mfma_f32_16x16x32_bf16 v[12:15], v[212:215], v[176:179], v[12:15]
    v_add_f32 v246, v246, v187
    v_add_f32 v246, v246, v188
    v_add_f32 v246, v246, v189
    v_max3_f32 v253, v192, v193, v194
    v_max3_f32 v253, v253, v195, v196
    v_max3_f32 v253, v253, v197, v198
    s_waitcnt lgkmcnt(6)
    v_mfma_f32_16x16x32_bf16 v[16:19], v[216:219], v[176:179], v[16:19]
    v_add_f32 v246, v246, v190
    v_add_f32 v246, v246, v191
    v_max_f32 v253, v253, v199
    v_cmp_lt_f32 vcc, s31, v253
    s_waitcnt lgkmcnt(4)
    v_mfma_f32_16x16x32_bf16 v[20:23], v[220:223], v[176:179], v[20:23]
    v_cvt_pk_bf16_f32 v184, v184, v185
    v_cvt_pk_bf16_f32 v185, v186, v187
    s_cbranch_vccnz k1_rare_q0b_2
k1_ok_q0b_2:
    s_waitcnt lgkmcnt(2)
    v_mfma_f32_16x16x32_bf16 v[24:27], v[224:227], v[176:179], v[24:27]
    v_cvt_pk_bf16_f32 v186, v188, v189
    v_cvt_pk_bf16_f32 v187, v190, v191
    v_exp_f32 v192, v192
    v_exp_f32 v193, v193
    s_waitcnt lgkmcnt(0)
    v_mfma_f32_16x16x32_bf16 v[28:31], v[228:231], v[176:179], v[28:31]
    v_exp_f32 v194, v194
    v_exp_f32 v195, v195
    v_exp_f32 v196, v196
    v_mfma_f32_16x16x32_bf16 v[32:35], v[200:203], v[184:187], v[32:35]
    v_exp_f32 v197, v197
    v_exp_f32 v198, v198
    v_mfma_f32_16x16x32_bf16 v[36:39], v[204:207], v[184:187], v[36:39]
    v_exp_f32 v199, v199
    v_add_f32 v247, v247, v192
    v_mfma_f32_16x16x32_bf16 v[40:43], v[208:211], v[184:187], v[40:43]
    v_add_f32 v247, v247, v193
    v_add_f32 v247, v247, v194
    v_mfma_f32_16x16x32_bf16 v[44:47], v[212:215], v[184:187], v[44:47]
    v_add_f32 v247, v247, v195
    v_add_f32 v247, v247, v196
    v_add_f32 v247, v247, v197
    v_mfma_f32_16x16x32_bf16 v[48:51], v[216:219], v[184:187], v[48:51]
    v_add_f32 v247, v247, v198
    v_add_f32 v247, v247, v199
    v_mfma_f32_16x16x32_bf16 v[52:55], v[220:223], v[184:187], v[52:55]
    v_cvt_pk_bf16_f32 v192, v192, v193
    v_cvt_pk_bf16_f32 v193, v194, v195
    v_mfma_f32_16x16x32_bf16 v[56:59], v[224:227], v[184:187], v[56:59]
    v_cvt_pk_bf16_f32 v194, v196, v197
    v_cvt_pk_bf16_f32 v195, v198, v199
    v_mfma_f32_16x16x32_bf16 v[60:63], v[228:231], v[184:187], v[60:63]
    s_nop 0
    v_mfma_f32_16x16x32_bf16 v[64:67], v[200:203], v[192:195], v[64:67]
    ds_read_b128 v[200:203], v249
    v_mfma_f32_16x16x32_bf16 v[68:71], v[204:207], v[192:195], v[68:71]
    ds_read_b128 v[204:207], v249 offset:64
    v_mfma_f32_16x16x32_bf16 v[72:75], v[208:211], v[192:195], v[72:75]
    ds_read_b128 v[208:211], v249 offset:128
    v_mfma_f32_16x16x32_bf16 v[76:79], v[212:215], v[192:195], v[76:79]
    ds_read_b128 v[212:215], v249 offset:192
    v_mfma_f32_16x16x32_bf16 v[80:83], v[216:219], v[192:195], v[80:83]
    ds_read_b128 v[216:219], v249 offset:4352
    v_mfma_f32_16x16x32_bf16 v[84:87], v[220:223], v[192:195], v[84:87]
    ds_read_b128 v[220:223], v249 offset:4416
    v_mfma_f32_16x16x32_bf16 v[88:91], v[224:227], v[192:195], v[88:91]
    ds_read_b128 v[224:227], v249 offset:4480
    v_mfma_f32_16x16x32_bf16 v[92:95], v[228:231], v[192:195], v[92:95]
    ds_read_b128 v[228:231], v249 offset:4544
    v_mbcnt_lo_u32_b32 v255, -1, 0
    v_mbcnt_hi_u32_b32 v255, -1, v255
    v_lshl_add_u32 v255, v255, 4, s55
    ds_read_b128 v[184:187], v255
    ds_read_b128 v[188:191], v255 offset:1024
    ds_read_b128 v[192:195], v255 offset:2048
    ds_read_b128 v[196:199], v255 offset:3072
    v_mov_b32 v176, v244
    v_mov_b32 v177, v244
    v_mov_b32 v178, v244
    v_mov_b32 v179, v244
    v_mov_b32 v180, v244
    v_mov_b32 v181, v244
    v_mov_b32 v182, v244
    v_mov_b32 v183, v244
    s_waitcnt lgkmcnt(0)
    v_mfma_f32_16x16x32_bf16 v[176:179], v[200:203], v[184:187], v[176:179]
    ds_read_b64_tr_b16 v[200:201], v250
    ds_read_b64_tr_b16 v[202:203], v250 offset:4096
    v_mfma_f32_16x16x32_bf16 v[176:179], v[204:207], v[188:191], v[176:179]
    v_xor_b32 v254, 32, v250
    ds_read_b64_tr_b16 v[204:205], v254
    ds_read_b64_tr_b16 v[206:207], v254 offset:4096
    v_mfma_f32_16x16x32_bf16 v[176:179], v[208:211], v[192:195], v[176:179]
    v_xor_b32 v255, 64, v250
    ds_read_b64_tr_b16 v[208:209], v255
    ds_read_b64_tr_b16 v[210:211], v255 offset:4096
    v_mfma_f32_16x16x32_bf16 v[176:179], v[212:215], v[196:199], v[176:179]
    v_xor_b32 v254, 96, v250
    ds_read_b64_tr_b16 v[212:213], v254
    ds_read_b64_tr_b16 v[214:215], v254 offset:4096
    v_mfma_f32_16x16x32_bf16 v[180:183], v[216:219], v[184:187], v[180:183]
    v_xor_b32 v255, 128, v250
    ds_read_b64_tr_b16 v[216:217], v255
    ds_read_b64_tr_b16 v[218:219], v255 offset:4096
    v_mfma_f32_16x16x32_bf16 v[180:183], v[220:223], v[188:191], v[180:183]
    v_xor_b32 v254, 160, v250
    ds_read_b64_tr_b16 v[220:221], v254
    ds_read_b64_tr_b16 v[222:223], v254 offset:4096
    v_mfma_f32_16x16x32_bf16 v[180:183], v[224:227], v[192:195], v[180:183]
    v_xor_b32 v255, 192, v250
    ds_read_b64_tr_b16 v[224:225], v255
    ds_read_b64_tr_b16 v[226:227], v255 offset:4096
    v_mfma_f32_16x16x32_bf16 v[180:183], v[228:231], v[196:199], v[180:183]
    v_xor_b32 v254, 224, v250
    ds_read_b64_tr_b16 v[228:229], v254
    ds_read_b64_tr_b16 v[230:231], v254 offset:4096
    v_max3_f32 v253, v176, v177, v178
    s_nop 3
    v_max3_f32 v253, v253, v179, v180
    v_max3_f32 v253, v253, v181, v182
    v_max_f32 v253, v253, v183
    v_cmp_lt_f32 vcc, s53, v253
    s_nop 1
    s_cbranch_vccnz k1_rare_q0b_L
k1_ok_q0b_L:
    v_exp_f32 v176, v176
    v_exp_f32 v177, v177
    v_exp_f32 v178, v178
    v_exp_f32 v179, v179
    v_exp_f32 v180, v180
    v_exp_f32 v181, v181
    v_exp_f32 v182, v182
    v_exp_f32 v183, v183
    v_add_f32 v248, v248, v176
    v_add_f32 v248, v248, v177
    v_add_f32 v248, v248, v178
    v_add_f32 v248, v248, v179
    v_add_f32 v248, v248, v180
    v_add_f32 v248, v248, v181
    v_add_f32 v248, v248, v182
    v_add_f32 v248, v248, v183
    v_cvt_pk_bf16_f32 v176, v176, v177
    v_cvt_pk_bf16_f32 v177, v178, v179
    v_cvt_pk_bf16_f32 v178, v180, v181
    v_cvt_pk_bf16_f32 v179, v182, v183
    s_mov_b32 s53, 0x41800000
    s_mov_b32 s54, 0
    s_waitcnt lgkmcnt(0)
    v_mfma_f32_16x16x32_bf16 v[96:99], v[200:203], v[176:179], v[96:99]
    ds_read_b128 v[200:203], v249 offset:16896
    v_mfma_f32_16x16x32_bf16 v[100:103], v[204:207], v[176:179], v[100:103]
    ds_read_b128 v[204:207], v249 offset:16960
    v_mfma_f32_16x16x32_bf16 v[104:107], v[208:211], v[176:179], v[104:107]
    ds_read_b128 v[208:211], v249 offset:17024
    v_mfma_f32_16x16x32_bf16 v[108:111], v[212:215], v[176:179], v[108:111]
    ds_read_b128 v[212:215], v249 offset:17088
    v_mfma_f32_16x16x32_bf16 v[112:115], v[216:219], v[176:179], v[112:115]
    ds_read_b128 v[216:219], v249 offset:21248
    v_mfma_f32_16x16x32_bf16 v[116:119], v[220:223], v[176:179], v[116:119]
    ds_read_b128 v[220:223], v249 offset:21312
    v_mfma_f32_16x16x32_bf16 v[120:123], v[224:227], v[176:179], v[120:123]
    ds_read_b128 v[224:227], v249 offset:21376
    v_mfma_f32_16x16x32_bf16 v[124:127], v[228:231], v[176:179], v[124:127]
    ds_read_b128 v[228:231], v249 offset:21440
k1_ste_q0:
k1_loop1:
    s_cmp_eq_u32 s52, 1
    s_cbranch_scc1 k1_sth_q1
    s_waitcnt lgkmcnt(7)
    v_mfma_f32_16x16x32_bf16 v[176:179], v[200:203], v[128:131], v[232:235]
    s_waitcnt lgkmcnt(6)
    v_mfma_f32_16x16x32_bf16 v[176:179], v[204:207], v[132:135], v[176:179]
    s_waitcnt lgkmcnt(5)
    v_mfma_f32_16x16x32_bf16 v[176:179], v[208:211], v[136:139], v[176:179]
    s_waitcnt lgkmcnt(4)
    v_mfma_f32_16x16x32_bf16 v[176:179], v[212:215], v[140:143], v[176:179]
    s_waitcnt lgkmcnt(3)
    v_mfma_f32_16x16x32_bf16 v[180:183], v[216:219], v[128:131], v[232:235]
    s_waitcnt lgkmcnt(2)
    v_mfma_f32_16x16x32_bf16 v[180:183], v[220:223], v[132:135], v[180:183]
    s_waitcnt lgkmcnt(1)
    v_mfma_f32_16x16x32_bf16 v[180:183], v[224:227], v[136:139], v[180:183]
    s_waitcnt lgkmcnt(0)
    v_mfma_f32_16x16x32_bf16 v[180:183], v[228:231], v[140:143], v[180:183]
    v_mfma_f32_16x16x32_bf16 v[184:187], v[200:203], v[144:147], v[236:239]
    v_mfma_f32_16x16x32_bf16 v[184:187], v[204:207], v[148:151], v[184:187]
    v_mfma_f32_16x16x32_bf16 v[184:187], v[208:211], v[152:155], v[184:187]
    v_max3_f32 v253, v176, v177, v178
    s_nop 3
    v_max3_f32 v253, v253, v179, v180
    v_max3_f32 v253, v253, v181, v182
    v_mfma_f32_16x16x32_bf16 v[184:187], v[212:215], v[156:159], v[184:187]
    v_max_f32 v253, v253, v183
    v_cmp_lt_f32 vcc, s31, v253
    v_mfma_f32_16x16x32_bf16 v[188:191], v[216:219], v[144:147], v[236:239]
    s_nop 0
    s_cbranch_vccnz k1_rare_q1a_0
k1_ok_q1a_0:
    v_mfma_f32_16x16x32_bf16 v[188:191], v[220:223], v[148:151], v[188:191]
    v_exp_f32 v176, v176
    v_exp_f32 v177, v177
    v_mfma_f32_16x16x32_bf16 v[188:191], v[224:227], v[152:155], v[188:191]
    v_exp_f32 v178, v178
    v_exp_f32 v179, v179
    v_exp_f32 v180, v180
    v_mfma_f32_16x16x32_bf16 v[188:191], v[228:231], v[156:159], v[188:191]
    v_exp_f32 v181, v181
    v_exp_f32 v182, v182
    v_mfma_f32_16x16x32_bf16 v[192:195], v[200:203], v[160:163], v[240:243]
    ds_read_b64_tr_b16 v[200:201], v250 offset:16896
    ds_read_b64_tr_b16 v[202:203], v250 offset:20992
    v_exp_f32 v183, v183
    v_add_f32 v245, v245, v176
    v_mfma_f32_16x16x32_bf16 v[192:195], v[204:207], v[164:167], v[192:195]
    v_xor_b32 v254, 32, v250
    ds_read_b64_tr_b16 v[204:205], v254 offset:16896
    ds_read_b64_tr_b16 v[206:207], v254 offset:20992
    v_add_f32 v245, v245, v177
    v_add_f32 v245, v245, v178
    v_mfma_f32_16x16x32_bf16 v[192:195], v[208:211], v[168:171], v[192:195]
    v_xor_b32 v255, 64, v250
    ds_read_b64_tr_b16 v[208:209], v255 offset:16896
    ds_read_b64_tr_b16 v[210:211], v255 offset:20992
    v_add_f32 v245, v245, v179
    v_add_f32 v245, v245, v180
    v_add_f32 v245, v245, v181
    v_mfma_f32_16x16x32_bf16 v[192:195], v[212:215], v[172:175], v[192:195]
    v_xor_b32 v254, 96, v250
    ds_read_b64_tr_b16 v[212:213], v254 offset:16896
    ds_read_b64_tr_b16 v[214:215], v254 offset:20992
    v_add_f32 v245, v245, v182
    v_add_f32 v245, v245, v183
    v_max3_f32 v253, v184, v185, v186
    v_max3_f32 v253, v253, v187, v188
    v_max3_f32 v253, v253, v189, v190
    v_mfma_f32_16x16x32_bf16 v[196:199], v[216:219], v[160:163], v[240:243]
    v_xor_b32 v255, 128, v250
    ds_read_b64_tr_b16 v[216:217], v255 offset:16896
    ds_read_b64_tr_b16 v[218:219], v255 offset:20992
    v_cvt_pk_bf16_f32 v176, v176, v177
    v_cvt_pk_bf16_f32 v177, v178, v179
    v_max_f32 v253, v253, v191
    v_cmp_lt_f32 vcc, s31, v253
    v_mfma_f32_16x16x32_bf16 v[196:199], v[220:223], v[164:167], v[196:199]
    v_xor_b32 v254, 160, v250
    ds_read_b64_tr_b16 v[220:221], v254 offset:16896
    ds_read_b64_tr_b16 v[222:223], v254 offset:20992
    v_cvt_pk_bf16_f32 v178, v180, v181
    v_cvt_pk_bf16_f32 v179, v182, v183
    s_cbranch_vccnz k1_rare_q1a_1
k1_ok_q1a_1:
    v_mfma_f32_16x16x32_bf16 v[196:199], v[224:227], v[168:171], v[196:199]
    v_xor_b32 v255, 192, v250
    ds_read_b64_tr_b16 v[224:225], v255 offset:16896
    ds_read_b64_tr_b16 v[226:227], v255 offset:20992
    v_exp_f32 v184, v184
    v_exp_f32 v185, v185
    v_mfma_f32_16x16x32_bf16 v[196:199], v[228:231], v[172:175], v[196:199]
    v_xor_b32 v254, 224, v250
    ds_read_b64_tr_b16 v[228:229], v254 offset:16896
    ds_read_b64_tr_b16 v[230:231], v254 offset:20992
    v_exp_f32 v186, v186
    v_exp_f32 v187, v187
    v_exp_f32 v188, v188
    s_waitcnt lgkmcnt(14)
    v_mfma_f32_16x16x32_bf16 v[0:3], v[200:203], v[176:179], v[0:3]
    v_exp_f32 v189, v189
    v_exp_f32 v190, v190
    s_waitcnt lgkmcnt(12)
    v_mfma_f32_16x16x32_bf16 v[4:7], v[204:207], v[176:179], v[4:7]
    v_exp_f32 v191, v191
    v_add_f32 v246, v246, v184
    s_waitcnt lgkmcnt(10)
    v_mfma_f32_16x16x32_bf16 v[8:11], v[208:211], v[176:179], v[8:11]
    v_add_f32 v246, v246, v185
    v_add_f32 v246, v246, v186
    s_waitcnt lgkmcnt(8)
    v_mfma_f32_16x16x32_bf16 v[12:15], v[212:215], v[176:179], v[12:15]
    v_add_f32 v246, v246, v187
    v_add_f32 v246, v246, v188
    v_add_f32 v246, v246, v189
    v_max3_f32 v253, v192, v193, v194
    v_max3_f32 v253, v253, v195, v196
    v_max3_f32 v253, v253, v197, v198
    s_waitcnt lgkmcnt(6)
    v_mfma_f32_16x16x32_bf16 v[16:19], v[216:219], v[176:179], v[16:19]
    v_add_f32 v246, v246, v190
    v_add_f32 v246, v246, v191
    v_max_f32 v253, v253, v199
    v_cmp_lt_f32 vcc, s31, v253
    s_waitcnt lgkmcnt(4)
    v_mfma_f32_16x16x32_bf16 v[20:23], v[220:223], v[176:179], v[20:23]
    v_cvt_pk_bf16_f32 v184, v184, v185
    v_cvt_pk_bf16_f32 v185, v186, v187
    s_cbranch_vccnz k1_rare_q1a_2
k1_ok_q1a_2:
    s_waitcnt lgkmcnt(2)
    v_mfma_f32_16x16x32_bf16 v[24:27], v[224:227], v[176:179], v[24:27]
    v_cvt_pk_bf16_f32 v186, v188, v189
    v_cvt_pk_bf16_f32 v187, v190, v191
    v_exp_f32 v192, v192
    v_exp_f32 v193, v193
    s_waitcnt lgkmcnt(0)
    v_mfma_f32_16x16x32_bf16 v[28:31], v[228:231], v[176:179], v[28:31]
    v_exp_f32 v194, v194
    v_exp_f32 v195, v195
    v_exp_f32 v196, v196
    v_mfma_f32_16x16x32_bf16 v[32:35], v[200:203], v[184:187], v[32:35]
    v_exp_f32 v197, v197
    v_exp_f32 v198, v198
    v_mfma_f32_16x16x32_bf16 v[36:39], v[204:207], v[184:187], v[36:39]
    v_exp_f32 v199, v199
    v_add_f32 v247, v247, v192
    v_mfma_f32_16x16x32_bf16 v[40:43], v[208:211], v[184:187], v[40:43]
    v_add_f32 v247, v247, v193
    v_add_f32 v247, v247, v194
    v_mfma_f32_16x16x32_bf16 v[44:47], v[212:215], v[184:187], v[44:47]
    v_add_f32 v247, v247, v195
    v_add_f32 v247, v247, v196
    v_add_f32 v247, v247, v197
    v_mfma_f32_16x16x32_bf16 v[48:51], v[216:219], v[184:187], v[48:51]
    v_add_f32 v247, v247, v198
    v_add_f32 v247, v247, v199
    v_mfma_f32_16x16x32_bf16 v[52:55], v[220:223], v[184:187], v[52:55]
    v_cvt_pk_bf16_f32 v192, v192, v193
    v_cvt_pk_bf16_f32 v193, v194, v195
    v_mfma_f32_16x16x32_bf16 v[56:59], v[224:227], v[184:187], v[56:59]
    v_cvt_pk_bf16_f32 v194, v196, v197
    v_cvt_pk_bf16_f32 v195, v198, v199
    v_mfma_f32_16x16x32_bf16 v[60:63], v[228:231], v[184:187], v[60:63]
    s_waitcnt vmcnt(0)
    s_barrier
    v_mfma_f32_16x16x32_bf16 v[64:67], v[200:203], v[192:195], v[64:67]
    ds_read_b128 v[200:203], v249 offset:33792
    v_mfma_f32_16x16x32_bf16 v[68:71], v[204:207], v[192:195], v[68:71]
    ds_read_b128 v[204:207], v249 offset:33856
    v_mfma_f32_16x16x32_bf16 v[72:75], v[208:211], v[192:195], v[72:75]
    ds_read_b128 v[208:211], v249 offset:33920
    v_mfma_f32_16x16x32_bf16 v[76:79], v[212:215], v[192:195], v[76:79]
    ds_read_b128 v[212:215], v249 offset:33984
    v_mfma_f32_16x16x32_bf16 v[80:83], v[216:219], v[192:195], v[80:83]
    ds_read_b128 v[216:219], v249 offset:38144
    v_mfma_f32_16x16x32_bf16 v[84:87], v[220:223], v[192:195], v[84:87]
    ds_read_b128 v[220:223], v249 offset:38208
    v_mfma_f32_16x16x32_bf16 v[88:91], v[224:227], v[192:195], v[88:91]
    ds_read_b128 v[224:227], v249 offset:38272
    v_mfma_f32_16x16x32_bf16 v[92:95], v[228:231], v[192:195], v[92:95]
    ds_read_b128 v[228:231], v249 offset:38336
    s_branch k1_ste_q1
k1_sth_q1:
    s_waitcnt lgkmcnt(7)
    v_mfma_f32_16x16x32_bf16 v[176:179], v[200:203], v[128:131], v[232:235]
    s_waitcnt lgkmcnt(6)
    v_mfma_f32_16x16x32_bf16 v[176:179], v[204:207], v[132:135], v[176:179]
    s_waitcnt lgkmcnt(5)
    v_mfma_f32_16x16x32_bf16 v[176:179], v[208:211], v[136:139], v[176:179]
    s_waitcnt lgkmcnt(4)
    v_mfma_f32_16x16x32_bf16 v[176:179], v[212:215], v[140:143], v[176:179]
    s_waitcnt lgkmcnt(3)
    v_mfma_f32_16x16x32_bf16 v[180:183], v[216:219], v[128:131], v[232:235]
    s_waitcnt lgkmcnt(2)
    v_mfma_f32_16x16x32_bf16 v[180:183], v[220:223], v[132:135], v[180:183]
    s_waitcnt lgkmcnt(1)
    v_mfma_f32_16x16x32_bf16 v[180:183], v[224:227], v[136:139], v[180:183]
    s_waitcnt lgkmcnt(0)
    v_mfma_f32_16x16x32_bf16 v[180:183], v[228:231], v[140:143], v[180:183]
    v_mfma_f32_16x16x32_bf16 v[184:187], v[200:203], v[144:147], v[236:239]
    v_mfma_f32_16x16x32_bf16 v[184:187], v[204:207], v[148:151], v[184:187]
    v_mfma_f32_16x16x32_bf16 v[184:187], v[208:211], v[152:155], v[184:187]
    v_max3_f32 v253, v176, v177, v178
    s_nop 3
    v_max3_f32 v253, v253, v179, v180
    v_max3_f32 v253, v253, v181, v182
    v_mfma_f32_16x16x32_bf16 v[184:187], v[212:215], v[156:159], v[184:187]
    v_max_f32 v253, v253, v183
    v_cmp_lt_f32 vcc, s31, v253
    v_mfma_f32_16x16x32_bf16 v[188:191], v[216:219], v[144:147], v[236:239]
    s_nop 0
    s_cbranch_vccnz k1_rare_q1b_0
k1_ok_q1b_0:
    v_mfma_f32_16x16x32_bf16 v[188:191], v[220:223], v[148:151], v[188:191]
    v_exp_f32 v176, v176
    v_exp_f32 v177, v177
    v_mfma_f32_16x16x32_bf16 v[188:191], v[224:227], v[152:155], v[188:191]
    v_exp_f32 v178, v178
    v_exp_f32 v179, v179
    v_exp_f32 v180, v180
    v_mfma_f32_16x16x32_bf16 v[188:191], v[228:231], v[156:159], v[188:191]
    v_exp_f32 v181, v181
    v_exp_f32 v182, v182
    v_mfma_f32_16x16x32_bf16 v[192:195], v[200:203], v[160:163], v[240:243]
    ds_read_b64_tr_b16 v[200:201], v250 offset:16896
    ds_read_b64_tr_b16 v[202:203], v250 offset:20992
    v_exp_f32 v183, v183
    v_add_f32 v245, v245, v176
    v_mfma_f32_16x16x32_bf16 v[192:195], v[204:207], v[164:167], v[192:195]
    v_xor_b32 v254, 32, v250
    ds_read_b64_tr_b16 v[204:205], v254 offset:16896
    ds_read_b64_tr_b16 v[206:207], v254 offset:20992
    v_add_f32 v245, v245, v177
    v_add_f32 v245, v245, v178
    v_mfma_f32_16x16x32_bf16 v[192:195], v[208:211], v[168:171], v[192:195]
    v_xor_b32 v255, 64, v250
    ds_read_b64_tr_b16 v[208:209], v255 offset:16896
    ds_read_b64_tr_b16 v[210:211], v255 offset:20992
    v_add_f32 v245, v245, v179
    v_add_f32 v245, v245, v180
    v_add_f32 v245, v245, v181
    v_mfma_f32_16x16x32_bf16 v[192:195], v[212:215], v[172:175], v[192:195]
    v_xor_b32 v254, 96, v250
    ds_read_b64_tr_b16 v[212:213], v254 offset:16896
    ds_read_b64_tr_b16 v[214:215], v254 offset:20992
    v_add_f32 v245, v245, v182
    v_add_f32 v245, v245, v183
    v_max3_f32 v253, v184, v185, v186
    v_max3_f32 v253, v253, v187, v188
    v_max3_f32 v253, v253, v189, v190
    v_mfma_f32_16x16x32_bf16 v[196:199], v[216:219], v[160:163], v[240:243]
    v_xor_b32 v255, 128, v250
    ds_read_b64_tr_b16 v[216:217], v255 offset:16896
    ds_read_b64_tr_b16 v[218:219], v255 offset:20992
    v_cvt_pk_bf16_f32 v176, v176, v177
    v_cvt_pk_bf16_f32 v177, v178, v179
    v_max_f32 v253, v253, v191
    v_cmp_lt_f32 vcc, s31, v253
    v_mfma_f32_16x16x32_bf16 v[196:199], v[220:223], v[164:167], v[196:199]
    v_xor_b32 v254, 160, v250
    ds_read_b64_tr_b16 v[220:221], v254 offset:16896
    ds_read_b64_tr_b16 v[222:223], v254 offset:20992
    v_cvt_pk_bf16_f32 v178, v180, v181
    v_cvt_pk_bf16_f32 v179, v182, v183
    s_cbranch_vccnz k1_rare_q1b_1
k1_ok_q1b_1:
    v_mfma_f32_16x16x32_bf16 v[196:199], v[224:227], v[168:171], v[196:199]
    v_xor_b32 v255, 192, v250
    ds_read_b64_tr_b16 v[224:225], v255 offset:16896
    ds_read_b64_tr_b16 v[226:227], v255 offset:20992
    v_exp_f32 v184, v184
    v_exp_f32 v185, v185
    v_mfma_f32_16x16x32_bf16 v[196:199], v[228:231], v[172:175], v[196:199]
    v_xor_b32 v254, 224, v250
    ds_read_b64_tr_b16 v[228:229], v254 offset:16896
    ds_read_b64_tr_b16 v[230:231], v254 offset:20992
    v_exp_f32 v186, v186
    v_exp_f32 v187, v187
    v_exp_f32 v188, v188
    s_waitcnt lgkmcnt(14)
    v_mfma_f32_16x16x32_bf16 v[0:3], v[200:203], v[176:179], v[0:3]
    v_exp_f32 v189, v189
    v_exp_f32 v190, v190
    s_waitcnt lgkmcnt(12)
    v_mfma_f32_16x16x32_bf16 v[4:7], v[204:207], v[176:179], v[4:7]
    v_exp_f32 v191, v191
    v_add_f32 v246, v246, v184
    s_waitcnt lgkmcnt(10)
    v_mfma_f32_16x16x32_bf16 v[8:11], v[208:211], v[176:179], v[8:11]
    v_add_f32 v246, v246, v185
    v_add_f32 v246, v246, v186
    s_waitcnt lgkmcnt(8)
    v_mfma_f32_16x16x32_bf16 v[12:15], v[212:215], v[176:179], v[12:15]
    v_add_f32 v246, v246, v187
    v_add_f32 v246, v246, v188
    v_add_f32 v246, v246, v189
    v_max3_f32 v253, v192, v193, v194
    v_max3_f32 v253, v253, v195, v196
    v_max3_f32 v253, v253, v197, v198
    s_waitcnt lgkmcnt(6)
    v_mfma_f32_16x16x32_bf16 v[16:19], v[216:219], v[176:179], v[16:19]
    v_add_f32 v246, v246, v190
    v_add_f32 v246, v246, v191
    v_max_f32 v253, v253, v199
    v_cmp_lt_f32 vcc, s31, v253
    s_waitcnt lgkmcnt(4)
    v_mfma_f32_16x16x32_bf16 v[20:23], v[220:223], v[176:179], v[20:23]
    v_cvt_pk_bf16_f32 v184, v184, v185
    v_cvt_pk_bf16_f32 v185, v186, v187
    s_cbranch_vccnz k1_rare_q1b_2
k1_ok_q1b_2:
    s_waitcnt lgkmcnt(2)
    v_mfma_f32_16x16x32_bf16 v[24:27], v[224:227], v[176:179], v[24:27]
    v_cvt_pk_bf16_f32 v186, v188, v189
    v_cvt_pk_bf16_f32 v187, v190, v191
    v_exp_f32 v192, v192
    v_exp_f32 v193, v193
    s_waitcnt lgkmcnt(0)
    v_mfma_f32_16x16x32_bf16 v[28:31], v[228:231], v[176:179], v[28:31]
    v_exp_f32 v194, v194
    v_exp_f32 v195, v195
    v_exp_f32 v196, v196
    v_mfma_f32_16x16x32_bf16 v[32:35], v[200:203], v[184:187], v[32:35]
    v_exp_f32 v197, v197
    v_exp_f32 v198, v198
    v_mfma_f32_16x16x32_bf16 v[36:39], v[204:207], v[184:187], v[36:39]
    v_exp_f32 v199, v199
    v_add_f32 v247, v247, v192
    v_mfma_f32_16x16x32_bf16 v[40:43], v[208:211], v[184:187], v[40:43]
    v_add_f32 v247, v247, v193
    v_add_f32 v247, v247, v194
    v_mfma_f32_16x16x32_bf16 v[44:47], v[212:215], v[184:187], v[44:47]
    v_add_f32 v247, v247, v195
    v_add_f32 v247, v247, v196
    v_add_f32 v247, v247, v197
    v_mfma_f32_16x16x32_bf16 v[48:51], v[216:219], v[184:187], v[48:51]
    v_add_f32 v247, v247, v198
    v_add_f32 v247, v247, v199
    v_mfma_f32_16x16x32_bf16 v[52:55], v[220:223], v[184:187], v[52:55]
    v_cvt_pk_bf16_f32 v192, v192, v193
    v_cvt_pk_bf16_f32 v193, v194, v195
    v_mfma_f32_16x16x32_bf16 v[56:59], v[224:227], v[184:187], v[56:59]
    v_cvt_pk_bf16_f32 v194, v196, v197
    v_cvt_pk_bf16_f32 v195, v198, v199
    v_mfma_f32_16x16x32_bf16 v[60:63], v[228:231], v[184:187], v[60:63]
    s_nop 0
    v_mfma_f32_16x16x32_bf16 v[64:67], v[200:203], v[192:195], v[64:67]
    ds_read_b128 v[200:203], v249 offset:16896
    v_mfma_f32_16x16x32_bf16 v[68:71], v[204:207], v[192:195], v[68:71]
    ds_read_b128 v[204:207], v249 offset:16960
    v_mfma_f32_16x16x32_bf16 v[72:75], v[208:211], v[192:195], v[72:75]
    ds_read_b128 v[208:211], v249 offset:17024
    v_mfma_f32_16x16x32_bf16 v[76:79], v[212:215], v[192:195], v[76:79]
    ds_read_b128 v[212:215], v249 offset:17088
    v_mfma_f32_16x16x32_bf16 v[80:83], v[216:219], v[192:195], v[80:83]
    ds_read_b128 v[216:219], v249 offset:21248
    v_mfma_f32_16x16x32_bf16 v[84:87], v[220:223], v[192:195], v[84:87]
    ds_read_b128 v[220:223], v249 offset:21312
    v_mfma_f32_16x16x32_bf16 v[88:91], v[224:227], v[192:195], v[88:91]
    ds_read_b128 v[224:227], v249 offset:21376
    v_mfma_f32_16x16x32_bf16 v[92:95], v[228:231], v[192:195], v[92:95]
    ds_read_b128 v[228:231], v249 offset:21440
    v_mbcnt_lo_u32_b32 v255, -1, 0
    v_mbcnt_hi_u32_b32 v255, -1, v255
    v_lshl_add_u32 v255, v255, 4, s55
    ds_read_b128 v[184:187], v255
    ds_read_b128 v[188:191], v255 offset:1024
    ds_read_b128 v[192:195], v255 offset:2048
    ds_read_b128 v[196:199], v255 offset:3072
    v_mov_b32 v176, v244
    v_mov_b32 v177, v244
    v_mov_b32 v178, v244
    v_mov_b32 v179, v244
    v_mov_b32 v180, v244
    v_mov_b32 v181, v244
    v_mov_b32 v182, v244
    v_mov_b32 v183, v244
    s_waitcnt lgkmcnt(0)
    v_mfma_f32_16x16x32_bf16 v[176:179], v[200:203], v[184:187], v[176:179]
    ds_read_b64_tr_b16 v[200:201], v250 offset:16896
    ds_read_b64_tr_b16 v[202:203], v250 offset:20992
    v_mfma_f32_16x16x32_bf16 v[176:179], v[204:207], v[188:191], v[176:179]
    v_xor_b32 v254, 32, v250
    ds_read_b64_tr_b16 v[204:205], v254 offset:16896
    ds_read_b64_tr_b16 v[206:207], v254 offset:20992
    v_mfma_f32_16x16x32_bf16 v[176:179], v[208:211], v[192:195], v[176:179]
    v_xor_b32 v255, 64, v250
    ds_read_b64_tr_b16 v[208:209], v255 offset:16896
    ds_read_b64_tr_b16 v[210:211], v255 offset:20992
    v_mfma_f32_16x16x32_bf16 v[176:179], v[212:215], v[196:199], v[176:179]
    v_xor_b32 v254, 96, v250
    ds_read_b64_tr_b16 v[212:213], v254 offset:16896
    ds_read_b64_tr_b16 v[214:215], v254 offset:20992
    v_mfma_f32_16x16x32_bf16 v[180:183], v[216:219], v[184:187], v[180:183]
    v_xor_b32 v255, 128, v250
    ds_read_b64_tr_b16 v[216:217], v255 offset:16896
    ds_read_b64_tr_b16 v[218:219], v255 offset:20992
    v_mfma_f32_16x16x32_bf16 v[180:183], v[220:223], v[188:191], v[180:183]
    v_xor_b32 v254, 160, v250
    ds_read_b64_tr_b16 v[220:221], v254 offset:16896
    ds_read_b64_tr_b16 v[222:223], v254 offset:20992
    v_mfma_f32_16x16x32_bf16 v[180:183], v[224:227], v[192:195], v[180:183]
    v_xor_b32 v255, 192, v250
    ds_read_b64_tr_b16 v[224:225], v255 offset:16896
    ds_read_b64_tr_b16 v[226:227], v255 offset:20992
    v_mfma_f32_16x16x32_bf16 v[180:183], v[228:231], v[196:199], v[180:183]
    v_xor_b32 v254, 224, v250
    ds_read_b64_tr_b16 v[228:229], v254 offset:16896
    ds_read_b64_tr_b16 v[230:231], v254 offset:20992
    v_max3_f32 v253, v176, v177, v178
    s_nop 3
    v_max3_f32 v253, v253, v179, v180
    v_max3_f32 v253, v253, v181, v182
    v_max_f32 v253, v253, v183
    v_cmp_lt_f32 vcc, s53, v253
    s_nop 1
    s_cbranch_vccnz k1_rare_q1b_L
k1_ok_q1b_L:
    v_exp_f32 v176, v176
    v_exp_f32 v177, v177
    v_exp_f32 v178, v178
    v_exp_f32 v179, v179
    v_exp_f32 v180, v180
    v_exp_f32 v181, v181
    v_exp_f32 v182, v182
    v_exp_f32 v183, v183
    v_add_f32 v248, v248, v176
    v_add_f32 v248, v248, v177
    v_add_f32 v248, v248, v178
    v_add_f32 v248, v248, v179
    v_add_f32 v248, v248, v180
    v_add_f32 v248, v248, v181
    v_add_f32 v248, v248, v182
    v_add_f32 v248, v248, v183
    v_cvt_pk_bf16_f32 v176, v176, v177
    v_cvt_pk_bf16_f32 v177, v178, v179
    v_cvt_pk_bf16_f32 v178, v180, v181
    v_cvt_pk_bf16_f32 v179, v182, v183
    s_mov_b32 s53, 0x41800000
    s_mov_b32 s54, 0
    s_waitcnt lgkmcnt(0)
    s_waitcnt vmcnt(0)
    s_barrier
    v_mfma_f32_16x16x32_bf16 v[96:99], v[200:203], v[176:179], v[96:99]
    ds_read_b128 v[200:203], v249 offset:33792
    v_mfma_f32_16x16x32_bf16 v[100:103], v[204:207], v[176:179], v[100:103]
    ds_read_b128 v[204:207], v249 offset:33856
    v_mfma_f32_16x16x32_bf16 v[104:107], v[208:211], v[176:179], v[104:107]
    ds_read_b128 v[208:211], v249 offset:33920
    v_mfma_f32_16x16x32_bf16 v[108:111], v[212:215], v[176:179], v[108:111]
    ds_read_b128 v[212:215], v249 offset:33984
    v_mfma_f32_16x16x32_bf16 v[112:115], v[216:219], v[176:179], v[112:115]
    ds_read_b128 v[216:219], v249 offset:38144
    v_mfma_f32_16x16x32_bf16 v[116:119], v[220:223], v[176:179], v[116:119]
    ds_read_b128 v[220:223], v249 offset:38208
    v_mfma_f32_16x16x32_bf16 v[120:123], v[224:227], v[176:179], v[120:123]
    ds_read_b128 v[224:227], v249 offset:38272
    v_mfma_f32_16x16x32_bf16 v[124:127], v[228:231], v[176:179], v[124:127]
    ds_read_b128 v[228:231], v249 offset:38336
k1_ste_q1:
    s_cmp_eq_u32 s52, 2
    s_cbranch_scc1 k1_sth_q2
    s_waitcnt lgkmcnt(7)
    v_mfma_f32_16x16x32_bf16 v[176:179], v[200:203], v[128:131], v[232:235]
    s_add_u32 m0, s43, 0
    s_nop 0
    buffer_load_dwordx4 v251, s[8:11], s33 offen nt lds
    s_waitcnt lgkmcnt(6)
    v_mfma_f32_16x16x32_bf16 v[176:179], v[204:207], v[132:135], v[176:179]
    s_waitcnt lgkmcnt(5)
    v_mfma_f32_16x16x32_bf16 v[176:179], v[208:211], v[136:139], v[176:179]
    s_add_u32 m0, s43, 4352
    s_add_u32 s37, s33, 4096
    buffer_load_dwordx4 v251, s[8:11], s37 offen nt lds
    s_waitcnt lgkmcnt(4)
    v_mfma_f32_16x16x32_bf16 v[176:179], v[212:215], v[140:143], v[176:179]
    s_waitcnt lgkmcnt(3)
    v_mfma_f32_16x16x32_bf16 v[180:183], v[216:219], v[128:131], v[232:235]
    s_add_u32 m0, s44, 0
    s_nop 0
    buffer_load_dwordx4 v252, s[12:15], s33 offen nt lds
    s_waitcnt lgkmcnt(2)
    v_mfma_f32_16x16x32_bf16 v[180:183], v[220:223], v[132:135], v[180:183]
    s_waitcnt lgkmcnt(1)
    v_mfma_f32_16x16x32_bf16 v[180:183], v[224:227], v[136:139], v[180:183]
    s_add_u32 m0, s44, 4096
    s_add_u32 s37, s33, 4096
    buffer_load_dwordx4 v252, s[12:15], s37 offen nt lds
    s_add_u32 s33, s33, 8192
    s_waitcnt lgkmcnt(0)
    v_mfma_f32_16x16x32_bf16 v[180:183], v[228:231], v[140:143], v[180:183]
    v_mfma_f32_16x16x32_bf16 v[184:187], v[200:203], v[144:147], v[236:239]
    s_add_u32 m0, s43, 16896
    s_nop 0
    buffer_load_dwordx4 v251, s[8:11], s33 offen nt lds
    v_mfma_f32_16x16x32_bf16 v[184:187], v[204:207], v[148:151], v[184:187]
    v_mfma_f32_16x16x32_bf16 v[184:187], v[208:211], v[152:155], v[184:187]
    s_add_u32 m0, s43, 21248
    s_add_u32 s37, s33, 4096
    buffer_load_dwordx4 v251, s[8:11], s37 offen nt lds
    v_max3_f32 v253, v176, v177, v178
    v_max3_f32 v253, v253, v179, v180
    v_max3_f32 v253, v253, v181, v182
    v_mfma_f32_16x16x32_bf16 v[184:187], v[212:215], v[156:159], v[184:187]
    v_max_f32 v253, v253, v183
    v_cmp_lt_f32 vcc, s31, v253
    v_mfma_f32_16x16x32_bf16 v[188:191], v[216:219], v[144:147], v[236:239]
    s_add_u32 m0, s44, 16896
    s_nop 0
    buffer_load_dwordx4 v252, s[12:15], s33 offen nt lds
    s_cbranch_vccnz k1_rare_q2a_0
k1_ok_q2a_0:
    v_mfma_f32_16x16x32_bf16 v[188:191], v[220:223], v[148:151], v[188:191]
    v_exp_f32 v176, v176
    v_exp_f32 v177, v177
    v_mfma_f32_16x16x32_bf16 v[188:191], v[224:227], v[152:155], v[188:191]
    s_add_u32 m0, s44, 20992
    s_add_u32 s37, s33, 4096
    buffer_load_dwordx4 v252, s[12:15], s37 offen nt lds
    s_add_u32 s33, s33, 8192
    v_exp_f32 v178, v178
    v_exp_f32 v179, v179
    v_exp_f32 v180, v180
    v_mfma_f32_16x16x32_bf16 v[188:191], v[228:231], v[156:159], v[188:191]
    v_exp_f32 v181, v181
    v_exp_f32 v182, v182
    v_mfma_f32_16x16x32_bf16 v[192:195], v[200:203], v[160:163], v[240:243]
    ds_read_b64_tr_b16 v[200:201], v250 offset:33792
    ds_read_b64_tr_b16 v[202:203], v250 offset:37888
    v_exp_f32 v183, v183
    v_add_f32 v245, v245, v176
    v_mfma_f32_16x16x32_bf16 v[192:195], v[204:207], v[164:167], v[192:195]
    v_xor_b32 v254, 32, v250
    ds_read_b64_tr_b16 v[204:205], v254 offset:33792
    ds_read_b64_tr_b16 v[206:207], v254 offset:37888
    v_add_f32 v245, v245, v177
    v_add_f32 v245, v245, v178
    v_mfma_f32_16x16x32_bf16 v[192:195], v[208:211], v[168:171], v[192:195]
    v_xor_b32 v255, 64, v250
    ds_read_b64_tr_b16 v[208:209], v255 offset:33792
    ds_read_b64_tr_b16 v[210:211], v255 offset:37888
    v_add_f32 v245, v245, v179
    v_add_f32 v245, v245, v180
    v_add_f32 v245, v245, v181
    v_mfma_f32_16x16x32_bf16 v[192:195], v[212:215], v[172:175], v[192:195]
    v_xor_b32 v254, 96, v250
    ds_read_b64_tr_b16 v[212:213], v254 offset:33792
    ds_read_b64_tr_b16 v[214:215], v254 offset:37888
    v_add_f32 v245, v245, v182
    v_add_f32 v245, v245, v183
    v_max3_f32 v253, v184, v185, v186
    v_max3_f32 v253, v253, v187, v188
    v_max3_f32 v253, v253, v189, v190
    v_mfma_f32_16x16x32_bf16 v[196:199], v[216:219], v[160:163], v[240:243]
    v_xor_b32 v255, 128, v250
    ds_read_b64_tr_b16 v[216:217], v255 offset:33792
    ds_read_b64_tr_b16 v[218:219], v255 offset:37888
    v_cvt_pk_bf16_f32 v176, v176, v177
    v_cvt_pk_bf16_f32 v177, v178, v179
    v_max_f32 v253, v253, v191
    v_cmp_lt_f32 vcc, s31, v253
    v_mfma_f32_16x16x32_bf16 v[196:199], v[220:223], v[164:167], v[196:199]
    v_xor_b32 v254, 160, v250
    ds_read_b64_tr_b16 v[220:221], v254 offset:33792
    ds_read_b64_tr_b16 v[222:223], v254 offset:37888
    v_cvt_pk_bf16_f32 v178, v180, v181
    v_cvt_pk_bf16_f32 v179, v182, v183
    s_cbranch_vccnz k1_rare_q2a_1
k1_ok_q2a_1:
    v_mfma_f32_16x16x32_bf16 v[196:199], v[224:227], v[168:171], v[196:199]
    v_xor_b32 v255, 192, v250
    ds_read_b64_tr_b16 v[224:225], v255 offset:33792
    ds_read_b64_tr_b16 v[226:227], v255 offset:37888
    v_exp_f32 v184, v184
    v_exp_f32 v185, v185
    v_mfma_f32_16x16x32_bf16 v[196:199], v[228:231], v[172:175], v[196:199]
    v_xor_b32 v254, 224, v250
    ds_read_b64_tr_b16 v[228:229], v254 offset:33792
    ds_read_b64_tr_b16 v[230:231], v254 offset:37888
    v_exp_f32 v186, v186
    v_exp_f32 v187, v187
    v_exp_f32 v188, v188
    s_waitcnt lgkmcnt(14)
    v_mfma_f32_16x16x32_bf16 v[0:3], v[200:203], v[176:179], v[0:3]
    v_exp_f32 v189, v189
    v_exp_f32 v190, v190
    s_waitcnt lgkmcnt(12)
    v_mfma_f32_16x16x32_bf16 v[4:7], v[204:207], v[176:179], v[4:7]
    v_exp_f32 v191, v191
    v_add_f32 v246, v246, v184
    s_waitcnt lgkmcnt(10)
    v_mfma_f32_16x16x32_bf16 v[8:11], v[208:211], v[176:179], v[8:11]
    v_add_f32 v246, v246, v185
    v_add_f32 v246, v246, v186
    s_waitcnt lgkmcnt(8)
    v_mfma_f32_16x16x32_bf16 v[12:15], v[212:215], v[176:179], v[12:15]
    v_add_f32 v246, v246, v187
    v_add_f32 v246, v246, v188
    v_add_f32 v246, v246, v189
    v_max3_f32 v253, v192, v193, v194
    v_max3_f32 v253, v253, v195, v196
    v_max3_f32 v253, v253, v197, v198
    s_waitcnt lgkmcnt(6)
    v_mfma_f32_16x16x32_bf16 v[16:19], v[216:219], v[176:179], v[16:19]
    v_add_f32 v246, v246, v190
    v_add_f32 v246, v246, v191
    v_max_f32 v253, v253, v199
    v_cmp_lt_f32 vcc, s31, v253
    s_waitcnt lgkmcnt(4)
    v_mfma_f32_16x16x32_bf16 v[20:23], v[220:223], v[176:179], v[20:23]
    v_cvt_pk_bf16_f32 v184, v184, v185
    v_cvt_pk_bf16_f32 v185, v186, v187
    s_cbranch_vccnz k1_rare_q2a_2
k1_ok_q2a_2:
    s_waitcnt lgkmcnt(2)
    v_mfma_f32_16x16x32_bf16 v[24:27], v[224:227], v[176:179], v[24:27]
    v_cvt_pk_bf16_f32 v186, v188, v189
    v_cvt_pk_bf16_f32 v187, v190, v191
    v_exp_f32 v192, v192
    v_exp_f32 v193, v193
    s_waitcnt lgkmcnt(0)
    v_mfma_f32_16x16x32_bf16 v[28:31], v[228:231], v[176:179], v[28:31]
    v_exp_f32 v194, v194
    v_exp_f32 v195, v195
    v_exp_f32 v196, v196
    v_mfma_f32_16x16x32_bf16 v[32:35], v[200:203], v[184:187], v[32:35]
    v_exp_f32 v197, v197
    v_exp_f32 v198, v198
    v_mfma_f32_16x16x32_bf16 v[36:39], v[204:207], v[184:187], v[36:39]
    v_exp_f32 v199, v199
    v_add_f32 v247, v247, v192
    v_mfma_f32_16x16x32_bf16 v[40:43], v[208:211], v[184:187], v[40:43]
    v_add_f32 v247, v247, v193
    v_add_f32 v247, v247, v194
    v_mfma_f32_16x16x32_bf16 v[44:47], v[212:215], v[184:187], v[44:47]
    v_add_f32 v247, v247, v195
    v_add_f32 v247, v247, v196
    v_add_f32 v247, v247, v197
    v_mfma_f32_16x16x32_bf16 v[48:51], v[216:219], v[184:187], v[48:51]
    v_add_f32 v247, v247, v198
    v_add_f32 v247, v247, v199
    v_mfma_f32_16x16x32_bf16 v[52:55], v[220:223], v[184:187], v[52:55]
    v_cvt_pk_bf16_f32 v192, v192, v193
    v_cvt_pk_bf16_f32 v193, v194, v195
    v_mfma_f32_16x16x32_bf16 v[56:59], v[224:227], v[184:187], v[56:59]
    v_cvt_pk_bf16_f32 v194, v196, v197
    v_cvt_pk_bf16_f32 v195, v198, v199
    v_mfma_f32_16x16x32_bf16 v[60:63], v[228:231], v[184:187], v[60:63]
    s_nop 0
    v_mfma_f32_16x16x32_bf16 v[64:67], v[200:203], v[192:195], v[64:67]
    ds_read_b128 v[200:203], v249 offset:50688
    v_mfma_f32_16x16x32_bf16 v[68:71], v[204:207], v[192:195], v[68:71]
    ds_read_b128 v[204:207], v249 offset:50752
    v_mfma_f32_16x16x32_bf16 v[72:75], v[208:211], v[192:195], v[72:75]
    ds_read_b128 v[208:211], v249 offset:50816
    v_mfma_f32_16x16x32_bf16 v[76:79], v[212:215], v[192:195], v[76:79]
    ds_read_b128 v[212:215], v249 offset:50880
    v_mfma_f32_16x16x32_bf16 v[80:83], v[216:219], v[192:195], v[80:83]
    ds_read_b128 v[216:219], v249 offset:55040
    v_mfma_f32_16x16x32_bf16 v[84:87], v[220:223], v[192:195], v[84:87]
    ds_read_b128 v[220:223], v249 offset:55104
    v_mfma_f32_16x16x32_bf16 v[88:91], v[224:227], v[192:195], v[88:91]
    ds_read_b128 v[224:227], v249 offset:55168
    v_mfma_f32_16x16x32_bf16 v[92:95], v[228:231], v[192:195], v[92:95]
    ds_read_b128 v[228:231], v249 offset:55232
    s_branch k1_ste_q2
k1_sth_q2:
    s_waitcnt lgkmcnt(7)
    v_mfma_f32_16x16x32_bf16 v[176:179], v[200:203], v[128:131], v[232:235]
    s_add_u32 m0, s43, 0
    s_nop 0
    buffer_load_dwordx4 v251, s[8:11], s33 offen nt lds
    s_waitcnt lgkmcnt(6)
    v_mfma_f32_16x16x32_bf16 v[176:179], v[204:207], v[132:135], v[176:179]
    s_waitcnt lgkmcnt(5)
    v_mfma_f32_16x16x32_bf16 v[176:179], v[208:211], v[136:139], v[176:179]
    s_add_u32 m0, s43, 4352
    s_add_u32 s37, s33, 4096
    buffer_load_dwordx4 v251, s[8:11], s37 offen nt lds
    s_waitcnt lgkmcnt(4)
    v_mfma_f32_16x16x32_bf16 v[176:179], v[212:215], v[140:143], v[176:179]
    s_waitcnt lgkmcnt(3)
    v_mfma_f32_16x16x32_bf16 v[180:183], v[216:219], v[128:131], v[232:235]
    s_add_u32 m0, s44, 0
    s_nop 0
    buffer_load_dwordx4 v252, s[12:15], s33 offen nt lds
    s_waitcnt lgkmcnt(2)
    v_mfma_f32_16x16x32_bf16 v[180:183], v[220:223], v[132:135], v[180:183]
    s_waitcnt lgkmcnt(1)
    v_mfma_f32_16x16x32_bf16 v[180:183], v[224:227], v[136:139], v[180:183]
    s_add_u32 m0, s44, 4096
    s_add_u32 s37, s33, 4096
    buffer_load_dwordx4 v252, s[12:15], s37 offen nt lds
    s_add_u32 s33, s33, 8192
    s_waitcnt lgkmcnt(0)
    v_mfma_f32_16x16x32_bf16 v[180:183], v[228:231], v[140:143], v[180:183]
    v_mfma_f32_16x16x32_bf16 v[184:187], v[200:203], v[144:147], v[236:239]
    s_add_u32 m0, s43, 16896
    s_nop 0
    buffer_load_dwordx4 v251, s[8:11], s33 offen nt lds
    v_mfma_f32_16x16x32_bf16 v[184:187], v[204:207], v[148:151], v[184:187]
    v_mfma_f32_16x16x32_bf16 v[184:187], v[208:211], v[152:155], v[184:187]
    s_add_u32 m0, s43, 21248
    s_add_u32 s37, s33, 4096
    buffer_load_dwordx4 v251, s[8:11], s37 offen nt lds
    v_max3_f32 v253, v176, v177, v178
    v_max3_f32 v253, v253, v179, v180
    v_max3_f32 v253, v253, v181, v182
    v_mfma_f32_16x16x32_bf16 v[184:187], v[212:215], v[156:159], v[184:187]
    v_max_f32 v253, v253, v183
    v_cmp_lt_f32 vcc, s31, v253
    v_mfma_f32_16x16x32_bf16 v[188:191], v[216:219], v[144:147], v[236:239]
    s_add_u32 m0, s44, 16896
    s_nop 0
    buffer_load_dwordx4 v252, s[12:15], s33 offen nt lds
    s_cbranch_vccnz k1_rare_q2b_0
k1_ok_q2b_0:
    v_mfma_f32_16x16x32_bf16 v[188:191], v[220:223], v[148:151], v[188:191]
    v_exp_f32 v176, v176
    v_exp_f32 v177, v177
    v_mfma_f32_16x16x32_bf16 v[188:191], v[224:227], v[152:155], v[188:191]
    s_add_u32 m0, s44, 20992
    s_add_u32 s37, s33, 4096
    buffer_load_dwordx4 v252, s[12:15], s37 offen nt lds
    s_add_u32 s33, s33, 8192
    v_exp_f32 v178, v178
    v_exp_f32 v179, v179
    v_exp_f32 v180, v180
    v_mfma_f32_16x16x32_bf16 v[188:191], v[228:231], v[156:159], v[188:191]
    v_exp_f32 v181, v181
    v_exp_f32 v182, v182
    v_mfma_f32_16x16x32_bf16 v[192:195], v[200:203], v[160:163], v[240:243]
    ds_read_b64_tr_b16 v[200:201], v250 offset:33792
    ds_read_b64_tr_b16 v[202:203], v250 offset:37888
    v_exp_f32 v183, v183
    v_add_f32 v245, v245, v176
    v_mfma_f32_16x16x32_bf16 v[192:195], v[204:207], v[164:167], v[192:195]
    v_xor_b32 v254, 32, v250
    ds_read_b64_tr_b16 v[204:205], v254 offset:33792
    ds_read_b64_tr_b16 v[206:207], v254 offset:37888
    v_add_f32 v245, v245, v177
    v_add_f32 v245, v245, v178
    v_mfma_f32_16x16x32_bf16 v[192:195], v[208:211], v[168:171], v[192:195]
    v_xor_b32 v255, 64, v250
    ds_read_b64_tr_b16 v[208:209], v255 offset:33792
    ds_read_b64_tr_b16 v[210:211], v255 offset:37888
    v_add_f32 v245, v245, v179
    v_add_f32 v245, v245, v180
    v_add_f32 v245, v245, v181
    v_mfma_f32_16x16x32_bf16 v[192:195], v[212:215], v[172:175], v[192:195]
    v_xor_b32 v254, 96, v250
    ds_read_b64_tr_b16 v[212:213], v254 offset:33792
    ds_read_b64_tr_b16 v[214:215], v254 offset:37888
    v_add_f32 v245, v245, v182
    v_add_f32 v245, v245, v183
    v_max3_f32 v253, v184, v185, v186
    v_max3_f32 v253, v253, v187, v188
    v_max3_f32 v253, v253, v189, v190
    v_mfma_f32_16x16x32_bf16 v[196:199], v[216:219], v[160:163], v[240:243]
    v_xor_b32 v255, 128, v250
    ds_read_b64_tr_b16 v[216:217], v255 offset:33792
    ds_read_b64_tr_b16 v[218:219], v255 offset:37888
    v_cvt_pk_bf16_f32 v176, v176, v177
    v_cvt_pk_bf16_f32 v177, v178, v179
    v_max_f32 v253, v253, v191
    v_cmp_lt_f32 vcc, s31, v253
    v_mfma_f32_16x16x32_bf16 v[196:199], v[220:223], v[164:167], v[196:199]
    v_xor_b32 v254, 160, v250
    ds_read_b64_tr_b16 v[220:221], v254 offset:33792
    ds_read_b64_tr_b16 v[222:223], v254 offset:37888
    v_cvt_pk_bf16_f32 v178, v180, v181
    v_cvt_pk_bf16_f32 v179, v182, v183
    s_cbranch_vccnz k1_rare_q2b_1
k1_ok_q2b_1:
    v_mfma_f32_16x16x32_bf16 v[196:199], v[224:227], v[168:171], v[196:199]
    v_xor_b32 v255, 192, v250
    ds_read_b64_tr_b16 v[224:225], v255 offset:33792
    ds_read_b64_tr_b16 v[226:227], v255 offset:37888
    v_exp_f32 v184, v184
    v_exp_f32 v185, v185
    v_mfma_f32_16x16x32_bf16 v[196:199], v[228:231], v[172:175], v[196:199]
    v_xor_b32 v254, 224, v250
    ds_read_b64_tr_b16 v[228:229], v254 offset:33792
    ds_read_b64_tr_b16 v[230:231], v254 offset:37888
    v_exp_f32 v186, v186
    v_exp_f32 v187, v187
    v_exp_f32 v188, v188
    s_waitcnt lgkmcnt(14)
    v_mfma_f32_16x16x32_bf16 v[0:3], v[200:203], v[176:179], v[0:3]
    v_exp_f32 v189, v189
    v_exp_f32 v190, v190
    s_waitcnt lgkmcnt(12)
    v_mfma_f32_16x16x32_bf16 v[4:7], v[204:207], v[176:179], v[4:7]
    v_exp_f32 v191, v191
    v_add_f32 v246, v246, v184
    s_waitcnt lgkmcnt(10)
    v_mfma_f32_16x16x32_bf16 v[8:11], v[208:211], v[176:179], v[8:11]
    v_add_f32 v246, v246, v185
    v_add_f32 v246, v246, v186
    s_waitcnt lgkmcnt(8)
    v_mfma_f32_16x16x32_bf16 v[12:15], v[212:215], v[176:179], v[12:15]
    v_add_f32 v246, v246, v187
    v_add_f32 v246, v246, v188
    v_add_f32 v246, v246, v189
    v_max3_f32 v253, v192, v193, v194
    v_max3_f32 v253, v253, v195, v196
    v_max3_f32 v253, v253, v197, v198
    s_waitcnt lgkmcnt(6)
    v_mfma_f32_16x16x32_bf16 v[16:19], v[216:219], v[176:179], v[16:19]
    v_add_f32 v246, v246, v190
    v_add_f32 v246, v246, v191
    v_max_f32 v253, v253, v199
    v_cmp_lt_f32 vcc, s31, v253
    s_waitcnt lgkmcnt(4)
    v_mfma_f32_16x16x32_bf16 v[20:23], v[220:223], v[176:179], v[20:23]
    v_cvt_pk_bf16_f32 v184, v184, v185
    v_cvt_pk_bf16_f32 v185, v186, v187
    s_cbranch_vccnz k1_rare_q2b_2
k1_ok_q2b_2:
    s_waitcnt lgkmcnt(2)
    v_mfma_f32_16x16x32_bf16 v[24:27], v[224:227], v[176:179], v[24:27]
    v_cvt_pk_bf16_f32 v186, v188, v189
    v_cvt_pk_bf16_f32 v187, v190, v191
    v_exp_f32 v192, v192
    v_exp_f32 v193, v193
    s_waitcnt lgkmcnt(0)
    v_mfma_f32_16x16x32_bf16 v[28:31], v[228:231], v[176:179], v[28:31]
    v_exp_f32 v194, v194
    v_exp_f32 v195, v195
    v_exp_f32 v196, v196
    v_mfma_f32_16x16x32_bf16 v[32:35], v[200:203], v[184:187], v[32:35]
    v_exp_f32 v197, v197
    v_exp_f32 v198, v198
    v_mfma_f32_16x16x32_bf16 v[36:39], v[204:207], v[184:187], v[36:39]
    v_exp_f32 v199, v199
    v_add_f32 v247, v247, v192
    v_mfma_f32_16x16x32_bf16 v[40:43], v[208:211], v[184:187], v[40:43]
    v_add_f32 v247, v247, v193
    v_add_f32 v247, v247, v194
    v_mfma_f32_16x16x32_bf16 v[44:47], v[212:215], v[184:187], v[44:47]
    v_add_f32 v247, v247, v195
    v_add_f32 v247, v247, v196
    v_add_f32 v247, v247, v197
    v_mfma_f32_16x16x32_bf16 v[48:51], v[216:219], v[184:187], v[48:51]
    v_add_f32 v247, v247, v198
    v_add_f32 v247, v247, v199
    v_mfma_f32_16x16x32_bf16 v[52:55], v[220:223], v[184:187], v[52:55]
    v_cvt_pk_bf16_f32 v192, v192, v193
    v_cvt_pk_bf16_f32 v193, v194, v195
    v_mfma_f32_16x16x32_bf16 v[56:59], v[224:227], v[184:187], v[56:59]
    v_cvt_pk_bf16_f32 v194, v196, v197
    v_cvt_pk_bf16_f32 v195, v198, v199
    v_mfma_f32_16x16x32_bf16 v[60:63], v[228:231], v[184:187], v[60:63]
    s_nop 0
    v_mfma_f32_16x16x32_bf16 v[64:67], v[200:203], v[192:195], v[64:67]
    ds_read_b128 v[200:203], v249 offset:33792
    v_mfma_f32_16x16x32_bf16 v[68:71], v[204:207], v[192:195], v[68:71]
    ds_read_b128 v[204:207], v249 offset:33856
    v_mfma_f32_16x16x32_bf16 v[72:75], v[208:211], v[192:195], v[72:75]
    ds_read_b128 v[208:211], v249 offset:33920
    v_mfma_f32_16x16x32_bf16 v[76:79], v[212:215], v[192:195], v[76:79]
    ds_read_b128 v[212:215], v249 offset:33984
    v_mfma_f32_16x16x32_bf16 v[80:83], v[216:219], v[192:195], v[80:83]
    ds_read_b128 v[216:219], v249 offset:38144
    v_mfma_f32_16x16x32_bf16 v[84:87], v[220:223], v[192:195], v[84:87]
    ds_read_b128 v[220:223], v249 offset:38208
    v_mfma_f32_16x16x32_bf16 v[88:91], v[224:227], v[192:195], v[88:91]
    ds_read_b128 v[224:227], v249 offset:38272
    v_mfma_f32_16x16x32_bf16 v[92:95], v[228:231], v[192:195], v[92:95]
    ds_read_b128 v[228:231], v249 offset:38336
    v_mbcnt_lo_u32_b32 v255, -1, 0
    v_mbcnt_hi_u32_b32 v255, -1, v255
    v_lshl_add_u32 v255, v255, 4, s55
    ds_read_b128 v[184:187], v255
    ds_read_b128 v[188:191], v255 offset:1024
    ds_read_b128 v[192:195], v255 offset:2048
    ds_read_b128 v[196:199], v255 offset:3072
    v_mov_b32 v176, v244
    v_mov_b32 v177, v244
    v_mov_b32 v178, v244
    v_mov_b32 v179, v244
    v_mov_b32 v180, v244
    v_mov_b32 v181, v244
    v_mov_b32 v182, v244
    v_mov_b32 v183, v244
    s_waitcnt lgkmcnt(0)
    v_mfma_f32_16x16x32_bf16 v[176:179], v[200:203], v[184:187], v[176:179]
    ds_read_b64_tr_b16 v[200:201], v250 offset:33792
    ds_read_b64_tr_b16 v[202:203], v250 offset:37888
    v_mfma_f32_16x16x32_bf16 v[176:179], v[204:207], v[188:191], v[176:179]
    v_xor_b32 v254, 32, v250
    ds_read_b64_tr_b16 v[204:205], v254 offset:33792
    ds_read_b64_tr_b16 v[206:207], v254 offset:37888
    v_mfma_f32_16x16x32_bf16 v[176:179], v[208:211], v[192:195], v[176:179]
    v_xor_b32 v255, 64, v250
    ds_read_b64_tr_b16 v[208:209], v255 offset:33792
    ds_read_b64_tr_b16 v[210:211], v255 offset:37888
    v_mfma_f32_16x16x32_bf16 v[176:179], v[212:215], v[196:199], v[176:179]
    v_xor_b32 v254, 96, v250
    ds_read_b64_tr_b16 v[212:213], v254 offset:33792
    ds_read_b64_tr_b16 v[214:215], v254 offset:37888
    v_mfma_f32_16x16x32_bf16 v[180:183], v[216:219], v[184:187], v[180:183]
    v_xor_b32 v255, 128, v250
    ds_read_b64_tr_b16 v[216:217], v255 offset:33792
    ds_read_b64_tr_b16 v[218:219], v255 offset:37888
    v_mfma_f32_16x16x32_bf16 v[180:183], v[220:223], v[188:191], v[180:183]
    v_xor_b32 v254, 160, v250
    ds_read_b64_tr_b16 v[220:221], v254 offset:33792
    ds_read_b64_tr_b16 v[222:223], v254 offset:37888
    v_mfma_f32_16x16x32_bf16 v[180:183], v[224:227], v[192:195], v[180:183]
    v_xor_b32 v255, 192, v250
    ds_read_b64_tr_b16 v[224:225], v255 offset:33792
    ds_read_b64_tr_b16 v[226:227], v255 offset:37888
    v_mfma_f32_16x16x32_bf16 v[180:183], v[228:231], v[196:199], v[180:183]
    v_xor_b32 v254, 224, v250
    ds_read_b64_tr_b16 v[228:229], v254 offset:33792
    ds_read_b64_tr_b16 v[230:231], v254 offset:37888
    v_max3_f32 v253, v176, v177, v178
    s_nop 3
    v_max3_f32 v253, v253, v179, v180
    v_max3_f32 v253, v253, v181, v182
    v_max_f32 v253, v253, v183
    v_cmp_lt_f32 vcc, s53, v253
    s_nop 1
    s_cbranch_vccnz k1_rare_q2b_L
k1_ok_q2b_L:
    v_exp_f32 v176, v176
    v_exp_f32 v177, v177
    v_exp_f32 v178, v178
    v_exp_f32 v179, v179
    v_exp_f32 v180, v180
    v_exp_f32 v181, v181
    v_exp_f32 v182, v182
    v_exp_f32 v183, v183
    v_add_f32 v248, v248, v176
    v_add_f32 v248, v248, v177
    v_add_f32 v248, v248, v178
    v_add_f32 v248, v248, v179
    v_add_f32 v248, v248, v180
    v_add_f32 v248, v248, v181
    v_add_f32 v248, v248, v182
    v_add_f32 v248, v248, v183
    v_cvt_pk_bf16_f32 v176, v176, v177
    v_cvt_pk_bf16_f32 v177, v178, v179
    v_cvt_pk_bf16_f32 v178, v180, v181
    v_cvt_pk_bf16_f32 v179, v182, v183
    s_mov_b32 s53, 0x41800000
    s_mov_b32 s54, 0
    s_waitcnt lgkmcnt(0)
    v_mfma_f32_16x16x32_bf16 v[96:99], v[200:203], v[176:179], v[96:99]
    ds_read_b128 v[200:203], v249 offset:50688
    v_mfma_f32_16x16x32_bf16 v[100:103], v[204:207], v[176:179], v[100:103]
    ds_read_b128 v[204:207], v249 offset:50752
    v_mfma_f32_16x16x32_bf16 v[104:107], v[208:211], v[176:179], v[104:107]
    ds_read_b128 v[208:211], v249 offset:50816
    v_mfma_f32_16x16x32_bf16 v[108:111], v[212:215], v[176:179], v[108:111]
    ds_read_b128 v[212:215], v249 offset:50880
    v_mfma_f32_16x16x32_bf16 v[112:115], v[216:219], v[176:179], v[112:115]
    ds_read_b128 v[216:219], v249 offset:55040
    v_mfma_f32_16x16x32_bf16 v[116:119], v[220:223], v[176:179], v[116:119]
    ds_read_b128 v[220:223], v249 offset:55104
    v_mfma_f32_16x16x32_bf16 v[120:123], v[224:227], v[176:179], v[120:123]
    ds_read_b128 v[224:227], v249 offset:55168
    v_mfma_f32_16x16x32_bf16 v[124:127], v[228:231], v[176:179], v[124:127]
    ds_read_b128 v[228:231], v249 offset:55232
k1_ste_q2:
    s_cmp_eq_u32 s52, 3
    s_cbranch_scc1 k1_sth_q3
    s_waitcnt lgkmcnt(7)
    v_mfma_f32_16x16x32_bf16 v[176:179], v[200:203], v[128:131], v[232:235]
    s_waitcnt lgkmcnt(6)
    v_mfma_f32_16x16x32_bf16 v[176:179], v[204:207], v[132:135], v[176:179]
    s_waitcnt lgkmcnt(5)
    v_mfma_f32_16x16x32_bf16 v[176:179], v[208:211], v[136:139], v[176:179]
    s_waitcnt lgkmcnt(4)
    v_mfma_f32_16x16x32_bf16 v[176:179], v[212:215], v[140:143], v[176:179]
    s_waitcnt lgkmcnt(3)
    v_mfma_f32_16x16x32_bf16 v[180:183], v[216:219], v[128:131], v[232:235]
    s_waitcnt lgkmcnt(2)
    v_mfma_f32_16x16x32_bf16 v[180:183], v[220:223], v[132:135], v[180:183]
    s_waitcnt lgkmcnt(1)
    v_mfma_f32_16x16x32_bf16 v[180:183], v[224:227], v[136:139], v[180:183]
    s_waitcnt lgkmcnt(0)
    v_mfma_f32_16x16x32_bf16 v[180:183], v[228:231], v[140:143], v[180:183]
    v_mfma_f32_16x16x32_bf16 v[184:187], v[200:203], v[144:147], v[236:239]
    v_mfma_f32_16x16x32_bf16 v[184:187], v[204:207], v[148:151], v[184:187]
    v_mfma_f32_16x16x32_bf16 v[184:187], v[208:211], v[152:155], v[184:187]
    v_max3_f32 v253, v176, v177, v178
    s_nop 3
    v_max3_f32 v253, v253, v179, v180
    v_max3_f32 v253, v253, v181, v182
    v_mfma_f32_16x16x32_bf16 v[184:187], v[212:215], v[156:159], v[184:187]
    v_max_f32 v253, v253, v183
    v_cmp_lt_f32 vcc, s31, v253
    v_mfma_f32_16x16x32_bf16 v[188:191], v[216:219], v[144:147], v[236:239]
    s_nop 0
    s_cbranch_vccnz k1_rare_q3a_0
k1_ok_q3a_0:
    v_mfma_f32_16x16x32_bf16 v[188:191], v[220:223], v[148:151], v[188:191]
    v_exp_f32 v176, v176
    v_exp_f32 v177, v177
    v_mfma_f32_16x16x32_bf16 v[188:191], v[224:227], v[152:155], v[188:191]
    v_exp_f32 v178, v178
    v_exp_f32 v179, v179
    v_exp_f32 v180, v180
    v_mfma_f32_16x16x32_bf16 v[188:191], v[228:231], v[156:159], v[188:191]
    v_exp_f32 v181, v181
    v_exp_f32 v182, v182
    v_mfma_f32_16x16x32_bf16 v[192:195], v[200:203], v[160:163], v[240:243]
    ds_read_b64_tr_b16 v[200:201], v250 offset:50688
    ds_read_b64_tr_b16 v[202:203], v250 offset:54784
    v_exp_f32 v183, v183
    v_add_f32 v245, v245, v176
    v_mfma_f32_16x16x32_bf16 v[192:195], v[204:207], v[164:167], v[192:195]
    v_xor_b32 v254, 32, v250
    ds_read_b64_tr_b16 v[204:205], v254 offset:50688
    ds_read_b64_tr_b16 v[206:207], v254 offset:54784
    v_add_f32 v245, v245, v177
    v_add_f32 v245, v245, v178
    v_mfma_f32_16x16x32_bf16 v[192:195], v[208:211], v[168:171], v[192:195]
    v_xor_b32 v255, 64, v250
    ds_read_b64_tr_b16 v[208:209], v255 offset:50688
    ds_read_b64_tr_b16 v[210:211], v255 offset:54784
    v_add_f32 v245, v245, v179
    v_add_f32 v245, v245, v180
    v_add_f32 v245, v245, v181
    v_mfma_f32_16x16x32_bf16 v[192:195], v[212:215], v[172:175], v[192:195]
    v_xor_b32 v254, 96, v250
    ds_read_b64_tr_b16 v[212:213], v254 offset:50688
    ds_read_b64_tr_b16 v[214:215], v254 offset:54784
    v_add_f32 v245, v245, v182
    v_add_f32 v245, v245, v183
    v_max3_f32 v253, v184, v185, v186
    v_max3_f32 v253, v253, v187, v188
    v_max3_f32 v253, v253, v189, v190
    v_mfma_f32_16x16x32_bf16 v[196:199], v[216:219], v[160:163], v[240:243]
    v_xor_b32 v255, 128, v250
    ds_read_b64_tr_b16 v[216:217], v255 offset:50688
    ds_read_b64_tr_b16 v[218:219], v255 offset:54784
    v_cvt_pk_bf16_f32 v176, v176, v177
    v_cvt_pk_bf16_f32 v177, v178, v179
    v_max_f32 v253, v253, v191
    v_cmp_lt_f32 vcc, s31, v253
    v_mfma_f32_16x16x32_bf16 v[196:199], v[220:223], v[164:167], v[196:199]
    v_xor_b32 v254, 160, v250
    ds_read_b64_tr_b16 v[220:221], v254 offset:50688
    ds_read_b64_tr_b16 v[222:223], v254 offset:54784
    v_cvt_pk_bf16_f32 v178, v180, v181
    v_cvt_pk_bf16_f32 v179, v182, v183
    s_cbranch_vccnz k1_rare_q3a_1
k1_ok_q3a_1:
    v_mfma_f32_16x16x32_bf16 v[196:199], v[224:227], v[168:171], v[196:199]
    v_xor_b32 v255, 192, v250
    ds_read_b64_tr_b16 v[224:225], v255 offset:50688
    ds_read_b64_tr_b16 v[226:227], v255 offset:54784
    v_exp_f32 v184, v184
    v_exp_f32 v185, v185
    v_mfma_f32_16x16x32_bf16 v[196:199], v[228:231], v[172:175], v[196:199]
    v_xor_b32 v254, 224, v250
    ds_read_b64_tr_b16 v[228:229], v254 offset:50688
    ds_read_b64_tr_b16 v[230:231], v254 offset:54784
    v_exp_f32 v186, v186
    v_exp_f32 v187, v187
    v_exp_f32 v188, v188
    s_waitcnt lgkmcnt(14)
    v_mfma_f32_16x16x32_bf16 v[0:3], v[200:203], v[176:179], v[0:3]
    v_exp_f32 v189, v189
    v_exp_f32 v190, v190
    s_waitcnt lgkmcnt(12)
    v_mfma_f32_16x16x32_bf16 v[4:7], v[204:207], v[176:179], v[4:7]
    v_exp_f32 v191, v191
    v_add_f32 v246, v246, v184
    s_waitcnt lgkmcnt(10)
    v_mfma_f32_16x16x32_bf16 v[8:11], v[208:211], v[176:179], v[8:11]
    v_add_f32 v246, v246, v185
    v_add_f32 v246, v246, v186
    s_waitcnt lgkmcnt(8)
    v_mfma_f32_16x16x32_bf16 v[12:15], v[212:215], v[176:179], v[12:15]
    v_add_f32 v246, v246, v187
    v_add_f32 v246, v246, v188
    v_add_f32 v246, v246, v189
    v_max3_f32 v253, v192, v193, v194
    v_max3_f32 v253, v253, v195, v196
    v_max3_f32 v253, v253, v197, v198
    s_waitcnt lgkmcnt(6)
    v_mfma_f32_16x16x32_bf16 v[16:19], v[216:219], v[176:179], v[16:19]
    v_add_f32 v246, v246, v190
    v_add_f32 v246, v246, v191
    v_max_f32 v253, v253, v199
    v_cmp_lt_f32 vcc, s31, v253
    s_waitcnt lgkmcnt(4)
    v_mfma_f32_16x16x32_bf16 v[20:23], v[220:223], v[176:179], v[20:23]
    v_cvt_pk_bf16_f32 v184, v184, v185
    v_cvt_pk_bf16_f32 v185, v186, v187
    s_cbranch_vccnz k1_rare_q3a_2
k1_ok_q3a_2:
    s_waitcnt lgkmcnt(2)
    v_mfma_f32_16x16x32_bf16 v[24:27], v[224:227], v[176:179], v[24:27]
    v_cvt_pk_bf16_f32 v186, v188, v189
    v_cvt_pk_bf16_f32 v187, v190, v191
    v_exp_f32 v192, v192
    v_exp_f32 v193, v193
    s_waitcnt lgkmcnt(0)
    v_mfma_f32_16x16x32_bf16 v[28:31], v[228:231], v[176:179], v[28:31]
    v_exp_f32 v194, v194
    v_exp_f32 v195, v195
    v_exp_f32 v196, v196
    v_mfma_f32_16x16x32_bf16 v[32:35], v[200:203], v[184:187], v[32:35]
    v_exp_f32 v197, v197
    v_exp_f32 v198, v198
    v_mfma_f32_16x16x32_bf16 v[36:39], v[204:207], v[184:187], v[36:39]
    v_exp_f32 v199, v199
    v_add_f32 v247, v247, v192
    v_mfma_f32_16x16x32_bf16 v[40:43], v[208:211], v[184:187], v[40:43]
    v_add_f32 v247, v247, v193
    v_add_f32 v247, v247, v194
    v_mfma_f32_16x16x32_bf16 v[44:47], v[212:215], v[184:187], v[44:47]
    v_add_f32 v247, v247, v195
    v_add_f32 v247, v247, v196
    v_add_f32 v247, v247, v197
    v_mfma_f32_16x16x32_bf16 v[48:51], v[216:219], v[184:187], v[48:51]
    v_add_f32 v247, v247, v198
    v_add_f32 v247, v247, v199
    v_mfma_f32_16x16x32_bf16 v[52:55], v[220:223], v[184:187], v[52:55]
    v_cvt_pk_bf16_f32 v192, v192, v193
    v_cvt_pk_bf16_f32 v193, v194, v195
    v_mfma_f32_16x16x32_bf16 v[56:59], v[224:227], v[184:187], v[56:59]
    v_cvt_pk_bf16_f32 v194, v196, v197
    v_cvt_pk_bf16_f32 v195, v198, v199
    v_mfma_f32_16x16x32_bf16 v[60:63], v[228:231], v[184:187], v[60:63]
    s_waitcnt vmcnt(0)
    s_barrier
    v_mfma_f32_16x16x32_bf16 v[64:67], v[200:203], v[192:195], v[64:67]
    ds_read_b128 v[200:203], v249
    v_mfma_f32_16x16x32_bf16 v[68:71], v[204:207], v[192:195], v[68:71]
    ds_read_b128 v[204:207], v249 offset:64
    v_mfma_f32_16x16x32_bf16 v[72:75], v[208:211], v[192:195], v[72:75]
    ds_read_b128 v[208:211], v249 offset:128
    v_mfma_f32_16x16x32_bf16 v[76:79], v[212:215], v[192:195], v[76:79]
    ds_read_b128 v[212:215], v249 offset:192
    v_mfma_f32_16x16x32_bf16 v[80:83], v[216:219], v[192:195], v[80:83]
    ds_read_b128 v[216:219], v249 offset:4352
    v_mfma_f32_16x16x32_bf16 v[84:87], v[220:223], v[192:195], v[84:87]
    ds_read_b128 v[220:223], v249 offset:4416
    v_mfma_f32_16x16x32_bf16 v[88:91], v[224:227], v[192:195], v[88:91]
    ds_read_b128 v[224:227], v249 offset:4480
    v_mfma_f32_16x16x32_bf16 v[92:95], v[228:231], v[192:195], v[92:95]
    ds_read_b128 v[228:231], v249 offset:4544
    s_branch k1_ste_q3
k1_sth_q3:
    s_waitcnt lgkmcnt(7)
    v_mfma_f32_16x16x32_bf16 v[176:179], v[200:203], v[128:131], v[232:235]
    s_waitcnt lgkmcnt(6)
    v_mfma_f32_16x16x32_bf16 v[176:179], v[204:207], v[132:135], v[176:179]
    s_waitcnt lgkmcnt(5)
    v_mfma_f32_16x16x32_bf16 v[176:179], v[208:211], v[136:139], v[176:179]
    s_waitcnt lgkmcnt(4)
    v_mfma_f32_16x16x32_bf16 v[176:179], v[212:215], v[140:143], v[176:179]
    s_waitcnt lgkmcnt(3)
    v_mfma_f32_16x16x32_bf16 v[180:183], v[216:219], v[128:131], v[232:235]
    s_waitcnt lgkmcnt(2)
    v_mfma_f32_16x16x32_bf16 v[180:183], v[220:223], v[132:135], v[180:183]
    s_waitcnt lgkmcnt(1)
    v_mfma_f32_16x16x32_bf16 v[180:183], v[224:227], v[136:139], v[180:183]
    s_waitcnt lgkmcnt(0)
    v_mfma_f32_16x16x32_bf16 v[180:183], v[228:231], v[140:143], v[180:183]
    v_mfma_f32_16x16x32_bf16 v[184:187], v[200:203], v[144:147], v[236:239]
    v_mfma_f32_16x16x32_bf16 v[184:187], v[204:207], v[148:151], v[184:187]
    v_mfma_f32_16x16x32_bf16 v[184:187], v[208:211], v[152:155], v[184:187]
    v_max3_f32 v253, v176, v177, v178
    s_nop 3
    v_max3_f32 v253, v253, v179, v180
    v_max3_f32 v253, v253, v181, v182
    v_mfma_f32_16x16x32_bf16 v[184:187], v[212:215], v[156:159], v[184:187]
    v_max_f32 v253, v253, v183
    v_cmp_lt_f32 vcc, s31, v253
    v_mfma_f32_16x16x32_bf16 v[188:191], v[216:219], v[144:147], v[236:239]
    s_nop 0
    s_cbranch_vccnz k1_rare_q3b_0
k1_ok_q3b_0:
    v_mfma_f32_16x16x32_bf16 v[188:191], v[220:223], v[148:151], v[188:191]
    v_exp_f32 v176, v176
    v_exp_f32 v177, v177
    v_mfma_f32_16x16x32_bf16 v[188:191], v[224:227], v[152:155], v[188:191]
    v_exp_f32 v178, v178
    v_exp_f32 v179, v179
    v_exp_f32 v180, v180
    v_mfma_f32_16x16x32_bf16 v[188:191], v[228:231], v[156:159], v[188:191]
    v_exp_f32 v181, v181
    v_exp_f32 v182, v182
    v_mfma_f32_16x16x32_bf16 v[192:195], v[200:203], v[160:163], v[240:243]
    ds_read_b64_tr_b16 v[200:201], v250 offset:50688
    ds_read_b64_tr_b16 v[202:203], v250 offset:54784
    v_exp_f32 v183, v183
    v_add_f32 v245, v245, v176
    v_mfma_f32_16x16x32_bf16 v[192:195], v[204:207], v[164:167], v[192:195]
    v_xor_b32 v254, 32, v250
    ds_read_b64_tr_b16 v[204:205], v254 offset:50688
    ds_read_b64_tr_b16 v[206:207], v254 offset:54784
    v_add_f32 v245, v245, v177
    v_add_f32 v245, v245, v178
    v_mfma_f32_16x16x32_bf16 v[192:195], v[208:211], v[168:171], v[192:195]
    v_xor_b32 v255, 64, v250
    ds_read_b64_tr_b16 v[208:209], v255 offset:50688
    ds_read_b64_tr_b16 v[210:211], v255 offset:54784
    v_add_f32 v245, v245, v179
    v_add_f32 v245, v245, v180
    v_add_f32 v245, v245, v181
    v_mfma_f32_16x16x32_bf16 v[192:195], v[212:215], v[172:175], v[192:195]
    v_xor_b32 v254, 96, v250
    ds_read_b64_tr_b16 v[212:213], v254 offset:50688
    ds_read_b64_tr_b16 v[214:215], v254 offset:54784
    v_add_f32 v245, v245, v182
    v_add_f32 v245, v245, v183
    v_max3_f32 v253, v184, v185, v186
    v_max3_f32 v253, v253, v187, v188
    v_max3_f32 v253, v253, v189, v190
    v_mfma_f32_16x16x32_bf16 v[196:199], v[216:219], v[160:163], v[240:243]
    v_xor_b32 v255, 128, v250
    ds_read_b64_tr_b16 v[216:217], v255 offset:50688
    ds_read_b64_tr_b16 v[218:219], v255 offset:54784
    v_cvt_pk_bf16_f32 v176, v176, v177
    v_cvt_pk_bf16_f32 v177, v178, v179
    v_max_f32 v253, v253, v191
    v_cmp_lt_f32 vcc, s31, v253
    v_mfma_f32_16x16x32_bf16 v[196:199], v[220:223], v[164:167], v[196:199]
    v_xor_b32 v254, 160, v250
    ds_read_b64_tr_b16 v[220:221], v254 offset:50688
    ds_read_b64_tr_b16 v[222:223], v254 offset:54784
    v_cvt_pk_bf16_f32 v178, v180, v181
    v_cvt_pk_bf16_f32 v179, v182, v183
    s_cbranch_vccnz k1_rare_q3b_1
k1_ok_q3b_1:
    v_mfma_f32_16x16x32_bf16 v[196:199], v[224:227], v[168:171], v[196:199]
    v_xor_b32 v255, 192, v250
    ds_read_b64_tr_b16 v[224:225], v255 offset:50688
    ds_read_b64_tr_b16 v[226:227], v255 offset:54784
    v_exp_f32 v184, v184
    v_exp_f32 v185, v185
    v_mfma_f32_16x16x32_bf16 v[196:199], v[228:231], v[172:175], v[196:199]
    v_xor_b32 v254, 224, v250
    ds_read_b64_tr_b16 v[228:229], v254 offset:50688
    ds_read_b64_tr_b16 v[230:231], v254 offset:54784
    v_exp_f32 v186, v186
    v_exp_f32 v187, v187
    v_exp_f32 v188, v188
    s_waitcnt lgkmcnt(14)
    v_mfma_f32_16x16x32_bf16 v[0:3], v[200:203], v[176:179], v[0:3]
    v_exp_f32 v189, v189
    v_exp_f32 v190, v190
    s_waitcnt lgkmcnt(12)
    v_mfma_f32_16x16x32_bf16 v[4:7], v[204:207], v[176:179], v[4:7]
    v_exp_f32 v191, v191
    v_add_f32 v246, v246, v184
    s_waitcnt lgkmcnt(10)
    v_mfma_f32_16x16x32_bf16 v[8:11], v[208:211], v[176:179], v[8:11]
    v_add_f32 v246, v246, v185
    v_add_f32 v246, v246, v186
    s_waitcnt lgkmcnt(8)
    v_mfma_f32_16x16x32_bf16 v[12:15], v[212:215], v[176:179], v[12:15]
    v_add_f32 v246, v246, v187
    v_add_f32 v246, v246, v188
    v_add_f32 v246, v246, v189
    v_max3_f32 v253, v192, v193, v194
    v_max3_f32 v253, v253, v195, v196
    v_max3_f32 v253, v253, v197, v198
    s_waitcnt lgkmcnt(6)
    v_mfma_f32_16x16x32_bf16 v[16:19], v[216:219], v[176:179], v[16:19]
    v_add_f32 v246, v246, v190
    v_add_f32 v246, v246, v191
    v_max_f32 v253, v253, v199
    v_cmp_lt_f32 vcc, s31, v253
    s_waitcnt lgkmcnt(4)
    v_mfma_f32_16x16x32_bf16 v[20:23], v[220:223], v[176:179], v[20:23]
    v_cvt_pk_bf16_f32 v184, v184, v185
    v_cvt_pk_bf16_f32 v185, v186, v187
    s_cbranch_vccnz k1_rare_q3b_2
k1_ok_q3b_2:
    s_waitcnt lgkmcnt(2)
    v_mfma_f32_16x16x32_bf16 v[24:27], v[224:227], v[176:179], v[24:27]
    v_cvt_pk_bf16_f32 v186, v188, v189
    v_cvt_pk_bf16_f32 v187, v190, v191
    v_exp_f32 v192, v192
    v_exp_f32 v193, v193
    s_waitcnt lgkmcnt(0)
    v_mfma_f32_16x16x32_bf16 v[28:31], v[228:231], v[176:179], v[28:31]
    v_exp_f32 v194, v194
    v_exp_f32 v195, v195
    v_exp_f32 v196, v196
    v_mfma_f32_16x16x32_bf16 v[32:35], v[200:203], v[184:187], v[32:35]
    v_exp_f32 v197, v197
    v_exp_f32 v198, v198
    v_mfma_f32_16x16x32_bf16 v[36:39], v[204:207], v[184:187], v[36:39]
    v_exp_f32 v199, v199
    v_add_f32 v247, v247, v192
    v_mfma_f32_16x16x32_bf16 v[40:43], v[208:211], v[184:187], v[40:43]
    v_add_f32 v247, v247, v193
    v_add_f32 v247, v247, v194
    v_mfma_f32_16x16x32_bf16 v[44:47], v[212:215], v[184:187], v[44:47]
    v_add_f32 v247, v247, v195
    v_add_f32 v247, v247, v196
    v_add_f32 v247, v247, v197
    v_mfma_f32_16x16x32_bf16 v[48:51], v[216:219], v[184:187], v[48:51]
    v_add_f32 v247, v247, v198
    v_add_f32 v247, v247, v199
    v_mfma_f32_16x16x32_bf16 v[52:55], v[220:223], v[184:187], v[52:55]
    v_cvt_pk_bf16_f32 v192, v192, v193
    v_cvt_pk_bf16_f32 v193, v194, v195
    v_mfma_f32_16x16x32_bf16 v[56:59], v[224:227], v[184:187], v[56:59]
    v_cvt_pk_bf16_f32 v194, v196, v197
    v_cvt_pk_bf16_f32 v195, v198, v199
    v_mfma_f32_16x16x32_bf16 v[60:63], v[228:231], v[184:187], v[60:63]
    s_nop 0
    v_mfma_f32_16x16x32_bf16 v[64:67], v[200:203], v[192:195], v[64:67]
    ds_read_b128 v[200:203], v249 offset:50688
    v_mfma_f32_16x16x32_bf16 v[68:71], v[204:207], v[192:195], v[68:71]
    ds_read_b128 v[204:207], v249 offset:50752
    v_mfma_f32_16x16x32_bf16 v[72:75], v[208:211], v[192:195], v[72:75]
    ds_read_b128 v[208:211], v249 offset:50816
    v_mfma_f32_16x16x32_bf16 v[76:79], v[212:215], v[192:195], v[76:79]
    ds_read_b128 v[212:215], v249 offset:50880
    v_mfma_f32_16x16x32_bf16 v[80:83], v[216:219], v[192:195], v[80:83]
    ds_read_b128 v[216:219], v249 offset:55040
    v_mfma_f32_16x16x32_bf16 v[84:87], v[220:223], v[192:195], v[84:87]
    ds_read_b128 v[220:223], v249 offset:55104
    v_mfma_f32_16x16x32_bf16 v[88:91], v[224:227], v[192:195], v[88:91]
    ds_read_b128 v[224:227], v249 offset:55168
    v_mfma_f32_16x16x32_bf16 v[92:95], v[228:231], v[192:195], v[92:95]
    ds_read_b128 v[228:231], v249 offset:55232
    v_mbcnt_lo_u32_b32 v255, -1, 0
    v_mbcnt_hi_u32_b32 v255, -1, v255
    v_lshl_add_u32 v255, v255, 4, s55
    ds_read_b128 v[184:187], v255
    ds_read_b128 v[188:191], v255 offset:1024
    ds_read_b128 v[192:195], v255 offset:2048
    ds_read_b128 v[196:199], v255 offset:3072
    v_mov_b32 v176, v244
    v_mov_b32 v177, v244
    v_mov_b32 v178, v244
    v_mov_b32 v179, v244
    v_mov_b32 v180, v244
    v_mov_b32 v181, v244
    v_mov_b32 v182, v244
    v_mov_b32 v183, v244
    s_waitcnt lgkmcnt(0)
    v_mfma_f32_16x16x32_bf16 v[176:179], v[200:203], v[184:187], v[176:179]
    ds_read_b64_tr_b16 v[200:201], v250 offset:50688
    ds_read_b64_tr_b16 v[202:203], v250 offset:54784
    v_mfma_f32_16x16x32_bf16 v[176:179], v[204:207], v[188:191], v[176:179]
    v_xor_b32 v254, 32, v250
    ds_read_b64_tr_b16 v[204:205], v254 offset:50688
    ds_read_b64_tr_b16 v[206:207], v254 offset:54784
    v_mfma_f32_16x16x32_bf16 v[176:179], v[208:211], v[192:195], v[176:179]
    v_xor_b32 v255, 64, v250
    ds_read_b64_tr_b16 v[208:209], v255 offset:50688
    ds_read_b64_tr_b16 v[210:211], v255 offset:54784
    v_mfma_f32_16x16x32_bf16 v[176:179], v[212:215], v[196:199], v[176:179]
    v_xor_b32 v254, 96, v250
    ds_read_b64_tr_b16 v[212:213], v254 offset:50688
    ds_read_b64_tr_b16 v[214:215], v254 offset:54784
    v_mfma_f32_16x16x32_bf16 v[180:183], v[216:219], v[184:187], v[180:183]
    v_xor_b32 v255, 128, v250
    ds_read_b64_tr_b16 v[216:217], v255 offset:50688
    ds_read_b64_tr_b16 v[218:219], v255 offset:54784
    v_mfma_f32_16x16x32_bf16 v[180:183], v[220:223], v[188:191], v[180:183]
    v_xor_b32 v254, 160, v250
    ds_read_b64_tr_b16 v[220:221], v254 offset:50688
    ds_read_b64_tr_b16 v[222:223], v254 offset:54784
    v_mfma_f32_16x16x32_bf16 v[180:183], v[224:227], v[192:195], v[180:183]
    v_xor_b32 v255, 192, v250
    ds_read_b64_tr_b16 v[224:225], v255 offset:50688
    ds_read_b64_tr_b16 v[226:227], v255 offset:54784
    v_mfma_f32_16x16x32_bf16 v[180:183], v[228:231], v[196:199], v[180:183]
    v_xor_b32 v254, 224, v250
    ds_read_b64_tr_b16 v[228:229], v254 offset:50688
    ds_read_b64_tr_b16 v[230:231], v254 offset:54784
    v_max3_f32 v253, v176, v177, v178
    s_nop 3
    v_max3_f32 v253, v253, v179, v180
    v_max3_f32 v253, v253, v181, v182
    v_max_f32 v253, v253, v183
    v_cmp_lt_f32 vcc, s53, v253
    s_nop 1
    s_cbranch_vccnz k1_rare_q3b_L
k1_ok_q3b_L:
    v_exp_f32 v176, v176
    v_exp_f32 v177, v177
    v_exp_f32 v178, v178
    v_exp_f32 v179, v179
    v_exp_f32 v180, v180
    v_exp_f32 v181, v181
    v_exp_f32 v182, v182
    v_exp_f32 v183, v183
    v_add_f32 v248, v248, v176
    v_add_f32 v248, v248, v177
    v_add_f32 v248, v248, v178
    v_add_f32 v248, v248, v179
    v_add_f32 v248, v248, v180
    v_add_f32 v248, v248, v181
    v_add_f32 v248, v248, v182
    v_add_f32 v248, v248, v183
    v_cvt_pk_bf16_f32 v176, v176, v177
    v_cvt_pk_bf16_f32 v177, v178, v179
    v_cvt_pk_bf16_f32 v178, v180, v181
    v_cvt_pk_bf16_f32 v179, v182, v183
    s_mov_b32 s53, 0x41800000
    s_mov_b32 s54, 0
    s_waitcnt lgkmcnt(0)
    s_waitcnt vmcnt(0)
    s_barrier
    v_mfma_f32_16x16x32_bf16 v[96:99], v[200:203], v[176:179], v[96:99]
    ds_read_b128 v[200:203], v249
    v_mfma_f32_16x16x32_bf16 v[100:103], v[204:207], v[176:179], v[100:103]
    ds_read_b128 v[204:207], v249 offset:64
    v_mfma_f32_16x16x32_bf16 v[104:107], v[208:211], v[176:179], v[104:107]
    ds_read_b128 v[208:211], v249 offset:128
    v_mfma_f32_16x16x32_bf16 v[108:111], v[212:215], v[176:179], v[108:111]
    ds_read_b128 v[212:215], v249 offset:192
    v_mfma_f32_16x16x32_bf16 v[112:115], v[216:219], v[176:179], v[112:115]
    ds_read_b128 v[216:219], v249 offset:4352
    v_mfma_f32_16x16x32_bf16 v[116:119], v[220:223], v[176:179], v[116:119]
    ds_read_b128 v[220:223], v249 offset:4416
    v_mfma_f32_16x16x32_bf16 v[120:123], v[224:227], v[176:179], v[120:123]
    ds_read_b128 v[224:227], v249 offset:4480
    v_mfma_f32_16x16x32_bf16 v[124:127], v[228:231], v[176:179], v[124:127]
    ds_read_b128 v[228:231], v249 offset:4544
k1_ste_q3:
    s_add_u32 s36, s36, 1
    s_cmp_lt_u32 s36, 4
    s_cbranch_scc1 k1_loop
    s_waitcnt lgkmcnt(0)
    s_nop 7
    v_mbcnt_lo_u32_b32 v254, -1, 0
    v_mbcnt_hi_u32_b32 v254, -1, v254
    v_lshlrev_b32 v254, 4, v254
    v_mov_b32 v253, v245
    s_nop 1
    v_permlane32_swap_b32 v245, v253
    v_add_f32 v245, v245, v253
    v_mov_b32 v253, v245
    s_nop 1
    v_permlane16_swap_b32 v245, v253
    v_add_f32 v245, v245, v253
    v_mov_b32 v253, v246
    s_nop 1
    v_permlane32_swap_b32 v246, v253
    v_add_f32 v246, v246, v253
    v_mov_b32 v253, v246
    s_nop 1
    v_permlane16_swap_b32 v246, v253
    v_add_f32 v246, v246, v253
    v_mov_b32 v253, v247
    s_nop 1
    v_permlane32_swap_b32 v247, v253
    v_add_f32 v247, v247, v253
    v_mov_b32 v253, v247
    s_nop 1
    v_permlane16_swap_b32 v247, v253
    v_add_f32 v247, v247, v253
    v_mov_b32 v253, v248
    s_nop 1
    v_permlane32_swap_b32 v248, v253
    v_add_f32 v248, v248, v253
    v_mov_b32 v253, v248
    s_nop 1
    v_permlane16_swap_b32 v248, v253
    v_add_f32 v248, v248, v253
    v_and_b32 v185, 240, v254
    v_lshrrev_b32 v185, 1, v185
    s_lshl_b32 s37, s30, 9
    s_add_u32 s37, s37, 151552
    v_add_u32 v185, s37, v185
    s_lshl_b32 s37, s28, 7
    v_add_u32 v186, s37, v185
    v_mov_b32 v192, v244
    v_mov_b32 v193, v248
    ds_write_b64 v186, v[192:193]
    v_rcp_f32 v232, v245
    v_rcp_f32 v233, v245
    v_rcp_f32 v236, v246
    v_rcp_f32 v237, v246
    v_rcp_f32 v240, v247
    v_rcp_f32 v241, v247
    s_mul_i32 s38, s28, 393216
    s_lshl_b32 s37, s29, 13
    v_add_u32 v189, s37, v254
    ds_write_b128 v189, v[96:99]
    ds_write_b128 v189, v[100:103] offset:1024
    ds_write_b128 v189, v[104:107] offset:2048
    ds_write_b128 v189, v[108:111] offset:3072
    ds_write_b128 v189, v[112:115] offset:4096
    ds_write_b128 v189, v[116:119] offset:5120
    ds_write_b128 v189, v[120:123] offset:6144
    ds_write_b128 v189, v[124:127] offset:7168
    v_pk_mul_f32 v[0:1], v[0:1], v[232:233]
    v_pk_mul_f32 v[2:3], v[2:3], v[232:233]
    v_pk_mul_f32 v[4:5], v[4:5], v[232:233]
    v_pk_mul_f32 v[6:7], v[6:7], v[232:233]
    v_cvt_pk_bf16_f32 v0, v0, v1
    v_cvt_pk_bf16_f32 v1, v2, v3
    v_cvt_pk_bf16_f32 v2, v4, v5
    v_cvt_pk_bf16_f32 v3, v6, v7
    buffer_store_dwordx4 v[0:3], v254, s[24:27], s38 offen sc1
    v_pk_mul_f32 v[8:9], v[8:9], v[232:233]
    v_pk_mul_f32 v[10:11], v[10:11], v[232:233]
    v_pk_mul_f32 v[12:13], v[12:13], v[232:233]
    v_pk_mul_f32 v[14:15], v[14:15], v[232:233]
    v_cvt_pk_bf16_f32 v8, v8, v9
    v_cvt_pk_bf16_f32 v9, v10, v11
    v_cvt_pk_bf16_f32 v10, v12, v13
    v_cvt_pk_bf16_f32 v11, v14, v15
    buffer_store_dwordx4 v[8:11], v254, s[24:27], s38 offen offset:1024 sc1
    v_pk_mul_f32 v[16:17], v[16:17], v[232:233]
    v_pk_mul_f32 v[18:19], v[18:19], v[232:233]
    v_pk_mul_f32 v[20:21], v[20:21], v[232:233]
    v_pk_mul_f32 v[22:23], v[22:23], v[232:233]
    v_cvt_pk_bf16_f32 v16, v16, v17
    v_cvt_pk_bf16_f32 v17, v18, v19
    v_cvt_pk_bf16_f32 v18, v20, v21
    v_cvt_pk_bf16_f32 v19, v22, v23
    buffer_store_dwordx4 v[16:19], v254, s[24:27], s38 offen offset:2048 sc1
    v_pk_mul_f32 v[24:25], v[24:25], v[232:233]
    v_pk_mul_f32 v[26:27], v[26:27], v[232:233]
    v_pk_mul_f32 v[28:29], v[28:29], v[232:233]
    v_pk_mul_f32 v[30:31], v[30:31], v[232:233]
    v_cvt_pk_bf16_f32 v24, v24, v25
    v_cvt_pk_bf16_f32 v25, v26, v27
    v_cvt_pk_bf16_f32 v26, v28, v29
    v_cvt_pk_bf16_f32 v27, v30, v31
    buffer_store_dwordx4 v[24:27], v254, s[24:27], s38 offen offset:3072 sc1
    s_add_u32 s38, s38, 131072
    v_pk_mul_f32 v[32:33], v[32:33], v[236:237]
    v_pk_mul_f32 v[34:35], v[34:35], v[236:237]
    v_pk_mul_f32 v[36:37], v[36:37], v[236:237]
    v_pk_mul_f32 v[38:39], v[38:39], v[236:237]
    v_cvt_pk_bf16_f32 v32, v32, v33
    v_cvt_pk_bf16_f32 v33, v34, v35
    v_cvt_pk_bf16_f32 v34, v36, v37
    v_cvt_pk_bf16_f32 v35, v38, v39
    buffer_store_dwordx4 v[32:35], v254, s[24:27], s38 offen sc1
    v_pk_mul_f32 v[40:41], v[40:41], v[236:237]
    v_pk_mul_f32 v[42:43], v[42:43], v[236:237]
    v_pk_mul_f32 v[44:45], v[44:45], v[236:237]
    v_pk_mul_f32 v[46:47], v[46:47], v[236:237]
    v_cvt_pk_bf16_f32 v40, v40, v41
    v_cvt_pk_bf16_f32 v41, v42, v43
    v_cvt_pk_bf16_f32 v42, v44, v45
    v_cvt_pk_bf16_f32 v43, v46, v47
    buffer_store_dwordx4 v[40:43], v254, s[24:27], s38 offen offset:1024 sc1
    v_pk_mul_f32 v[48:49], v[48:49], v[236:237]
    v_pk_mul_f32 v[50:51], v[50:51], v[236:237]
    v_pk_mul_f32 v[52:53], v[52:53], v[236:237]
    v_pk_mul_f32 v[54:55], v[54:55], v[236:237]
    v_cvt_pk_bf16_f32 v48, v48, v49
    v_cvt_pk_bf16_f32 v49, v50, v51
    v_cvt_pk_bf16_f32 v50, v52, v53
    v_cvt_pk_bf16_f32 v51, v54, v55
    buffer_store_dwordx4 v[48:51], v254, s[24:27], s38 offen offset:2048 sc1
    v_pk_mul_f32 v[56:57], v[56:57], v[236:237]
    v_pk_mul_f32 v[58:59], v[58:59], v[236:237]
    v_pk_mul_f32 v[60:61], v[60:61], v[236:237]
    v_pk_mul_f32 v[62:63], v[62:63], v[236:237]
    v_cvt_pk_bf16_f32 v56, v56, v57
    v_cvt_pk_bf16_f32 v57, v58, v59
    v_cvt_pk_bf16_f32 v58, v60, v61
    v_cvt_pk_bf16_f32 v59, v62, v63
    buffer_store_dwordx4 v[56:59], v254, s[24:27], s38 offen offset:3072 sc1
    s_add_u32 s38, s38, 131072
    v_pk_mul_f32 v[64:65], v[64:65], v[240:241]
    v_pk_mul_f32 v[66:67], v[66:67], v[240:241]
    v_pk_mul_f32 v[68:69], v[68:69], v[240:241]
    v_pk_mul_f32 v[70:71], v[70:71], v[240:241]
    v_cvt_pk_bf16_f32 v64, v64, v65
    v_cvt_pk_bf16_f32 v65, v66, v67
    v_cvt_pk_bf16_f32 v66, v68, v69
    v_cvt_pk_bf16_f32 v67, v70, v71
    buffer_store_dwordx4 v[64:67], v254, s[24:27], s38 offen sc1
    v_pk_mul_f32 v[72:73], v[72:73], v[240:241]
    v_pk_mul_f32 v[74:75], v[74:75], v[240:241]
    v_pk_mul_f32 v[76:77], v[76:77], v[240:241]
    v_pk_mul_f32 v[78:79], v[78:79], v[240:241]
    v_cvt_pk_bf16_f32 v72, v72, v73
    v_cvt_pk_bf16_f32 v73, v74, v75
    v_cvt_pk_bf16_f32 v74, v76, v77
    v_cvt_pk_bf16_f32 v75, v78, v79
    buffer_store_dwordx4 v[72:75], v254, s[24:27], s38 offen offset:1024 sc1
    v_pk_mul_f32 v[80:81], v[80:81], v[240:241]
    v_pk_mul_f32 v[82:83], v[82:83], v[240:241]
    v_pk_mul_f32 v[84:85], v[84:85], v[240:241]
    v_pk_mul_f32 v[86:87], v[86:87], v[240:241]
    v_cvt_pk_bf16_f32 v80, v80, v81
    v_cvt_pk_bf16_f32 v81, v82, v83
    v_cvt_pk_bf16_f32 v82, v84, v85
    v_cvt_pk_bf16_f32 v83, v86, v87
    buffer_store_dwordx4 v[80:83], v254, s[24:27], s38 offen offset:2048 sc1
    v_pk_mul_f32 v[88:89], v[88:89], v[240:241]
    v_pk_mul_f32 v[90:91], v[90:91], v[240:241]
    v_pk_mul_f32 v[92:93], v[92:93], v[240:241]
    v_pk_mul_f32 v[94:95], v[94:95], v[240:241]
    v_cvt_pk_bf16_f32 v88, v88, v89
    v_cvt_pk_bf16_f32 v89, v90, v91
    v_cvt_pk_bf16_f32 v90, v92, v93
    v_cvt_pk_bf16_f32 v91, v94, v95
    buffer_store_dwordx4 v[88:91], v254, s[24:27], s38 offen offset:3072 sc1
    s_lshl_b32 s37, s28, 11
    s_lshl_b32 s39, s30, 15
    s_add_u32 s37, s37, s39
    v_add_u32 v189, s37, v254
    s_waitcnt lgkmcnt(0)
    s_barrier
    ds_read_b64 v[176:177], v185
    ds_read_b64 v[178:179], v185 offset:128
    ds_read_b64 v[180:181], v185 offset:256
    ds_read_b64 v[182:183], v185 offset:384
    ds_read_b128 v[200:203], v189
    ds_read_b128 v[204:207], v189 offset:1024
    ds_read_b128 v[208:211], v189 offset:8192
    ds_read_b128 v[212:215], v189 offset:9216
    ds_read_b128 v[216:219], v189 offset:16384
    ds_read_b128 v[220:223], v189 offset:17408
    ds_read_b128 v[224:227], v189 offset:24576
    ds_read_b128 v[228:231], v189 offset:25600
    s_waitcnt lgkmcnt(8)
    v_min3_f32 v186, v176, v178, v180
    v_min_f32 v186, v186, v182
    v_sub_f32 v176, v186, v176
    v_exp_f32 v176, v176
    v_sub_f32 v178, v186, v178
    v_exp_f32 v178, v178
    v_sub_f32 v180, v186, v180
    v_exp_f32 v180, v180
    v_sub_f32 v182, v186, v182
    v_exp_f32 v182, v182
    v_mul_f32 v187, v176, v177
    v_fma_f32 v187, v178, v179, v187
    v_fma_f32 v187, v180, v181, v187
    v_fma_f32 v187, v182, v183, v187
    v_rcp_f32 v187, v187
    s_nop 0
    v_mul_f32 v176, v176, v187
    v_mul_f32 v178, v178, v187
    v_mul_f32 v180, v180, v187
    v_mul_f32 v182, v182, v187
    s_waitcnt lgkmcnt(0)
    v_mul_f32 v200, v200, v176
    v_fma_f32 v200, v208, v178, v200
    v_fma_f32 v200, v216, v180, v200
    v_fma_f32 v200, v224, v182, v200
    v_mul_f32 v201, v201, v176
    v_fma_f32 v201, v209, v178, v201
    v_fma_f32 v201, v217, v180, v201
    v_fma_f32 v201, v225, v182, v201
    v_mul_f32 v202, v202, v176
    v_fma_f32 v202, v210, v178, v202
    v_fma_f32 v202, v218, v180, v202
    v_fma_f32 v202, v226, v182, v202
    v_mul_f32 v203, v203, v176
    v_fma_f32 v203, v211, v178, v203
    v_fma_f32 v203, v219, v180, v203
    v_fma_f32 v203, v227, v182, v203
    v_mul_f32 v204, v204, v176
    v_fma_f32 v204, v212, v178, v204
    v_fma_f32 v204, v220, v180, v204
    v_fma_f32 v204, v228, v182, v204
    v_mul_f32 v205, v205, v176
    v_fma_f32 v205, v213, v178, v205
    v_fma_f32 v205, v221, v180, v205
    v_fma_f32 v205, v229, v182, v205
    v_mul_f32 v206, v206, v176
    v_fma_f32 v206, v214, v178, v206
    v_fma_f32 v206, v222, v180, v206
    v_fma_f32 v206, v230, v182, v206
    v_mul_f32 v207, v207, v176
    v_fma_f32 v207, v215, v178, v207
    v_fma_f32 v207, v223, v180, v207
    v_fma_f32 v207, v231, v182, v207
    v_cvt_pk_bf16_f32 v200, v200, v201
    v_cvt_pk_bf16_f32 v201, v202, v203
    v_cvt_pk_bf16_f32 v202, v204, v205
    v_cvt_pk_bf16_f32 v203, v206, v207
    s_add_u32 s37, s40, 1572864
    buffer_store_dwordx4 v[200:203], v254, s[24:27], s37 offen sc1
k1_done:
    s_endpgm
k1_rare_p0b_L:
    s_call_b64 s[34:35], k1_fix_3
    s_branch k1_ok_p0b_L
k1_rare_q0a_0:
    s_call_b64 s[34:35], k1_fix_0
    s_branch k1_ok_q0a_0
k1_rare_q0a_1:
    s_call_b64 s[34:35], k1_fix_1
    s_branch k1_ok_q0a_1
k1_rare_q0a_2:
    s_call_b64 s[34:35], k1_fix_2
    s_branch k1_ok_q0a_2
k1_rare_q0b_0:
    s_call_b64 s[34:35], k1_fix_0
    s_branch k1_ok_q0b_0
k1_rare_q0b_1:
    s_call_b64 s[34:35], k1_fix_1
    s_branch k1_ok_q0b_1
k1_rare_q0b_2:
    s_call_b64 s[34:35], k1_fix_2
    s_branch k1_ok_q0b_2
k1_rare_q0b_L:
    s_call_b64 s[34:35], k1_fix_3
    s_branch k1_ok_q0b_L
k1_rare_q1a_0:
    s_call_b64 s[34:35], k1_fix_0
    s_branch k1_ok_q1a_0
k1_rare_q1a_1:
    s_call_b64 s[34:35], k1_fix_1
    s_branch k1_ok_q1a_1
k1_rare_q1a_2:
    s_call_b64 s[34:35], k1_fix_2
    s_branch k1_ok_q1a_2
k1_rare_q1b_0:
    s_call_b64 s[34:35], k1_fix_0
    s_branch k1_ok_q1b_0
k1_rare_q1b_1:
    s_call_b64 s[34:35], k1_fix_1
    s_branch k1_ok_q1b_1
k1_rare_q1b_2:
    s_call_b64 s[34:35], k1_fix_2
    s_branch k1_ok_q1b_2
k1_rare_q1b_L:
    s_call_b64 s[34:35], k1_fix_3
    s_branch k1_ok_q1b_L
k1_rare_q2a_0:
    s_call_b64 s[34:35], k1_fix_0
    s_branch k1_ok_q2a_0
k1_rare_q2a_1:
    s_call_b64 s[34:35], k1_fix_1
    s_branch k1_ok_q2a_1
k1_rare_q2a_2:
    s_call_b64 s[34:35], k1_fix_2
    s_branch k1_ok_q2a_2
k1_rare_q2b_0:
    s_call_b64 s[34:35], k1_fix_0
    s_branch k1_ok_q2b_0
k1_rare_q2b_1:
    s_call_b64 s[34:35], k1_fix_1
    s_branch k1_ok_q2b_1
k1_rare_q2b_2:
    s_call_b64 s[34:35], k1_fix_2
    s_branch k1_ok_q2b_2
k1_rare_q2b_L:
    s_call_b64 s[34:35], k1_fix_3
    s_branch k1_ok_q2b_L
k1_rare_q3a_0:
    s_call_b64 s[34:35], k1_fix_0
    s_branch k1_ok_q3a_0
k1_rare_q3a_1:
    s_call_b64 s[34:35], k1_fix_1
    s_branch k1_ok_q3a_1
k1_rare_q3a_2:
    s_call_b64 s[34:35], k1_fix_2
    s_branch k1_ok_q3a_2
k1_rare_q3b_0:
    s_call_b64 s[34:35], k1_fix_0
    s_branch k1_ok_q3b_0
k1_rare_q3b_1:
    s_call_b64 s[34:35], k1_fix_1
    s_branch k1_ok_q3b_1
k1_rare_q3b_2:
    s_call_b64 s[34:35], k1_fix_2
    s_branch k1_ok_q3b_2
k1_rare_q3b_L:
    s_call_b64 s[34:35], k1_fix_3
    s_branch k1_ok_q3b_L
k1_fix_0:
    s_nop 7
    s_nop 7
    s_nop 3
    v_mov_b32 v254, v253
    s_nop 1
    v_permlane32_swap_b32 v253, v254
    v_max_f32 v253, v253, v254
    v_mov_b32 v254, v253
    s_nop 1
    v_permlane16_swap_b32 v253, v254
    v_max_f32 v253, v253, v254
    v_max_f32 v253, 0, v253
    v_sub_f32 v176, v176, v253
    v_sub_f32 v177, v177, v253
    v_sub_f32 v178, v178, v253
    v_sub_f32 v179, v179, v253
    v_sub_f32 v180, v180, v253
    v_sub_f32 v181, v181, v253
    v_sub_f32 v182, v182, v253
    v_sub_f32 v183, v183, v253
    v_sub_f32 v232, v232, v253
    v_sub_f32 v233, v233, v253
    v_sub_f32 v234, v234, v253
    v_sub_f32 v235, v235, v253
    v_exp_f32 v253, -v253
    s_nop 0
    v_mul_f32 v245, v245, v253
    v_mul_f32 v0, v0, v253
    v_mul_f32 v1, v1, v253
    v_mul_f32 v2, v2, v253
    v_mul_f32 v3, v3, v253
    v_mul_f32 v4, v4, v253
    v_mul_f32 v5, v5, v253
    v_mul_f32 v6, v6, v253
    v_mul_f32 v7, v7, v253
    v_mul_f32 v8, v8, v253
    v_mul_f32 v9, v9, v253
    v_mul_f32 v10, v10, v253
    v_mul_f32 v11, v11, v253
    v_mul_f32 v12, v12, v253
    v_mul_f32 v13, v13, v253
    v_mul_f32 v14, v14, v253
    v_mul_f32 v15, v15, v253
    v_mul_f32 v16, v16, v253
    v_mul_f32 v17, v17, v253
    v_mul_f32 v18, v18, v253
    v_mul_f32 v19, v19, v253
    v_mul_f32 v20, v20, v253
    v_mul_f32 v21, v21, v253
    v_mul_f32 v22, v22, v253
    v_mul_f32 v23, v23, v253
    v_mul_f32 v24, v24, v253
    v_mul_f32 v25, v25, v253
    v_mul_f32 v26, v26, v253
    v_mul_f32 v27, v27, v253
    v_mul_f32 v28, v28, v253
    v_mul_f32 v29, v29, v253
    v_mul_f32 v30, v30, v253
    v_mul_f32 v31, v31, v253
    s_nop 3
    s_setpc_b64 s[34:35]
k1_fix_1:
    s_nop 7
    s_nop 7
    s_nop 3
    v_mov_b32 v254, v253
    s_nop 1
    v_permlane32_swap_b32 v253, v254
    v_max_f32 v253, v253, v254
    v_mov_b32 v254, v253
    s_nop 1
    v_permlane16_swap_b32 v253, v254
    v_max_f32 v253, v253, v254
    v_max_f32 v253, 0, v253
    v_sub_f32 v184, v184, v253
    v_sub_f32 v185, v185, v253
    v_sub_f32 v186, v186, v253
    v_sub_f32 v187, v187, v253
    v_sub_f32 v188, v188, v253
    v_sub_f32 v189, v189, v253
    v_sub_f32 v190, v190, v253
    v_sub_f32 v191, v191, v253
    v_sub_f32 v236, v236, v253
    v_sub_f32 v237, v237, v253
    v_sub_f32 v238, v238, v253
    v_sub_f32 v239, v239, v253
    v_exp_f32 v253, -v253
    s_nop 0
    v_mul_f32 v246, v246, v253
    v_mul_f32 v32, v32, v253
    v_mul_f32 v33, v33, v253
    v_mul_f32 v34, v34, v253
    v_mul_f32 v35, v35, v253
    v_mul_f32 v36, v36, v253
    v_mul_f32 v37, v37, v253
    v_mul_f32 v38, v38, v253
    v_mul_f32 v39, v39, v253
    v_mul_f32 v40, v40, v253
    v_mul_f32 v41, v41, v253
    v_mul_f32 v42, v42, v253
    v_mul_f32 v43, v43, v253
    v_mul_f32 v44, v44, v253
    v_mul_f32 v45, v45, v253
    v_mul_f32 v46, v46, v253
    v_mul_f32 v47, v47, v253
    v_mul_f32 v48, v48, v253
    v_mul_f32 v49, v49, v253
    v_mul_f32 v50, v50, v253
    v_mul_f32 v51, v51, v253
    v_mul_f32 v52, v52, v253
    v_mul_f32 v53, v53, v253
    v_mul_f32 v54, v54, v253
    v_mul_f32 v55, v55, v253
    v_mul_f32 v56, v56, v253
    v_mul_f32 v57, v57, v253
    v_mul_f32 v58, v58, v253
    v_mul_f32 v59, v59, v253
    v_mul_f32 v60, v60, v253
    v_mul_f32 v61, v61, v253
    v_mul_f32 v62, v62, v253
    v_mul_f32 v63, v63, v253
    s_nop 3
    s_setpc_b64 s[34:35]
k1_fix_2:
    s_nop 7
    s_nop 7
    s_nop 3
    v_mov_b32 v254, v253
    s_nop 1
    v_permlane32_swap_b32 v253, v254
    v_max_f32 v253, v253, v254
    v_mov_b32 v254, v253
    s_nop 1
    v_permlane16_swap_b32 v253, v254
    v_max_f32 v253, v253, v254
    v_max_f32 v253, 0, v253
    v_sub_f32 v192, v192, v253
    v_sub_f32 v193, v193, v253
    v_sub_f32 v194, v194, v253
    v_sub_f32 v195, v195, v253
    v_sub_f32 v196, v196, v253
    v_sub_f32 v197, v197, v253
    v_sub_f32 v198, v198, v253
    v_sub_f32 v199, v199, v253
    v_sub_f32 v240, v240, v253
    v_sub_f32 v241, v241, v253
    v_sub_f32 v242, v242, v253
    v_sub_f32 v243, v243, v253
    v_exp_f32 v253, -v253
    s_nop 0
    v_mul_f32 v247, v247, v253
    v_mul_f32 v64, v64, v253
    v_mul_f32 v65, v65, v253
    v_mul_f32 v66, v66, v253
    v_mul_f32 v67, v67, v253
    v_mul_f32 v68, v68, v253
    v_mul_f32 v69, v69, v253
    v_mul_f32 v70, v70, v253
    v_mul_f32 v71, v71, v253
    v_mul_f32 v72, v72, v253
    v_mul_f32 v73, v73, v253
    v_mul_f32 v74, v74, v253
    v_mul_f32 v75, v75, v253
    v_mul_f32 v76, v76, v253
    v_mul_f32 v77, v77, v253
    v_mul_f32 v78, v78, v253
    v_mul_f32 v79, v79, v253
    v_mul_f32 v80, v80, v253
    v_mul_f32 v81, v81, v253
    v_mul_f32 v82, v82, v253
    v_mul_f32 v83, v83, v253
    v_mul_f32 v84, v84, v253
    v_mul_f32 v85, v85, v253
    v_mul_f32 v86, v86, v253
    v_mul_f32 v87, v87, v253
    v_mul_f32 v88, v88, v253
    v_mul_f32 v89, v89, v253
    v_mul_f32 v90, v90, v253
    v_mul_f32 v91, v91, v253
    v_mul_f32 v92, v92, v253
    v_mul_f32 v93, v93, v253
    v_mul_f32 v94, v94, v253
    v_mul_f32 v95, v95, v253
    s_nop 3
    s_setpc_b64 s[34:35]
k1_fix_3:
    s_nop 7
    s_nop 7
    s_nop 3
    v_mov_b32 v254, v253
    s_nop 1
    v_permlane32_swap_b32 v253, v254
    v_max_f32 v253, v253, v254
    v_mov_b32 v254, v253
    s_nop 1
    v_permlane16_swap_b32 v253, v254
    v_max_f32 v253, v253, v254
    v_max_f32 v253, s54, v253
    v_sub_f32 v176, v176, v253
    v_sub_f32 v177, v177, v253
    v_sub_f32 v178, v178, v253
    v_sub_f32 v179, v179, v253
    v_sub_f32 v180, v180, v253
    v_sub_f32 v181, v181, v253
    v_sub_f32 v182, v182, v253
    v_sub_f32 v183, v183, v253
    v_sub_f32 v244, v244, v253
    v_max_f32 v253, 0, v253
    v_exp_f32 v253, -v253
    s_nop 0
    v_mul_f32 v248, v248, v253
    v_mul_f32 v96, v96, v253
    v_mul_f32 v97, v97, v253
    v_mul_f32 v98, v98, v253
    v_mul_f32 v99, v99, v253
    v_mul_f32 v100, v100, v253
    v_mul_f32 v101, v101, v253
    v_mul_f32 v102, v102, v253
    v_mul_f32 v103, v103, v253
    v_mul_f32 v104, v104, v253
    v_mul_f32 v105, v105, v253
    v_mul_f32 v106, v106, v253
    v_mul_f32 v107, v107, v253
    v_mul_f32 v108, v108, v253
    v_mul_f32 v109, v109, v253
    v_mul_f32 v110, v110, v253
    v_mul_f32 v111, v111, v253
    v_mul_f32 v112, v112, v253
    v_mul_f32 v113, v113, v253
    v_mul_f32 v114, v114, v253
    v_mul_f32 v115, v115, v253
    v_mul_f32 v116, v116, v253
    v_mul_f32 v117, v117, v253
    v_mul_f32 v118, v118, v253
    v_mul_f32 v119, v119, v253
    v_mul_f32 v120, v120, v253
    v_mul_f32 v121, v121, v253
    v_mul_f32 v122, v122, v253
    v_mul_f32 v123, v123, v253
    v_mul_f32 v124, v124, v253
    v_mul_f32 v125, v125, v253
    v_mul_f32 v126, v126, v253
    v_mul_f32 v127, v127, v253
    s_nop 3
    s_setpc_b64 s[34:35]
.globl oproj_kernel
.p2align 8
.type oproj_kernel,@function
oproj_kernel:
    s_cmp_ge_u32 s2, 256
    s_cbranch_scc1 k2_done
    s_and_b32 s21, s2, 7
    s_lshr_b32 s22, s2, 3
    s_lshr_b32 s30, s21, 2
    s_and_b32 s21, s21, 3
    s_lshl_b32 s21, s21, 2
    s_and_b32 s23, s22, 3
    s_add_u32 s31, s21, s23
    s_lshr_b32 s32, s22, 2
    s_lshr_b32 s33, s31, 1
    s_and_b32 s34, s31, 1
    s_mul_i32 s21, s30, 40
    s_add_u32 s4, s0, s21
    s_addc_u32 s5, s1, 0
    s_load_dwordx2 s[40:41], s[4:5], 32
    s_load_dwordx2 s[42:43], s[0:1], 80
    s_load_dwordx2 s[44:45], s[0:1], 96
    v_lshrrev_b32 v140, 6, v0
    s_nop 0
    v_readfirstlane_b32 s37, v140
    v_and_b32 v135, 63, v0
    v_lshrrev_b32 v136, 4, v135
    v_and_b32 v137, 15, v135
    v_lshrrev_b32 v138, 2, v137
    v_and_b32 v139, 3, v137
    v_lshlrev_b32 v132, 4, v135
    s_and_b32 s20, s37, 3
    s_lshr_b32 s38, s37, 2
    s_sub_u32 s35, 7, s34
    s_mul_i32 s36, s34, 7
    s_waitcnt lgkmcnt(0)
    s_lshl_b32 s21, s32, 7
    s_add_u32 s8, s40, s21
    s_addc_u32 s9, s41, 0
    s_sub_u32 s10, 4194304, s21
    s_mov_b32 s11, 131072
    s_lshl_b32 s21, s30, 3
    s_add_u32 s21, s21, s33
    s_mul_i32 s21, s21, 13
    s_add_u32 s21, s21, s36
    s_lshl_b32 s21, s21, 17
    s_add_u32 s12, s44, s21
    s_addc_u32 s13, s45, 0
    s_lshl_b32 s14, s35, 17
    s_mov_b32 s15, 131072
    v_lshlrev_b32 v133, 1, v136
    v_and_b32 v140, 7, v135
    v_xor_b32 v133, v133, v140
    v_lshlrev_b32 v133, 4, v133
    v_lshrrev_b32 v140, 3, v135
    v_lshl_add_u32 v133, v140, 10, v133
    s_lshl_b32 s25, s37, 11
    s_lshl_b32 s26, s37, 14
    s_lshl_b32 s27, s20, 18
    s_lshl_b32 s21, s38, 11
    s_add_u32 s27, s27, s21
    s_add_u32 s28, s27, 131072
    s_cmp_eq_u32 s20, 3
    s_cbranch_scc1 k2_w3
    s_add_u32 m0, s25, 0
    s_nop 0
    buffer_load_dwordx4 v133, s[8:11], s26 offen lds
    buffer_load_dwordx4 v[32:35], v132, s[12:15], s27 offen
    buffer_load_dwordx4 v[36:39], v132, s[12:15], s28 offen
    s_add_u32 m0, s25, 1024
    s_add_u32 s21, s26, 8192
    buffer_load_dwordx4 v133, s[8:11], s21 offen lds
    s_add_u32 s26, s26, 131072
    buffer_load_dwordx4 v[40:43], v132, s[12:15], s27 offen offset:1024
    s_add_u32 s27, s27, 4096
    buffer_load_dwordx4 v[44:47], v132, s[12:15], s28 offen offset:1024
    s_add_u32 s28, s28, 4096
    s_add_u32 m0, s25, 16384
    s_nop 0
    buffer_load_dwordx4 v133, s[8:11], s26 offen lds
    buffer_load_dwordx4 v[48:51], v132, s[12:15], s27 offen
    buffer_load_dwordx4 v[52:55], v132, s[12:15], s28 offen
    s_add_u32 m0, s25, 17408
    s_add_u32 s21, s26, 8192
    buffer_load_dwordx4 v133, s[8:11], s21 offen lds
    s_add_u32 s26, s26, 131072
    buffer_load_dwordx4 v[56:59], v132, s[12:15], s27 offen offset:1024
    s_add_u32 s27, s27, 4096
    buffer_load_dwordx4 v[60:63], v132, s[12:15], s28 offen offset:1024
    s_add_u32 s28, s28, 4096
    s_add_u32 m0, s25, 32768
    s_nop 0
    buffer_load_dwordx4 v133, s[8:11], s26 offen lds
    buffer_load_dwordx4 v[64:67], v132, s[12:15], s27 offen
    buffer_load_dwordx4 v[68:71], v132, s[12:15], s28 offen
    s_add_u32 m0, s25, 33792
    s_add_u32 s21, s26, 8192
    buffer_load_dwordx4 v133, s[8:11], s21 offen lds
    s_add_u32 s26, s26, 131072
    buffer_load_dwordx4 v[72:75], v132, s[12:15], s27 offen offset:1024
    s_add_u32 s27, s27, 4096
    buffer_load_dwordx4 v[76:79], v132, s[12:15], s28 offen offset:1024
    s_add_u32 s28, s28, 4096
    s_mul_i32 s21, s33, 208
    s_lshl_b32 s22, s36, 4
    s_add_u32 s21, s21, s22
    s_lshl_b32 s21, s21, 11
    s_lshl_b32 s22, s30, 10
    s_add_u32 s21, s21, s22
    s_lshl_b32 s22, s32, 7
    s_add_u32 s21, s21, s22
    s_add_u32 s16, s42, s21
    s_addc_u32 s17, s43, 0
    s_lshl_b32 s21, s35, 15
    s_sub_u32 s18, s21, 1920
    s_mov_b32 s19, 131072
    v_and_b32 v140, 1, v136
    v_lshlrev_b32 v140, 1, v140
    v_lshrrev_b32 v128, 1, v138
    v_or_b32 v140, v140, v128
    v_lshlrev_b32 v128, 5, v140
    v_lshl_add_u32 v128, v139, 3, v128
    v_lshl_add_u32 v128, v138, 7, v128
    v_lshl_add_u32 v128, v136, 9, v128
    v_xor_b32 v129, 32, v128
    v_xor_b32 v130, 64, v128
    v_xor_b32 v131, 96, v128
    v_lshlrev_b32 v134, 11, v137
    v_lshl_add_u32 v134, v136, 4, v134
    s_lshl_b32 s21, s38, 13
    v_add_u32 v128, s21, v128
    v_add_u32 v129, s21, v129
    v_add_u32 v130, s21, v130
    v_add_u32 v131, s21, v131
    s_waitcnt vmcnt(12)
    s_barrier
    ds_read_b64_tr_b16 v[96:97], v128
    ds_read_b64_tr_b16 v[98:99], v128 offset:2048
    ds_read_b64_tr_b16 v[100:101], v129
    ds_read_b64_tr_b16 v[102:103], v129 offset:2048
    ds_read_b64_tr_b16 v[104:105], v130
    ds_read_b64_tr_b16 v[106:107], v130 offset:2048
    ds_read_b64_tr_b16 v[108:109], v131
    ds_read_b64_tr_b16 v[110:111], v131 offset:2048
    ds_read_b64_tr_b16 v[112:113], v128 offset:4096
    ds_read_b64_tr_b16 v[114:115], v128 offset:6144
    ds_read_b64_tr_b16 v[116:117], v129 offset:4096
    ds_read_b64_tr_b16 v[118:119], v129 offset:6144
    ds_read_b64_tr_b16 v[120:121], v130 offset:4096
    ds_read_b64_tr_b16 v[122:123], v130 offset:6144
    ds_read_b64_tr_b16 v[124:125], v131 offset:4096
    ds_read_b64_tr_b16 v[126:127], v131 offset:6144
    s_waitcnt vmcnt(6)
    s_barrier
    s_waitcnt lgkmcnt(14)
    v_mfma_f32_16x16x32_bf16 v[0:3], v[96:99], v[32:35], 0
    s_add_u32 m0, s25, 49152
    s_nop 0
    buffer_load_dwordx4 v133, s[8:11], s26 offen lds
    v_mfma_f32_16x16x32_bf16 v[16:19], v[96:99], v[36:39], 0
    ds_read_b64_tr_b16 v[96:97], v128 offset:16384
    ds_read_b64_tr_b16 v[98:99], v128 offset:18432
    s_waitcnt lgkmcnt(14)
    v_mfma_f32_16x16x32_bf16 v[4:7], v[100:103], v[32:35], 0
    v_mfma_f32_16x16x32_bf16 v[20:23], v[100:103], v[36:39], 0
    buffer_load_dwordx4 v[80:83], v132, s[12:15], s27 offen
    ds_read_b64_tr_b16 v[100:101], v129 offset:16384
    ds_read_b64_tr_b16 v[102:103], v129 offset:18432
    s_waitcnt lgkmcnt(14)
    v_mfma_f32_16x16x32_bf16 v[8:11], v[104:107], v[32:35], 0
    v_mfma_f32_16x16x32_bf16 v[24:27], v[104:107], v[36:39], 0
    buffer_load_dwordx4 v[84:87], v132, s[12:15], s28 offen
    ds_read_b64_tr_b16 v[104:105], v130 offset:16384
    ds_read_b64_tr_b16 v[106:107], v130 offset:18432
    s_waitcnt lgkmcnt(14)
    v_mfma_f32_16x16x32_bf16 v[12:15], v[108:111], v[32:35], 0
    v_mfma_f32_16x16x32_bf16 v[28:31], v[108:111], v[36:39], 0
    ds_read_b64_tr_b16 v[108:109], v131 offset:16384
    ds_read_b64_tr_b16 v[110:111], v131 offset:18432
    s_waitcnt lgkmcnt(14)
    v_mfma_f32_16x16x32_bf16 v[0:3], v[112:115], v[40:43], v[0:3]
    s_add_u32 m0, s25, 50176
    s_add_u32 s21, s26, 8192
    buffer_load_dwordx4 v133, s[8:11], s21 offen lds
    s_add_u32 s26, s26, 131072
    v_mfma_f32_16x16x32_bf16 v[16:19], v[112:115], v[44:47], v[16:19]
    ds_read_b64_tr_b16 v[112:113], v128 offset:20480
    ds_read_b64_tr_b16 v[114:115], v128 offset:22528
    s_waitcnt lgkmcnt(14)
    v_mfma_f32_16x16x32_bf16 v[4:7], v[116:119], v[40:43], v[4:7]
    v_mfma_f32_16x16x32_bf16 v[20:23], v[116:119], v[44:47], v[20:23]
    buffer_load_dwordx4 v[88:91], v132, s[12:15], s27 offen offset:1024
    s_add_u32 s27, s27, 4096
    ds_read_b64_tr_b16 v[116:117], v129 offset:20480
    ds_read_b64_tr_b16 v[118:119], v129 offset:22528
    s_waitcnt lgkmcnt(14)
    v_mfma_f32_16x16x32_bf16 v[8:11], v[120:123], v[40:43], v[8:11]
    v_mfma_f32_16x16x32_bf16 v[24:27], v[120:123], v[44:47], v[24:27]
    buffer_load_dwordx4 v[92:95], v132, s[12:15], s28 offen offset:1024
    s_add_u32 s28, s28, 4096
    ds_read_b64_tr_b16 v[120:121], v130 offset:20480
    ds_read_b64_tr_b16 v[122:123], v130 offset:22528
    s_waitcnt lgkmcnt(14)
    v_mfma_f32_16x16x32_bf16 v[12:15], v[124:127], v[40:43], v[12:15]
    v_mfma_f32_16x16x32_bf16 v[28:31], v[124:127], v[44:47], v[28:31]
    ds_read_b64_tr_b16 v[124:125], v131 offset:20480
    ds_read_b64_tr_b16 v[126:127], v131 offset:22528
    s_waitcnt vmcnt(6)
    s_barrier
    s_waitcnt lgkmcnt(14)
    v_mfma_f32_16x16x32_bf16 v[0:3], v[96:99], v[48:51], v[0:3]
    s_add_u32 m0, s25, 0
    s_nop 0
    buffer_load_dwordx4 v133, s[8:11], s26 offen lds
    v_mfma_f32_16x16x32_bf16 v[16:19], v[96:99], v[52:55], v[16:19]
    ds_read_b64_tr_b16 v[96:97], v128 offset:32768
    ds_read_b64_tr_b16 v[98:99], v128 offset:34816
    s_waitcnt lgkmcnt(14)
    v_mfma_f32_16x16x32_bf16 v[4:7], v[100:103], v[48:51], v[4:7]
    v_mfma_f32_16x16x32_bf16 v[20:23], v[100:103], v[52:55], v[20:23]
    buffer_load_dwordx4 v[32:35], v132, s[12:15], s27 offen
    ds_read_b64_tr_b16 v[100:101], v129 offset:32768
    ds_read_b64_tr_b16 v[102:103], v129 offset:34816
    s_waitcnt lgkmcnt(14)
    v_mfma_f32_16x16x32_bf16 v[8:11], v[104:107], v[48:51], v[8:11]
    v_mfma_f32_16x16x32_bf16 v[24:27], v[104:107], v[52:55], v[24:27]
    buffer_load_dwordx4 v[36:39], v132, s[12:15], s28 offen
    ds_read_b64_tr_b16 v[104:105], v130 offset:32768
    ds_read_b64_tr_b16 v[106:107], v130 offset:34816
    s_waitcnt lgkmcnt(14)
    v_mfma_f32_16x16x32_bf16 v[12:15], v[108:111], v[48:51], v[12:15]
    v_mfma_f32_16x16x32_bf16 v[28:31], v[108:111], v[52:55], v[28:31]
    ds_read_b64_tr_b16 v[108:109], v131 offset:32768
    ds_read_b64_tr_b16 v[110:111], v131 offset:34816
    s_waitcnt lgkmcnt(14)
    v_mfma_f32_16x16x32_bf16 v[0:3], v[112:115], v[56:59], v[0:3]
    s_add_u32 m0, s25, 1024
    s_add_u32 s21, s26, 8192
    buffer_load_dwordx4 v133, s[8:11], s21 offen lds
    s_add_u32 s26, s26, 131072
    v_mfma_f32_16x16x32_bf16 v[16:19], v[112:115], v[60:63], v[16:19]
    ds_read_b64_tr_b16 v[112:113], v128 offset:36864
    ds_read_b64_tr_b16 v[114:115], v128 offset:38912
    s_waitcnt lgkmcnt(14)
    v_mfma_f32_16x16x32_bf16 v[4:7], v[116:119], v[56:59], v[4:7]
    v_mfma_f32_16x16x32_bf16 v[20:23], v[116:119], v[60:63], v[20:23]
    buffer_load_dwordx4 v[40:43], v132, s[12:15], s27 offen offset:1024
    s_add_u32 s27, s27, 4096
    ds_read_b64_tr_b16 v[116:117], v129 offset:36864
    ds_read_b64_tr_b16 v[118:119], v129 offset:38912
    s_waitcnt lgkmcnt(14)
    v_mfma_f32_16x16x32_bf16 v[8:11], v[120:123], v[56:59], v[8:11]
    v_mfma_f32_16x16x32_bf16 v[24:27], v[120:123], v[60:63], v[24:27]
    buffer_load_dwordx4 v[44:47], v132, s[12:15], s28 offen offset:1024
    s_add_u32 s28, s28, 4096
    ds_read_b64_tr_b16 v[120:121], v130 offset:36864
    ds_read_b64_tr_b16 v[122:123], v130 offset:38912
    s_waitcnt lgkmcnt(14)
    v_mfma_f32_16x16x32_bf16 v[12:15], v[124:127], v[56:59], v[12:15]
    v_mfma_f32_16x16x32_bf16 v[28:31], v[124:127], v[60:63], v[28:31]
    ds_read_b64_tr_b16 v[124:125], v131 offset:36864
    ds_read_b64_tr_b16 v[126:127], v131 offset:38912
    s_waitcnt vmcnt(6)
    s_barrier
    s_waitcnt lgkmcnt(14)
    v_mfma_f32_16x16x32_bf16 v[0:3], v[96:99], v[64:67], v[0:3]
    s_add_u32 m0, s25, 16384
    s_nop 0
    buffer_load_dwordx4 v133, s[8:11], s26 offen lds
    v_mfma_f32_16x16x32_bf16 v[16:19], v[96:99], v[68:71], v[16:19]
    ds_read_b64_tr_b16 v[96:97], v128 offset:49152
    ds_read_b64_tr_b16 v[98:99], v128 offset:51200
    s_waitcnt lgkmcnt(14)
    v_mfma_f32_16x16x32_bf16 v[4:7], v[100:103], v[64:67], v[4:7]
    v_mfma_f32_16x16x32_bf16 v[20:23], v[100:103], v[68:71], v[20:23]
    buffer_load_dwordx4 v[48:51], v132, s[12:15], s27 offen
    ds_read_b64_tr_b16 v[100:101], v129 offset:49152
    ds_read_b64_tr_b16 v[102:103], v129 offset:51200
    s_waitcnt lgkmcnt(14)
    v_mfma_f32_16x16x32_bf16 v[8:11], v[104:107], v[64:67], v[8:11]
    v_mfma_f32_16x16x32_bf16 v[24:27], v[104:107], v[68:71], v[24:27]
    buffer_load_dwordx4 v[52:55], v132, s[12:15], s28 offen
    ds_read_b64_tr_b16 v[104:105], v130 offset:49152
    ds_read_b64_tr_b16 v[106:107], v130 offset:51200
    s_waitcnt lgkmcnt(14)
    v_mfma_f32_16x16x32_bf16 v[12:15], v[108:111], v[64:67], v[12:15]
    v_mfma_f32_16x16x32_bf16 v[28:31], v[108:111], v[68:71], v[28:31]
    ds_read_b64_tr_b16 v[108:109], v131 offset:49152
    ds_read_b64_tr_b16 v[110:111], v131 offset:51200
    s_waitcnt lgkmcnt(14)
    v_mfma_f32_16x16x32_bf16 v[0:3], v[112:115], v[72:75], v[0:3]
    s_add_u32 m0, s25, 17408
    s_add_u32 s21, s26, 8192
    buffer_load_dwordx4 v133, s[8:11], s21 offen lds
    s_add_u32 s26, s26, 131072
    v_mfma_f32_16x16x32_bf16 v[16:19], v[112:115], v[76:79], v[16:19]
    ds_read_b64_tr_b16 v[112:113], v128 offset:53248
    ds_read_b64_tr_b16 v[114:115], v128 offset:55296
    s_waitcnt lgkmcnt(14)
    v_mfma_f32_16x16x32_bf16 v[4:7], v[116:119], v[72:75], v[4:7]
    v_mfma_f32_16x16x32_bf16 v[20:23], v[116:119], v[76:79], v[20:23]
    buffer_load_dwordx4 v[56:59], v132, s[12:15], s27 offen offset:1024
    s_add_u32 s27, s27, 4096
    ds_read_b64_tr_b16 v[116:117], v129 offset:53248
    ds_read_b64_tr_b16 v[118:119], v129 offset:55296
    s_waitcnt lgkmcnt(14)
    v_mfma_f32_16x16x32_bf16 v[8:11], v[120:123], v[72:75], v[8:11]
    v_mfma_f32_16x16x32_bf16 v[24:27], v[120:123], v[76:79], v[24:27]
    buffer_load_dwordx4 v[60:63], v132, s[12:15], s28 offen offset:1024
    s_add_u32 s28, s28, 4096
    ds_read_b64_tr_b16 v[120:121], v130 offset:53248
    ds_read_b64_tr_b16 v[122:123], v130 offset:55296
    s_waitcnt lgkmcnt(14)
    v_mfma_f32_16x16x32_bf16 v[12:15], v[124:127], v[72:75], v[12:15]
    v_mfma_f32_16x16x32_bf16 v[28:31], v[124:127], v[76:79], v[28:31]
    ds_read_b64_tr_b16 v[124:125], v131 offset:53248
    ds_read_b64_tr_b16 v[126:127], v131 offset:55296
    s_waitcnt vmcnt(6)
    s_barrier
    s_waitcnt lgkmcnt(14)
    v_mfma_f32_16x16x32_bf16 v[0:3], v[96:99], v[80:83], v[0:3]
    s_add_u32 m0, s25, 32768
    s_nop 0
    buffer_load_dwordx4 v133, s[8:11], s26 offen lds
    v_mfma_f32_16x16x32_bf16 v[16:19], v[96:99], v[84:87], v[16:19]
    ds_read_b64_tr_b16 v[96:97], v128
    ds_read_b64_tr_b16 v[98:99], v128 offset:2048
    s_waitcnt lgkmcnt(14)
    v_mfma_f32_16x16x32_bf16 v[4:7], v[100:103], v[80:83], v[4:7]
    v_mfma_f32_16x16x32_bf16 v[20:23], v[100:103], v[84:87], v[20:23]
    buffer_load_dwordx4 v[64:67], v132, s[12:15], s27 offen
    ds_read_b64_tr_b16 v[100:101], v129
    ds_read_b64_tr_b16 v[102:103], v129 offset:2048
    s_waitcnt lgkmcnt(14)
    v_mfma_f32_16x16x32_bf16 v[8:11], v[104:107], v[80:83], v[8:11]
    v_mfma_f32_16x16x32_bf16 v[24:27], v[104:107], v[84:87], v[24:27]
    buffer_load_dwordx4 v[68:71], v132, s[12:15], s28 offen
    ds_read_b64_tr_b16 v[104:105], v130
    ds_read_b64_tr_b16 v[106:107], v130 offset:2048
    s_waitcnt lgkmcnt(14)
    v_mfma_f32_16x16x32_bf16 v[12:15], v[108:111], v[80:83], v[12:15]
    v_mfma_f32_16x16x32_bf16 v[28:31], v[108:111], v[84:87], v[28:31]
    ds_read_b64_tr_b16 v[108:109], v131
    ds_read_b64_tr_b16 v[110:111], v131 offset:2048
    s_waitcnt lgkmcnt(14)
    v_mfma_f32_16x16x32_bf16 v[0:3], v[112:115], v[88:91], v[0:3]
    s_add_u32 m0, s25, 33792
    s_add_u32 s21, s26, 8192
    buffer_load_dwordx4 v133, s[8:11], s21 offen lds
    s_add_u32 s26, s26, 131072
    v_mfma_f32_16x16x32_bf16 v[16:19], v[112:115], v[92:95], v[16:19]
    ds_read_b64_tr_b16 v[112:113], v128 offset:4096
    ds_read_b64_tr_b16 v[114:115], v128 offset:6144
    s_waitcnt lgkmcnt(14)
    v_mfma_f32_16x16x32_bf16 v[4:7], v[116:119], v[88:91], v[4:7]
    v_mfma_f32_16x16x32_bf16 v[20:23], v[116:119], v[92:95], v[20:23]
    buffer_load_dwordx4 v[72:75], v132, s[12:15], s27 offen offset:1024
    s_add_u32 s27, s27, 4096
    ds_read_b64_tr_b16 v[116:117], v129 offset:4096
    ds_read_b64_tr_b16 v[118:119], v129 offset:6144
    s_waitcnt lgkmcnt(14)
    v_mfma_f32_16x16x32_bf16 v[8:11], v[120:123], v[88:91], v[8:11]
    v_mfma_f32_16x16x32_bf16 v[24:27], v[120:123], v[92:95], v[24:27]
    buffer_load_dwordx4 v[76:79], v132, s[12:15], s28 offen offset:1024
    s_add_u32 s28, s28, 4096
    ds_read_b64_tr_b16 v[120:121], v130 offset:4096
    ds_read_b64_tr_b16 v[122:123], v130 offset:6144
    s_waitcnt lgkmcnt(14)
    v_mfma_f32_16x16x32_bf16 v[12:15], v[124:127], v[88:91], v[12:15]
    v_mfma_f32_16x16x32_bf16 v[28:31], v[124:127], v[92:95], v[28:31]
    ds_read_b64_tr_b16 v[124:125], v131 offset:4096
    ds_read_b64_tr_b16 v[126:127], v131 offset:6144
    s_mov_b32 s29, 0
k2_loopa:
    s_waitcnt vmcnt(6)
    s_barrier
    s_waitcnt lgkmcnt(14)
    v_mfma_f32_16x16x32_bf16 v[0:3], v[96:99], v[32:35], v[0:3]
    s_add_u32 m0, s25, 49152
    s_nop 0
    buffer_load_dwordx4 v133, s[8:11], s26 offen lds
    v_mfma_f32_16x16x32_bf16 v[16:19], v[96:99], v[36:39], v[16:19]
    ds_read_b64_tr_b16 v[96:97], v128 offset:16384
    ds_read_b64_tr_b16 v[98:99], v128 offset:18432
    s_waitcnt lgkmcnt(14)
    v_mfma_f32_16x16x32_bf16 v[4:7], v[100:103], v[32:35], v[4:7]
    v_mfma_f32_16x16x32_bf16 v[20:23], v[100:103], v[36:39], v[20:23]
    buffer_load_dwordx4 v[80:83], v132, s[12:15], s27 offen
    ds_read_b64_tr_b16 v[100:101], v129 offset:16384
    ds_read_b64_tr_b16 v[102:103], v129 offset:18432
    s_waitcnt lgkmcnt(14)
    v_mfma_f32_16x16x32_bf16 v[8:11], v[104:107], v[32:35], v[8:11]
    v_mfma_f32_16x16x32_bf16 v[24:27], v[104:107], v[36:39], v[24:27]
    buffer_load_dwordx4 v[84:87], v132, s[12:15], s28 offen
    ds_read_b64_tr_b16 v[104:105], v130 offset:16384
    ds_read_b64_tr_b16 v[106:107], v130 offset:18432
    s_waitcnt lgkmcnt(14)
    v_mfma_f32_16x16x32_bf16 v[12:15], v[108:111], v[32:35], v[12:15]
    v_mfma_f32_16x16x32_bf16 v[28:31], v[108:111], v[36:39], v[28:31]
    ds_read_b64_tr_b16 v[108:109], v131 offset:16384
    ds_read_b64_tr_b16 v[110:111], v131 offset:18432
    s_waitcnt lgkmcnt(14)
    v_mfma_f32_16x16x32_bf16 v[0:3], v[112:115], v[40:43], v[0:3]
    s_add_u32 m0, s25, 50176
    s_add_u32 s21, s26, 8192
    buffer_load_dwordx4 v133, s[8:11], s21 offen lds
    s_add_u32 s26, s26, 131072
    v_mfma_f32_16x16x32_bf16 v[16:19], v[112:115], v[44:47], v[16:19]
    ds_read_b64_tr_b16 v[112:113], v128 offset:20480
    ds_read_b64_tr_b16 v[114:115], v128 offset:22528
    s_waitcnt lgkmcnt(14)
    v_mfma_f32_16x16x32_bf16 v[4:7], v[116:119], v[40:43], v[4:7]
    v_mfma_f32_16x16x32_bf16 v[20:23], v[116:119], v[44:47], v[20:23]
    buffer_load_dwordx4 v[88:91], v132, s[12:15], s27 offen offset:1024
    s_add_u32 s27, s27, 4096
    ds_read_b64_tr_b16 v[116:117], v129 offset:20480
    ds_read_b64_tr_b16 v[118:119], v129 offset:22528
    s_waitcnt lgkmcnt(14)
    v_mfma_f32_16x16x32_bf16 v[8:11], v[120:123], v[40:43], v[8:11]
    v_mfma_f32_16x16x32_bf16 v[24:27], v[120:123], v[44:47], v[24:27]
    buffer_load_dwordx4 v[92:95], v132, s[12:15], s28 offen offset:1024
    s_add_u32 s28, s28, 4096
    ds_read_b64_tr_b16 v[120:121], v130 offset:20480
    ds_read_b64_tr_b16 v[122:123], v130 offset:22528
    s_waitcnt lgkmcnt(14)
    v_mfma_f32_16x16x32_bf16 v[12:15], v[124:127], v[40:43], v[12:15]
    v_mfma_f32_16x16x32_bf16 v[28:31], v[124:127], v[44:47], v[28:31]
    ds_read_b64_tr_b16 v[124:125], v131 offset:20480
    ds_read_b64_tr_b16 v[126:127], v131 offset:22528
    s_waitcnt vmcnt(6)
    s_barrier
    s_waitcnt lgkmcnt(14)
    v_mfma_f32_16x16x32_bf16 v[0:3], v[96:99], v[48:51], v[0:3]
    s_add_u32 m0, s25, 0
    s_nop 0
    buffer_load_dwordx4 v133, s[8:11], s26 offen lds
    v_mfma_f32_16x16x32_bf16 v[16:19], v[96:99], v[52:55], v[16:19]
    ds_read_b64_tr_b16 v[96:97], v128 offset:32768
    ds_read_b64_tr_b16 v[98:99], v128 offset:34816
    s_waitcnt lgkmcnt(14)
    v_mfma_f32_16x16x32_bf16 v[4:7], v[100:103], v[48:51], v[4:7]
    v_mfma_f32_16x16x32_bf16 v[20:23], v[100:103], v[52:55], v[20:23]
    buffer_load_dwordx4 v[32:35], v132, s[12:15], s27 offen
    ds_read_b64_tr_b16 v[100:101], v129 offset:32768
    ds_read_b64_tr_b16 v[102:103], v129 offset:34816
    s_waitcnt lgkmcnt(14)
    v_mfma_f32_16x16x32_bf16 v[8:11], v[104:107], v[48:51], v[8:11]
    v_mfma_f32_16x16x32_bf16 v[24:27], v[104:107], v[52:55], v[24:27]
    buffer_load_dwordx4 v[36:39], v132, s[12:15], s28 offen
    ds_read_b64_tr_b16 v[104:105], v130 offset:32768
    ds_read_b64_tr_b16 v[106:107], v130 offset:34816
    s_waitcnt lgkmcnt(14)
    v_mfma_f32_16x16x32_bf16 v[12:15], v[108:111], v[48:51], v[12:15]
    v_mfma_f32_16x16x32_bf16 v[28:31], v[108:111], v[52:55], v[28:31]
    ds_read_b64_tr_b16 v[108:109], v131 offset:32768
    ds_read_b64_tr_b16 v[110:111], v131 offset:34816
    s_waitcnt lgkmcnt(14)
    v_mfma_f32_16x16x32_bf16 v[0:3], v[112:115], v[56:59], v[0:3]
    s_add_u32 m0, s25, 1024
    s_add_u32 s21, s26, 8192
    buffer_load_dwordx4 v133, s[8:11], s21 offen lds
    s_add_u32 s26, s26, 131072
    v_mfma_f32_16x16x32_bf16 v[16:19], v[112:115], v[60:63], v[16:19]
    ds_read_b64_tr_b16 v[112:113], v128 offset:36864
    ds_read_b64_tr_b16 v[114:115], v128 offset:38912
    s_waitcnt lgkmcnt(14)
    v_mfma_f32_16x16x32_bf16 v[4:7], v[116:119], v[56:59], v[4:7]
    v_mfma_f32_16x16x32_bf16 v[20:23], v[116:119], v[60:63], v[20:23]
    buffer_load_dwordx4 v[40:43], v132, s[12:15], s27 offen offset:1024
    s_add_u32 s27, s27, 4096
    ds_read_b64_tr_b16 v[116:117], v129 offset:36864
    ds_read_b64_tr_b16 v[118:119], v129 offset:38912
    s_waitcnt lgkmcnt(14)
    v_mfma_f32_16x16x32_bf16 v[8:11], v[120:123], v[56:59], v[8:11]
    v_mfma_f32_16x16x32_bf16 v[24:27], v[120:123], v[60:63], v[24:27]
    buffer_load_dwordx4 v[44:47], v132, s[12:15], s28 offen offset:1024
    s_add_u32 s28, s28, 4096
    ds_read_b64_tr_b16 v[120:121], v130 offset:36864
    ds_read_b64_tr_b16 v[122:123], v130 offset:38912
    s_waitcnt lgkmcnt(14)
    v_mfma_f32_16x16x32_bf16 v[12:15], v[124:127], v[56:59], v[12:15]
    v_mfma_f32_16x16x32_bf16 v[28:31], v[124:127], v[60:63], v[28:31]
    ds_read_b64_tr_b16 v[124:125], v131 offset:36864
    ds_read_b64_tr_b16 v[126:127], v131 offset:38912
    s_waitcnt vmcnt(6)
    s_barrier
    s_waitcnt lgkmcnt(14)
    v_mfma_f32_16x16x32_bf16 v[0:3], v[96:99], v[64:67], v[0:3]
    s_add_u32 m0, s25, 16384
    s_nop 0
    buffer_load_dwordx4 v133, s[8:11], s26 offen lds
    v_mfma_f32_16x16x32_bf16 v[16:19], v[96:99], v[68:71], v[16:19]
    ds_read_b64_tr_b16 v[96:97], v128 offset:49152
    ds_read_b64_tr_b16 v[98:99], v128 offset:51200
    s_waitcnt lgkmcnt(14)
    v_mfma_f32_16x16x32_bf16 v[4:7], v[100:103], v[64:67], v[4:7]
    v_mfma_f32_16x16x32_bf16 v[20:23], v[100:103], v[68:71], v[20:23]
    buffer_load_dwordx4 v[48:51], v132, s[12:15], s27 offen
    ds_read_b64_tr_b16 v[100:101], v129 offset:49152
    ds_read_b64_tr_b16 v[102:103], v129 offset:51200
    s_waitcnt lgkmcnt(14)
    v_mfma_f32_16x16x32_bf16 v[8:11], v[104:107], v[64:67], v[8:11]
    v_mfma_f32_16x16x32_bf16 v[24:27], v[104:107], v[68:71], v[24:27]
    buffer_load_dwordx4 v[52:55], v132, s[12:15], s28 offen
    ds_read_b64_tr_b16 v[104:105], v130 offset:49152
    ds_read_b64_tr_b16 v[106:107], v130 offset:51200
    s_waitcnt lgkmcnt(14)
    v_mfma_f32_16x16x32_bf16 v[12:15], v[108:111], v[64:67], v[12:15]
    v_mfma_f32_16x16x32_bf16 v[28:31], v[108:111], v[68:71], v[28:31]
    ds_read_b64_tr_b16 v[108:109], v131 offset:49152
    ds_read_b64_tr_b16 v[110:111], v131 offset:51200
    s_waitcnt lgkmcnt(14)
    v_mfma_f32_16x16x32_bf16 v[0:3], v[112:115], v[72:75], v[0:3]
    s_add_u32 m0, s25, 17408
    s_add_u32 s21, s26, 8192
    buffer_load_dwordx4 v133, s[8:11], s21 offen lds
    s_add_u32 s26, s26, 131072
    v_mfma_f32_16x16x32_bf16 v[16:19], v[112:115], v[76:79], v[16:19]
    ds_read_b64_tr_b16 v[112:113], v128 offset:53248
    ds_read_b64_tr_b16 v[114:115], v128 offset:55296
    s_waitcnt lgkmcnt(14)
    v_mfma_f32_16x16x32_bf16 v[4:7], v[116:119], v[72:75], v[4:7]
    v_mfma_f32_16x16x32_bf16 v[20:23], v[116:119], v[76:79], v[20:23]
    buffer_load_dwordx4 v[56:59], v132, s[12:15], s27 offen offset:1024
    s_add_u32 s27, s27, 4096
    ds_read_b64_tr_b16 v[116:117], v129 offset:53248
    ds_read_b64_tr_b16 v[118:119], v129 offset:55296
    s_waitcnt lgkmcnt(14)
    v_mfma_f32_16x16x32_bf16 v[8:11], v[120:123], v[72:75], v[8:11]
    v_mfma_f32_16x16x32_bf16 v[24:27], v[120:123], v[76:79], v[24:27]
    buffer_load_dwordx4 v[60:63], v132, s[12:15], s28 offen offset:1024
    s_add_u32 s28, s28, 4096
    ds_read_b64_tr_b16 v[120:121], v130 offset:53248
    ds_read_b64_tr_b16 v[122:123], v130 offset:55296
    s_waitcnt lgkmcnt(14)
    v_mfma_f32_16x16x32_bf16 v[12:15], v[124:127], v[72:75], v[12:15]
    v_mfma_f32_16x16x32_bf16 v[28:31], v[124:127], v[76:79], v[28:31]
    ds_read_b64_tr_b16 v[124:125], v131 offset:53248
    ds_read_b64_tr_b16 v[126:127], v131 offset:55296
    s_waitcnt vmcnt(6)
    s_barrier
    s_waitcnt lgkmcnt(14)
    v_mfma_f32_16x16x32_bf16 v[0:3], v[96:99], v[80:83], v[0:3]
    s_add_u32 m0, s25, 32768
    s_nop 0
    buffer_load_dwordx4 v133, s[8:11], s26 offen lds
    v_mfma_f32_16x16x32_bf16 v[16:19], v[96:99], v[84:87], v[16:19]
    ds_read_b64_tr_b16 v[96:97], v128
    ds_read_b64_tr_b16 v[98:99], v128 offset:2048
    s_waitcnt lgkmcnt(14)
    v_mfma_f32_16x16x32_bf16 v[4:7], v[100:103], v[80:83], v[4:7]
    v_mfma_f32_16x16x32_bf16 v[20:23], v[100:103], v[84:87], v[20:23]
    buffer_load_dwordx4 v[64:67], v132, s[12:15], s27 offen
    ds_read_b64_tr_b16 v[100:101], v129
    ds_read_b64_tr_b16 v[102:103], v129 offset:2048
    s_waitcnt lgkmcnt(14)
    v_mfma_f32_16x16x32_bf16 v[8:11], v[104:107], v[80:83], v[8:11]
    v_mfma_f32_16x16x32_bf16 v[24:27], v[104:107], v[84:87], v[24:27]
    buffer_load_dwordx4 v[68:71], v132, s[12:15], s28 offen
    ds_read_b64_tr_b16 v[104:105], v130
    ds_read_b64_tr_b16 v[106:107], v130 offset:2048
    s_waitcnt lgkmcnt(14)
    v_mfma_f32_16x16x32_bf16 v[12:15], v[108:111], v[80:83], v[12:15]
    v_mfma_f32_16x16x32_bf16 v[28:31], v[108:111], v[84:87], v[28:31]
    ds_read_b64_tr_b16 v[108:109], v131
    ds_read_b64_tr_b16 v[110:111], v131 offset:2048
    s_waitcnt lgkmcnt(14)
    v_mfma_f32_16x16x32_bf16 v[0:3], v[112:115], v[88:91], v[0:3]
    s_add_u32 m0, s25, 33792
    s_add_u32 s21, s26, 8192
    buffer_load_dwordx4 v133, s[8:11], s21 offen lds
    s_add_u32 s26, s26, 131072
    v_mfma_f32_16x16x32_bf16 v[16:19], v[112:115], v[92:95], v[16:19]
    ds_read_b64_tr_b16 v[112:113], v128 offset:4096
    ds_read_b64_tr_b16 v[114:115], v128 offset:6144
    s_waitcnt lgkmcnt(14)
    v_mfma_f32_16x16x32_bf16 v[4:7], v[116:119], v[88:91], v[4:7]
    v_mfma_f32_16x16x32_bf16 v[20:23], v[116:119], v[92:95], v[20:23]
    buffer_load_dwordx4 v[72:75], v132, s[12:15], s27 offen offset:1024
    s_add_u32 s27, s27, 4096
    ds_read_b64_tr_b16 v[116:117], v129 offset:4096
    ds_read_b64_tr_b16 v[118:119], v129 offset:6144
    s_waitcnt lgkmcnt(14)
    v_mfma_f32_16x16x32_bf16 v[8:11], v[120:123], v[88:91], v[8:11]
    v_mfma_f32_16x16x32_bf16 v[24:27], v[120:123], v[92:95], v[24:27]
    buffer_load_dwordx4 v[76:79], v132, s[12:15], s28 offen offset:1024
    s_add_u32 s28, s28, 4096
    ds_read_b64_tr_b16 v[120:121], v130 offset:4096
    ds_read_b64_tr_b16 v[122:123], v130 offset:6144
    s_waitcnt lgkmcnt(14)
    v_mfma_f32_16x16x32_bf16 v[12:15], v[124:127], v[88:91], v[12:15]
    v_mfma_f32_16x16x32_bf16 v[28:31], v[124:127], v[92:95], v[28:31]
    ds_read_b64_tr_b16 v[124:125], v131 offset:4096
    ds_read_b64_tr_b16 v[126:127], v131 offset:6144
    s_add_u32 s29, s29, 1
    s_cmp_lt_u32 s29, 6
    s_cbranch_scc1 k2_loopa
    s_waitcnt vmcnt(6)
    s_barrier
    s_waitcnt lgkmcnt(14)
    v_mfma_f32_16x16x32_bf16 v[0:3], v[96:99], v[32:35], v[0:3]
    s_add_u32 m0, s25, 49152
    s_nop 0
    buffer_load_dwordx4 v133, s[8:11], s26 offen lds
    v_mfma_f32_16x16x32_bf16 v[16:19], v[96:99], v[36:39], v[16:19]
    ds_read_b64_tr_b16 v[96:97], v128 offset:16384
    ds_read_b64_tr_b16 v[98:99], v128 offset:18432
    s_waitcnt lgkmcnt(14)
    v_mfma_f32_16x16x32_bf16 v[4:7], v[100:103], v[32:35], v[4:7]
    v_mfma_f32_16x16x32_bf16 v[20:23], v[100:103], v[36:39], v[20:23]
    buffer_load_dwordx4 v[80:83], v132, s[12:15], s27 offen
    ds_read_b64_tr_b16 v[100:101], v129 offset:16384
    ds_read_b64_tr_b16 v[102:103], v129 offset:18432
    s_waitcnt lgkmcnt(14)
    v_mfma_f32_16x16x32_bf16 v[8:11], v[104:107], v[32:35], v[8:11]
    v_mfma_f32_16x16x32_bf16 v[24:27], v[104:107], v[36:39], v[24:27]
    buffer_load_dwordx4 v[84:87], v132, s[12:15], s28 offen
    ds_read_b64_tr_b16 v[104:105], v130 offset:16384
    ds_read_b64_tr_b16 v[106:107], v130 offset:18432
    s_waitcnt lgkmcnt(14)
    v_mfma_f32_16x16x32_bf16 v[12:15], v[108:111], v[32:35], v[12:15]
    v_mfma_f32_16x16x32_bf16 v[28:31], v[108:111], v[36:39], v[28:31]
    ds_read_b64_tr_b16 v[108:109], v131 offset:16384
    ds_read_b64_tr_b16 v[110:111], v131 offset:18432
    s_waitcnt lgkmcnt(14)
    v_mfma_f32_16x16x32_bf16 v[0:3], v[112:115], v[40:43], v[0:3]
    s_add_u32 m0, s25, 50176
    s_add_u32 s21, s26, 8192
    buffer_load_dwordx4 v133, s[8:11], s21 offen lds
    s_add_u32 s26, s26, 131072
    v_mfma_f32_16x16x32_bf16 v[16:19], v[112:115], v[44:47], v[16:19]
    ds_read_b64_tr_b16 v[112:113], v128 offset:20480
    ds_read_b64_tr_b16 v[114:115], v128 offset:22528
    s_waitcnt lgkmcnt(14)
    v_mfma_f32_16x16x32_bf16 v[4:7], v[116:119], v[40:43], v[4:7]
    v_mfma_f32_16x16x32_bf16 v[20:23], v[116:119], v[44:47], v[20:23]
    buffer_load_dwordx4 v[88:91], v132, s[12:15], s27 offen offset:1024
    s_add_u32 s27, s27, 4096
    ds_read_b64_tr_b16 v[116:117], v129 offset:20480
    ds_read_b64_tr_b16 v[118:119], v129 offset:22528
    s_waitcnt lgkmcnt(14)
    v_mfma_f32_16x16x32_bf16 v[8:11], v[120:123], v[40:43], v[8:11]
    v_mfma_f32_16x16x32_bf16 v[24:27], v[120:123], v[44:47], v[24:27]
    buffer_load_dwordx4 v[92:95], v132, s[12:15], s28 offen offset:1024
    s_add_u32 s28, s28, 4096
    ds_read_b64_tr_b16 v[120:121], v130 offset:20480
    ds_read_b64_tr_b16 v[122:123], v130 offset:22528
    s_waitcnt lgkmcnt(14)
    v_mfma_f32_16x16x32_bf16 v[12:15], v[124:127], v[40:43], v[12:15]
    v_mfma_f32_16x16x32_bf16 v[28:31], v[124:127], v[44:47], v[28:31]
    ds_read_b64_tr_b16 v[124:125], v131 offset:20480
    ds_read_b64_tr_b16 v[126:127], v131 offset:22528
    s_waitcnt vmcnt(6)
    s_barrier
    s_waitcnt lgkmcnt(14)
    v_mfma_f32_16x16x32_bf16 v[0:3], v[96:99], v[48:51], v[0:3]
    v_mfma_f32_16x16x32_bf16 v[16:19], v[96:99], v[52:55], v[16:19]
    ds_read_b64_tr_b16 v[96:97], v128 offset:32768
    ds_read_b64_tr_b16 v[98:99], v128 offset:34816
    s_waitcnt lgkmcnt(14)
    v_mfma_f32_16x16x32_bf16 v[4:7], v[100:103], v[48:51], v[4:7]
    v_mfma_f32_16x16x32_bf16 v[20:23], v[100:103], v[52:55], v[20:23]
    ds_read_b64_tr_b16 v[100:101], v129 offset:32768
    ds_read_b64_tr_b16 v[102:103], v129 offset:34816
    s_waitcnt lgkmcnt(14)
    v_mfma_f32_16x16x32_bf16 v[8:11], v[104:107], v[48:51], v[8:11]
    v_mfma_f32_16x16x32_bf16 v[24:27], v[104:107], v[52:55], v[24:27]
    ds_read_b64_tr_b16 v[104:105], v130 offset:32768
    ds_read_b64_tr_b16 v[106:107], v130 offset:34816
    s_waitcnt lgkmcnt(14)
    v_mfma_f32_16x16x32_bf16 v[12:15], v[108:111], v[48:51], v[12:15]
    v_mfma_f32_16x16x32_bf16 v[28:31], v[108:111], v[52:55], v[28:31]
    ds_read_b64_tr_b16 v[108:109], v131 offset:32768
    ds_read_b64_tr_b16 v[110:111], v131 offset:34816
    s_waitcnt lgkmcnt(14)
    v_mfma_f32_16x16x32_bf16 v[0:3], v[112:115], v[56:59], v[0:3]
    v_mfma_f32_16x16x32_bf16 v[16:19], v[112:115], v[60:63], v[16:19]
    ds_read_b64_tr_b16 v[112:113], v128 offset:36864
    ds_read_b64_tr_b16 v[114:115], v128 offset:38912
    s_waitcnt lgkmcnt(14)
    v_mfma_f32_16x16x32_bf16 v[4:7], v[116:119], v[56:59], v[4:7]
    v_mfma_f32_16x16x32_bf16 v[20:23], v[116:119], v[60:63], v[20:23]
    ds_read_b64_tr_b16 v[116:117], v129 offset:36864
    ds_read_b64_tr_b16 v[118:119], v129 offset:38912
    s_waitcnt lgkmcnt(14)
    v_mfma_f32_16x16x32_bf16 v[8:11], v[120:123], v[56:59], v[8:11]
    v_mfma_f32_16x16x32_bf16 v[24:27], v[120:123], v[60:63], v[24:27]
    ds_read_b64_tr_b16 v[120:121], v130 offset:36864
    ds_read_b64_tr_b16 v[122:123], v130 offset:38912
    s_waitcnt lgkmcnt(14)
    v_mfma_f32_16x16x32_bf16 v[12:15], v[124:127], v[56:59], v[12:15]
    v_mfma_f32_16x16x32_bf16 v[28:31], v[124:127], v[60:63], v[28:31]
    ds_read_b64_tr_b16 v[124:125], v131 offset:36864
    ds_read_b64_tr_b16 v[126:127], v131 offset:38912
    s_waitcnt vmcnt(0)
    s_barrier
    s_waitcnt lgkmcnt(14)
    v_mfma_f32_16x16x32_bf16 v[0:3], v[96:99], v[64:67], v[0:3]
    v_mfma_f32_16x16x32_bf16 v[16:19], v[96:99], v[68:71], v[16:19]
    ds_read_b64_tr_b16 v[96:97], v128 offset:49152
    ds_read_b64_tr_b16 v[98:99], v128 offset:51200
    s_waitcnt lgkmcnt(14)
    v_mfma_f32_16x16x32_bf16 v[4:7], v[100:103], v[64:67], v[4:7]
    v_mfma_f32_16x16x32_bf16 v[20:23], v[100:103], v[68:71], v[20:23]
    ds_read_b64_tr_b16 v[100:101], v129 offset:49152
    ds_read_b64_tr_b16 v[102:103], v129 offset:51200
    s_waitcnt lgkmcnt(14)
    v_mfma_f32_16x16x32_bf16 v[8:11], v[104:107], v[64:67], v[8:11]
    v_mfma_f32_16x16x32_bf16 v[24:27], v[104:107], v[68:71], v[24:27]
    ds_read_b64_tr_b16 v[104:105], v130 offset:49152
    ds_read_b64_tr_b16 v[106:107], v130 offset:51200
    s_waitcnt lgkmcnt(14)
    v_mfma_f32_16x16x32_bf16 v[12:15], v[108:111], v[64:67], v[12:15]
    v_mfma_f32_16x16x32_bf16 v[28:31], v[108:111], v[68:71], v[28:31]
    ds_read_b64_tr_b16 v[108:109], v131 offset:49152
    ds_read_b64_tr_b16 v[110:111], v131 offset:51200
    s_waitcnt lgkmcnt(14)
    v_mfma_f32_16x16x32_bf16 v[0:3], v[112:115], v[72:75], v[0:3]
    v_mfma_f32_16x16x32_bf16 v[16:19], v[112:115], v[76:79], v[16:19]
    ds_read_b64_tr_b16 v[112:113], v128 offset:53248
    ds_read_b64_tr_b16 v[114:115], v128 offset:55296
    s_waitcnt lgkmcnt(14)
    v_mfma_f32_16x16x32_bf16 v[4:7], v[116:119], v[72:75], v[4:7]
    v_mfma_f32_16x16x32_bf16 v[20:23], v[116:119], v[76:79], v[20:23]
    ds_read_b64_tr_b16 v[116:117], v129 offset:53248
    ds_read_b64_tr_b16 v[118:119], v129 offset:55296
    s_waitcnt lgkmcnt(14)
    v_mfma_f32_16x16x32_bf16 v[8:11], v[120:123], v[72:75], v[8:11]
    v_mfma_f32_16x16x32_bf16 v[24:27], v[120:123], v[76:79], v[24:27]
    ds_read_b64_tr_b16 v[120:121], v130 offset:53248
    ds_read_b64_tr_b16 v[122:123], v130 offset:55296
    s_waitcnt lgkmcnt(14)
    v_mfma_f32_16x16x32_bf16 v[12:15], v[124:127], v[72:75], v[12:15]
    v_mfma_f32_16x16x32_bf16 v[28:31], v[124:127], v[76:79], v[28:31]
    ds_read_b64_tr_b16 v[124:125], v131 offset:53248
    ds_read_b64_tr_b16 v[126:127], v131 offset:55296
    s_waitcnt lgkmcnt(14)
    v_mfma_f32_16x16x32_bf16 v[0:3], v[96:99], v[80:83], v[0:3]
    v_mfma_f32_16x16x32_bf16 v[16:19], v[96:99], v[84:87], v[16:19]
    s_waitcnt lgkmcnt(12)
    v_mfma_f32_16x16x32_bf16 v[4:7], v[100:103], v[80:83], v[4:7]
    v_mfma_f32_16x16x32_bf16 v[20:23], v[100:103], v[84:87], v[20:23]
    s_waitcnt lgkmcnt(10)
    v_mfma_f32_16x16x32_bf16 v[8:11], v[104:107], v[80:83], v[8:11]
    v_mfma_f32_16x16x32_bf16 v[24:27], v[104:107], v[84:87], v[24:27]
    s_waitcnt lgkmcnt(8)
    v_mfma_f32_16x16x32_bf16 v[12:15], v[108:111], v[80:83], v[12:15]
    v_mfma_f32_16x16x32_bf16 v[28:31], v[108:111], v[84:87], v[28:31]
    s_waitcnt lgkmcnt(6)
    v_mfma_f32_16x16x32_bf16 v[0:3], v[112:115], v[88:91], v[0:3]
    v_mfma_f32_16x16x32_bf16 v[16:19], v[112:115], v[92:95], v[16:19]
    s_waitcnt lgkmcnt(4)
    v_mfma_f32_16x16x32_bf16 v[4:7], v[116:119], v[88:91], v[4:7]
    v_mfma_f32_16x16x32_bf16 v[20:23], v[116:119], v[92:95], v[20:23]
    s_waitcnt lgkmcnt(2)
    v_mfma_f32_16x16x32_bf16 v[8:11], v[120:123], v[88:91], v[8:11]
    v_mfma_f32_16x16x32_bf16 v[24:27], v[120:123], v[92:95], v[24:27]
    s_waitcnt lgkmcnt(0)
    v_mfma_f32_16x16x32_bf16 v[12:15], v[124:127], v[88:91], v[12:15]
    v_mfma_f32_16x16x32_bf16 v[28:31], v[124:127], v[92:95], v[28:31]
    s_lshl_b32 s21, s20, 13
    v_add_u32 v135, s21, v132
    s_cmp_eq_u32 s38, 0
    s_cbranch_scc1 k2_loa
    s_nop 7
    ds_write_b128 v135, v[0:3]
    ds_write_b128 v135, v[4:7] offset:1024
    ds_write_b128 v135, v[8:11] offset:2048
    ds_write_b128 v135, v[12:15] offset:3072
    ds_write_b128 v135, v[16:19] offset:4096
    ds_write_b128 v135, v[20:23] offset:5120
    ds_write_b128 v135, v[24:27] offset:6144
    ds_write_b128 v135, v[28:31] offset:7168
    s_waitcnt lgkmcnt(0)
    s_barrier
    s_branch k2_done
k2_loa:
    s_barrier
    ds_read_b128 v[32:35], v135
    ds_read_b128 v[36:39], v135 offset:1024
    ds_read_b128 v[40:43], v135 offset:2048
    ds_read_b128 v[44:47], v135 offset:3072
    ds_read_b128 v[48:51], v135 offset:4096
    ds_read_b128 v[52:55], v135 offset:5120
    ds_read_b128 v[56:59], v135 offset:6144
    ds_read_b128 v[60:63], v135 offset:7168
    s_waitcnt lgkmcnt(0)
    s_nop 7
    v_add_f32 v0, v0, v32
    v_add_f32 v1, v1, v33
    v_add_f32 v2, v2, v34
    v_add_f32 v3, v3, v35
    v_add_f32 v4, v4, v36
    v_add_f32 v5, v5, v37
    v_add_f32 v6, v6, v38
    v_add_f32 v7, v7, v39
    v_add_f32 v8, v8, v40
    v_add_f32 v9, v9, v41
    v_add_f32 v10, v10, v42
    v_add_f32 v11, v11, v43
    v_add_f32 v12, v12, v44
    v_add_f32 v13, v13, v45
    v_add_f32 v14, v14, v46
    v_add_f32 v15, v15, v47
    v_add_f32 v16, v16, v48
    v_add_f32 v17, v17, v49
    v_add_f32 v18, v18, v50
    v_add_f32 v19, v19, v51
    v_add_f32 v20, v20, v52
    v_add_f32 v21, v21, v53
    v_add_f32 v22, v22, v54
    v_add_f32 v23, v23, v55
    v_add_f32 v24, v24, v56
    v_add_f32 v25, v25, v57
    v_add_f32 v26, v26, v58
    v_add_f32 v27, v27, v59
    v_add_f32 v28, v28, v60
    v_add_f32 v29, v29, v61
    v_add_f32 v30, v30, v62
    v_add_f32 v31, v31, v63
    s_lshl_b32 s21, s20, 16
    v_cvt_pk_bf16_f32 v0, v0, v1
    v_cvt_pk_bf16_f32 v1, v2, v3
    v_cvt_pk_bf16_f32 v2, v4, v5
    v_cvt_pk_bf16_f32 v3, v6, v7
    s_nop 0
    v_permlane32_swap_b32 v0, v2
    v_permlane32_swap_b32 v1, v3
    s_nop 0
    v_permlane16_swap_b32 v0, v2
    v_permlane16_swap_b32 v1, v3
    s_nop 1
    buffer_store_dwordx4 v[0:3], v134, s[16:19], s21 offen
    v_cvt_pk_bf16_f32 v8, v8, v9
    v_cvt_pk_bf16_f32 v9, v10, v11
    v_cvt_pk_bf16_f32 v10, v12, v13
    v_cvt_pk_bf16_f32 v11, v14, v15
    s_nop 0
    v_permlane32_swap_b32 v8, v10
    v_permlane32_swap_b32 v9, v11
    s_nop 0
    v_permlane16_swap_b32 v8, v10
    v_permlane16_swap_b32 v9, v11
    s_nop 1
    buffer_store_dwordx4 v[8:11], v134, s[16:19], s21 offen offset:64
    s_add_u32 s21, s21, 32768
    v_cvt_pk_bf16_f32 v16, v16, v17
    v_cvt_pk_bf16_f32 v17, v18, v19
    v_cvt_pk_bf16_f32 v18, v20, v21
    v_cvt_pk_bf16_f32 v19, v22, v23
    s_nop 0
    v_permlane32_swap_b32 v16, v18
    v_permlane32_swap_b32 v17, v19
    s_nop 0
    v_permlane16_swap_b32 v16, v18
    v_permlane16_swap_b32 v17, v19
    s_nop 1
    buffer_store_dwordx4 v[16:19], v134, s[16:19], s21 offen
    v_cvt_pk_bf16_f32 v24, v24, v25
    v_cvt_pk_bf16_f32 v25, v26, v27
    v_cvt_pk_bf16_f32 v26, v28, v29
    v_cvt_pk_bf16_f32 v27, v30, v31
    s_nop 0
    v_permlane32_swap_b32 v24, v26
    v_permlane32_swap_b32 v25, v27
    s_nop 0
    v_permlane16_swap_b32 v24, v26
    v_permlane16_swap_b32 v25, v27
    s_nop 1
    buffer_store_dwordx4 v[24:27], v134, s[16:19], s21 offen offset:64
    s_branch k2_end
k2_w3:
    s_cmp_eq_u32 s34, 1
    s_cbranch_scc1 k2_w3e
    s_add_u32 m0, s25, 0
    s_nop 0
    buffer_load_dwordx4 v133, s[8:11], s26 offen lds
    buffer_load_dwordx4 v[32:35], v132, s[12:15], s27 offen
    s_add_u32 m0, s25, 1024
    s_add_u32 s21, s26, 8192
    buffer_load_dwordx4 v133, s[8:11], s21 offen lds
    s_add_u32 s26, s26, 131072
    buffer_load_dwordx4 v[40:43], v132, s[12:15], s27 offen offset:1024
    s_add_u32 s27, s27, 4096
    s_add_u32 m0, s25, 16384
    s_nop 0
    buffer_load_dwordx4 v133, s[8:11], s26 offen lds
    buffer_load_dwordx4 v[48:51], v132, s[12:15], s27 offen
    s_add_u32 m0, s25, 17408
    s_add_u32 s21, s26, 8192
    buffer_load_dwordx4 v133, s[8:11], s21 offen lds
    s_add_u32 s26, s26, 131072
    buffer_load_dwordx4 v[56:59], v132, s[12:15], s27 offen offset:1024
    s_add_u32 s27, s27, 4096
    s_add_u32 m0, s25, 32768
    s_nop 0
    buffer_load_dwordx4 v133, s[8:11], s26 offen lds
    buffer_load_dwordx4 v[64:67], v132, s[12:15], s27 offen
    s_add_u32 m0, s25, 33792
    s_add_u32 s21, s26, 8192
    buffer_load_dwordx4 v133, s[8:11], s21 offen lds
    s_add_u32 s26, s26, 131072
    buffer_load_dwordx4 v[72:75], v132, s[12:15], s27 offen offset:1024
    s_add_u32 s27, s27, 4096
    s_mul_i32 s21, s33, 208
    s_lshl_b32 s22, s36, 4
    s_add_u32 s21, s21, s22
    s_lshl_b32 s21, s21, 11
    s_lshl_b32 s22, s30, 10
    s_add_u32 s21, s21, s22
    s_lshl_b32 s22, s32, 7
    s_add_u32 s21, s21, s22
    s_add_u32 s16, s42, s21
    s_addc_u32 s17, s43, 0
    s_lshl_b32 s21, s35, 15
    s_sub_u32 s18, s21, 1920
    s_mov_b32 s19, 131072
    v_and_b32 v140, 1, v136
    v_lshlrev_b32 v140, 1, v140
    v_lshrrev_b32 v128, 1, v138
    v_or_b32 v140, v140, v128
    v_lshlrev_b32 v128, 5, v140
    v_lshl_add_u32 v128, v139, 3, v128
    v_lshl_add_u32 v128, v138, 7, v128
    v_lshl_add_u32 v128, v136, 9, v128
    v_xor_b32 v129, 32, v128
    v_xor_b32 v130, 64, v128
    v_xor_b32 v131, 96, v128
    v_lshlrev_b32 v134, 11, v137
    v_lshl_add_u32 v134, v136, 4, v134
    s_lshl_b32 s21, s38, 13
    v_add_u32 v128, s21, v128
    v_add_u32 v129, s21, v129
    v_add_u32 v130, s21, v130
    v_add_u32 v131, s21, v131
    s_waitcnt vmcnt(8)
    s_barrier
    ds_read_b64_tr_b16 v[96:97], v128
    ds_read_b64_tr_b16 v[98:99], v128 offset:2048
    ds_read_b64_tr_b16 v[100:101], v129
    ds_read_b64_tr_b16 v[102:103], v129 offset:2048
    ds_read_b64_tr_b16 v[104:105], v130
    ds_read_b64_tr_b16 v[106:107], v130 offset:2048
    ds_read_b64_tr_b16 v[108:109], v131
    ds_read_b64_tr_b16 v[110:111], v131 offset:2048
    ds_read_b64_tr_b16 v[112:113], v128 offset:4096
    ds_read_b64_tr_b16 v[114:115], v128 offset:6144
    ds_read_b64_tr_b16 v[116:117], v129 offset:4096
    ds_read_b64_tr_b16 v[118:119], v129 offset:6144
    ds_read_b64_tr_b16 v[120:121], v130 offset:4096
    ds_read_b64_tr_b16 v[122:123], v130 offset:6144
    ds_read_b64_tr_b16 v[124:125], v131 offset:4096
    ds_read_b64_tr_b16 v[126:127], v131 offset:6144
    s_waitcnt vmcnt(4)
    s_barrier
    s_waitcnt lgkmcnt(14)
    v_mfma_f32_16x16x32_bf16 v[0:3], v[96:99], v[32:35], 0
    s_add_u32 m0, s25, 49152
    s_nop 0
    buffer_load_dwordx4 v133, s[8:11], s26 offen lds
    ds_read_b64_tr_b16 v[96:97], v128 offset:16384
    ds_read_b64_tr_b16 v[98:99], v128 offset:18432
    s_waitcnt lgkmcnt(14)
    v_mfma_f32_16x16x32_bf16 v[4:7], v[100:103], v[32:35], 0
    ds_read_b64_tr_b16 v[100:101], v129 offset:16384
    ds_read_b64_tr_b16 v[102:103], v129 offset:18432
    s_waitcnt lgkmcnt(14)
    v_mfma_f32_16x16x32_bf16 v[8:11], v[104:107], v[32:35], 0
    buffer_load_dwordx4 v[80:83], v132, s[12:15], s27 offen
    ds_read_b64_tr_b16 v[104:105], v130 offset:16384
    ds_read_b64_tr_b16 v[106:107], v130 offset:18432
    s_waitcnt lgkmcnt(14)
    v_mfma_f32_16x16x32_bf16 v[12:15], v[108:111], v[32:35], 0
    ds_read_b64_tr_b16 v[108:109], v131 offset:16384
    ds_read_b64_tr_b16 v[110:111], v131 offset:18432
    s_waitcnt lgkmcnt(14)
    v_mfma_f32_16x16x32_bf16 v[0:3], v[112:115], v[40:43], v[0:3]
    s_add_u32 m0, s25, 50176
    s_add_u32 s21, s26, 8192
    buffer_load_dwordx4 v133, s[8:11], s21 offen lds
    s_add_u32 s26, s26, 131072
    ds_read_b64_tr_b16 v[112:113], v128 offset:20480
    ds_read_b64_tr_b16 v[114:115], v128 offset:22528
    s_waitcnt lgkmcnt(14)
    v_mfma_f32_16x16x32_bf16 v[4:7], v[116:119], v[40:43], v[4:7]
    ds_read_b64_tr_b16 v[116:117], v129 offset:20480
    ds_read_b64_tr_b16 v[118:119], v129 offset:22528
    s_waitcnt lgkmcnt(14)
    v_mfma_f32_16x16x32_bf16 v[8:11], v[120:123], v[40:43], v[8:11]
    buffer_load_dwordx4 v[88:91], v132, s[12:15], s27 offen offset:1024
    s_add_u32 s27, s27, 4096
    ds_read_b64_tr_b16 v[120:121], v130 offset:20480
    ds_read_b64_tr_b16 v[122:123], v130 offset:22528
    s_waitcnt lgkmcnt(14)
    v_mfma_f32_16x16x32_bf16 v[12:15], v[124:127], v[40:43], v[12:15]
    ds_read_b64_tr_b16 v[124:125], v131 offset:20480
    ds_read_b64_tr_b16 v[126:127], v131 offset:22528
    s_waitcnt vmcnt(4)
    s_barrier
    s_waitcnt lgkmcnt(14)
    v_mfma_f32_16x16x32_bf16 v[0:3], v[96:99], v[48:51], v[0:3]
    s_add_u32 m0, s25, 0
    s_nop 0
    buffer_load_dwordx4 v133, s[8:11], s26 offen lds
    ds_read_b64_tr_b16 v[96:97], v128 offset:32768
    ds_read_b64_tr_b16 v[98:99], v128 offset:34816
    s_waitcnt lgkmcnt(14)
    v_mfma_f32_16x16x32_bf16 v[4:7], v[100:103], v[48:51], v[4:7]
    ds_read_b64_tr_b16 v[100:101], v129 offset:32768
    ds_read_b64_tr_b16 v[102:103], v129 offset:34816
    s_waitcnt lgkmcnt(14)
    v_mfma_f32_16x16x32_bf16 v[8:11], v[104:107], v[48:51], v[8:11]
    buffer_load_dwordx4 v[32:35], v132, s[12:15], s27 offen
    ds_read_b64_tr_b16 v[104:105], v130 offset:32768
    ds_read_b64_tr_b16 v[106:107], v130 offset:34816
    s_waitcnt lgkmcnt(14)
    v_mfma_f32_16x16x32_bf16 v[12:15], v[108:111], v[48:51], v[12:15]
    ds_read_b64_tr_b16 v[108:109], v131 offset:32768
    ds_read_b64_tr_b16 v[110:111], v131 offset:34816
    s_waitcnt lgkmcnt(14)
    v_mfma_f32_16x16x32_bf16 v[0:3], v[112:115], v[56:59], v[0:3]
    s_add_u32 m0, s25, 1024
    s_add_u32 s21, s26, 8192
    buffer_load_dwordx4 v133, s[8:11], s21 offen lds
    s_add_u32 s26, s26, 131072
    ds_read_b64_tr_b16 v[112:113], v128 offset:36864
    ds_read_b64_tr_b16 v[114:115], v128 offset:38912
    s_waitcnt lgkmcnt(14)
    v_mfma_f32_16x16x32_bf16 v[4:7], v[116:119], v[56:59], v[4:7]
    ds_read_b64_tr_b16 v[116:117], v129 offset:36864
    ds_read_b64_tr_b16 v[118:119], v129 offset:38912
    s_waitcnt lgkmcnt(14)
    v_mfma_f32_16x16x32_bf16 v[8:11], v[120:123], v[56:59], v[8:11]
    buffer_load_dwordx4 v[40:43], v132, s[12:15], s27 offen offset:1024
    s_add_u32 s27, s27, 4096
    ds_read_b64_tr_b16 v[120:121], v130 offset:36864
    ds_read_b64_tr_b16 v[122:123], v130 offset:38912
    s_waitcnt lgkmcnt(14)
    v_mfma_f32_16x16x32_bf16 v[12:15], v[124:127], v[56:59], v[12:15]
    ds_read_b64_tr_b16 v[124:125], v131 offset:36864
    ds_read_b64_tr_b16 v[126:127], v131 offset:38912
    s_waitcnt vmcnt(4)
    s_barrier
    s_waitcnt lgkmcnt(14)
    v_mfma_f32_16x16x32_bf16 v[0:3], v[96:99], v[64:67], v[0:3]
    s_add_u32 m0, s25, 16384
    s_nop 0
    buffer_load_dwordx4 v133, s[8:11], s26 offen lds
    ds_read_b64_tr_b16 v[96:97], v128 offset:49152
    ds_read_b64_tr_b16 v[98:99], v128 offset:51200
    s_waitcnt lgkmcnt(14)
    v_mfma_f32_16x16x32_bf16 v[4:7], v[100:103], v[64:67], v[4:7]
    ds_read_b64_tr_b16 v[100:101], v129 offset:49152
    ds_read_b64_tr_b16 v[102:103], v129 offset:51200
    s_waitcnt lgkmcnt(14)
    v_mfma_f32_16x16x32_bf16 v[8:11], v[104:107], v[64:67], v[8:11]
    buffer_load_dwordx4 v[48:51], v132, s[12:15], s27 offen
    ds_read_b64_tr_b16 v[104:105], v130 offset:49152
    ds_read_b64_tr_b16 v[106:107], v130 offset:51200
    s_waitcnt lgkmcnt(14)
    v_mfma_f32_16x16x32_bf16 v[12:15], v[108:111], v[64:67], v[12:15]
    ds_read_b64_tr_b16 v[108:109], v131 offset:49152
    ds_read_b64_tr_b16 v[110:111], v131 offset:51200
    s_waitcnt lgkmcnt(14)
    v_mfma_f32_16x16x32_bf16 v[0:3], v[112:115], v[72:75], v[0:3]
    s_add_u32 m0, s25, 17408
    s_add_u32 s21, s26, 8192
    buffer_load_dwordx4 v133, s[8:11], s21 offen lds
    s_add_u32 s26, s26, 131072
    ds_read_b64_tr_b16 v[112:113], v128 offset:53248
    ds_read_b64_tr_b16 v[114:115], v128 offset:55296
    s_waitcnt lgkmcnt(14)
    v_mfma_f32_16x16x32_bf16 v[4:7], v[116:119], v[72:75], v[4:7]
    ds_read_b64_tr_b16 v[116:117], v129 offset:53248
    ds_read_b64_tr_b16 v[118:119], v129 offset:55296
    s_waitcnt lgkmcnt(14)
    v_mfma_f32_16x16x32_bf16 v[8:11], v[120:123], v[72:75], v[8:11]
    buffer_load_dwordx4 v[56:59], v132, s[12:15], s27 offen offset:1024
    s_add_u32 s27, s27, 4096
    ds_read_b64_tr_b16 v[120:121], v130 offset:53248
    ds_read_b64_tr_b16 v[122:123], v130 offset:55296
    s_waitcnt lgkmcnt(14)
    v_mfma_f32_16x16x32_bf16 v[12:15], v[124:127], v[72:75], v[12:15]
    ds_read_b64_tr_b16 v[124:125], v131 offset:53248
    ds_read_b64_tr_b16 v[126:127], v131 offset:55296
    s_waitcnt vmcnt(4)
    s_barrier
    s_waitcnt lgkmcnt(14)
    v_mfma_f32_16x16x32_bf16 v[0:3], v[96:99], v[80:83], v[0:3]
    s_add_u32 m0, s25, 32768
    s_nop 0
    buffer_load_dwordx4 v133, s[8:11], s26 offen lds
    ds_read_b64_tr_b16 v[96:97], v128
    ds_read_b64_tr_b16 v[98:99], v128 offset:2048
    s_waitcnt lgkmcnt(14)
    v_mfma_f32_16x16x32_bf16 v[4:7], v[100:103], v[80:83], v[4:7]
    ds_read_b64_tr_b16 v[100:101], v129
    ds_read_b64_tr_b16 v[102:103], v129 offset:2048
    s_waitcnt lgkmcnt(14)
    v_mfma_f32_16x16x32_bf16 v[8:11], v[104:107], v[80:83], v[8:11]
    buffer_load_dwordx4 v[64:67], v132, s[12:15], s27 offen
    ds_read_b64_tr_b16 v[104:105], v130
    ds_read_b64_tr_b16 v[106:107], v130 offset:2048
    s_waitcnt lgkmcnt(14)
    v_mfma_f32_16x16x32_bf16 v[12:15], v[108:111], v[80:83], v[12:15]
    ds_read_b64_tr_b16 v[108:109], v131
    ds_read_b64_tr_b16 v[110:111], v131 offset:2048
    s_waitcnt lgkmcnt(14)
    v_mfma_f32_16x16x32_bf16 v[0:3], v[112:115], v[88:91], v[0:3]
    s_add_u32 m0, s25, 33792
    s_add_u32 s21, s26, 8192
    buffer_load_dwordx4 v133, s[8:11], s21 offen lds
    s_add_u32 s26, s26, 131072
    ds_read_b64_tr_b16 v[112:113], v128 offset:4096
    ds_read_b64_tr_b16 v[114:115], v128 offset:6144
    s_waitcnt lgkmcnt(14)
    v_mfma_f32_16x16x32_bf16 v[4:7], v[116:119], v[88:91], v[4:7]
    ds_read_b64_tr_b16 v[116:117], v129 offset:4096
    ds_read_b64_tr_b16 v[118:119], v129 offset:6144
    s_waitcnt lgkmcnt(14)
    v_mfma_f32_16x16x32_bf16 v[8:11], v[120:123], v[88:91], v[8:11]
    buffer_load_dwordx4 v[72:75], v132, s[12:15], s27 offen offset:1024
    s_add_u32 s27, s27, 4096
    ds_read_b64_tr_b16 v[120:121], v130 offset:4096
    ds_read_b64_tr_b16 v[122:123], v130 offset:6144
    s_waitcnt lgkmcnt(14)
    v_mfma_f32_16x16x32_bf16 v[12:15], v[124:127], v[88:91], v[12:15]
    ds_read_b64_tr_b16 v[124:125], v131 offset:4096
    ds_read_b64_tr_b16 v[126:127], v131 offset:6144
    s_mov_b32 s29, 0
k2_loopb:
    s_waitcnt vmcnt(4)
    s_barrier
    s_waitcnt lgkmcnt(14)
    v_mfma_f32_16x16x32_bf16 v[0:3], v[96:99], v[32:35], v[0:3]
    s_add_u32 m0, s25, 49152
    s_nop 0
    buffer_load_dwordx4 v133, s[8:11], s26 offen lds
    ds_read_b64_tr_b16 v[96:97], v128 offset:16384
    ds_read_b64_tr_b16 v[98:99], v128 offset:18432
    s_waitcnt lgkmcnt(14)
    v_mfma_f32_16x16x32_bf16 v[4:7], v[100:103], v[32:35], v[4:7]
    ds_read_b64_tr_b16 v[100:101], v129 offset:16384
    ds_read_b64_tr_b16 v[102:103], v129 offset:18432
    s_waitcnt lgkmcnt(14)
    v_mfma_f32_16x16x32_bf16 v[8:11], v[104:107], v[32:35], v[8:11]
    buffer_load_dwordx4 v[80:83], v132, s[12:15], s27 offen
    ds_read_b64_tr_b16 v[104:105], v130 offset:16384
    ds_read_b64_tr_b16 v[106:107], v130 offset:18432
    s_waitcnt lgkmcnt(14)
    v_mfma_f32_16x16x32_bf16 v[12:15], v[108:111], v[32:35], v[12:15]
    ds_read_b64_tr_b16 v[108:109], v131 offset:16384
    ds_read_b64_tr_b16 v[110:111], v131 offset:18432
    s_waitcnt lgkmcnt(14)
    v_mfma_f32_16x16x32_bf16 v[0:3], v[112:115], v[40:43], v[0:3]
    s_add_u32 m0, s25, 50176
    s_add_u32 s21, s26, 8192
    buffer_load_dwordx4 v133, s[8:11], s21 offen lds
    s_add_u32 s26, s26, 131072
    ds_read_b64_tr_b16 v[112:113], v128 offset:20480
    ds_read_b64_tr_b16 v[114:115], v128 offset:22528
    s_waitcnt lgkmcnt(14)
    v_mfma_f32_16x16x32_bf16 v[4:7], v[116:119], v[40:43], v[4:7]
    ds_read_b64_tr_b16 v[116:117], v129 offset:20480
    ds_read_b64_tr_b16 v[118:119], v129 offset:22528
    s_waitcnt lgkmcnt(14)
    v_mfma_f32_16x16x32_bf16 v[8:11], v[120:123], v[40:43], v[8:11]
    buffer_load_dwordx4 v[88:91], v132, s[12:15], s27 offen offset:1024
    s_add_u32 s27, s27, 4096
    ds_read_b64_tr_b16 v[120:121], v130 offset:20480
    ds_read_b64_tr_b16 v[122:123], v130 offset:22528
    s_waitcnt lgkmcnt(14)
    v_mfma_f32_16x16x32_bf16 v[12:15], v[124:127], v[40:43], v[12:15]
    ds_read_b64_tr_b16 v[124:125], v131 offset:20480
    ds_read_b64_tr_b16 v[126:127], v131 offset:22528
    s_waitcnt vmcnt(4)
    s_barrier
    s_waitcnt lgkmcnt(14)
    v_mfma_f32_16x16x32_bf16 v[0:3], v[96:99], v[48:51], v[0:3]
    s_add_u32 m0, s25, 0
    s_nop 0
    buffer_load_dwordx4 v133, s[8:11], s26 offen lds
    ds_read_b64_tr_b16 v[96:97], v128 offset:32768
    ds_read_b64_tr_b16 v[98:99], v128 offset:34816
    s_waitcnt lgkmcnt(14)
    v_mfma_f32_16x16x32_bf16 v[4:7], v[100:103], v[48:51], v[4:7]
    ds_read_b64_tr_b16 v[100:101], v129 offset:32768
    ds_read_b64_tr_b16 v[102:103], v129 offset:34816
    s_waitcnt lgkmcnt(14)
    v_mfma_f32_16x16x32_bf16 v[8:11], v[104:107], v[48:51], v[8:11]
    buffer_load_dwordx4 v[32:35], v132, s[12:15], s27 offen
    ds_read_b64_tr_b16 v[104:105], v130 offset:32768
    ds_read_b64_tr_b16 v[106:107], v130 offset:34816
    s_waitcnt lgkmcnt(14)
    v_mfma_f32_16x16x32_bf16 v[12:15], v[108:111], v[48:51], v[12:15]
    ds_read_b64_tr_b16 v[108:109], v131 offset:32768
    ds_read_b64_tr_b16 v[110:111], v131 offset:34816
    s_waitcnt lgkmcnt(14)
    v_mfma_f32_16x16x32_bf16 v[0:3], v[112:115], v[56:59], v[0:3]
    s_add_u32 m0, s25, 1024
    s_add_u32 s21, s26, 8192
    buffer_load_dwordx4 v133, s[8:11], s21 offen lds
    s_add_u32 s26, s26, 131072
    ds_read_b64_tr_b16 v[112:113], v128 offset:36864
    ds_read_b64_tr_b16 v[114:115], v128 offset:38912
    s_waitcnt lgkmcnt(14)
    v_mfma_f32_16x16x32_bf16 v[4:7], v[116:119], v[56:59], v[4:7]
    ds_read_b64_tr_b16 v[116:117], v129 offset:36864
    ds_read_b64_tr_b16 v[118:119], v129 offset:38912
    s_waitcnt lgkmcnt(14)
    v_mfma_f32_16x16x32_bf16 v[8:11], v[120:123], v[56:59], v[8:11]
    buffer_load_dwordx4 v[40:43], v132, s[12:15], s27 offen offset:1024
    s_add_u32 s27, s27, 4096
    ds_read_b64_tr_b16 v[120:121], v130 offset:36864
    ds_read_b64_tr_b16 v[122:123], v130 offset:38912
    s_waitcnt lgkmcnt(14)
    v_mfma_f32_16x16x32_bf16 v[12:15], v[124:127], v[56:59], v[12:15]
    ds_read_b64_tr_b16 v[124:125], v131 offset:36864
    ds_read_b64_tr_b16 v[126:127], v131 offset:38912
    s_waitcnt vmcnt(4)
    s_barrier
    s_waitcnt lgkmcnt(14)
    v_mfma_f32_16x16x32_bf16 v[0:3], v[96:99], v[64:67], v[0:3]
    s_add_u32 m0, s25, 16384
    s_nop 0
    buffer_load_dwordx4 v133, s[8:11], s26 offen lds
    ds_read_b64_tr_b16 v[96:97], v128 offset:49152
    ds_read_b64_tr_b16 v[98:99], v128 offset:51200
    s_waitcnt lgkmcnt(14)
    v_mfma_f32_16x16x32_bf16 v[4:7], v[100:103], v[64:67], v[4:7]
    ds_read_b64_tr_b16 v[100:101], v129 offset:49152
    ds_read_b64_tr_b16 v[102:103], v129 offset:51200
    s_waitcnt lgkmcnt(14)
    v_mfma_f32_16x16x32_bf16 v[8:11], v[104:107], v[64:67], v[8:11]
    buffer_load_dwordx4 v[48:51], v132, s[12:15], s27 offen
    ds_read_b64_tr_b16 v[104:105], v130 offset:49152
    ds_read_b64_tr_b16 v[106:107], v130 offset:51200
    s_waitcnt lgkmcnt(14)
    v_mfma_f32_16x16x32_bf16 v[12:15], v[108:111], v[64:67], v[12:15]
    ds_read_b64_tr_b16 v[108:109], v131 offset:49152
    ds_read_b64_tr_b16 v[110:111], v131 offset:51200
    s_waitcnt lgkmcnt(14)
    v_mfma_f32_16x16x32_bf16 v[0:3], v[112:115], v[72:75], v[0:3]
    s_add_u32 m0, s25, 17408
    s_add_u32 s21, s26, 8192
    buffer_load_dwordx4 v133, s[8:11], s21 offen lds
    s_add_u32 s26, s26, 131072
    ds_read_b64_tr_b16 v[112:113], v128 offset:53248
    ds_read_b64_tr_b16 v[114:115], v128 offset:55296
    s_waitcnt lgkmcnt(14)
    v_mfma_f32_16x16x32_bf16 v[4:7], v[116:119], v[72:75], v[4:7]
    ds_read_b64_tr_b16 v[116:117], v129 offset:53248
    ds_read_b64_tr_b16 v[118:119], v129 offset:55296
    s_waitcnt lgkmcnt(14)
    v_mfma_f32_16x16x32_bf16 v[8:11], v[120:123], v[72:75], v[8:11]
    buffer_load_dwordx4 v[56:59], v132, s[12:15], s27 offen offset:1024
    s_add_u32 s27, s27, 4096
    ds_read_b64_tr_b16 v[120:121], v130 offset:53248
    ds_read_b64_tr_b16 v[122:123], v130 offset:55296
    s_waitcnt lgkmcnt(14)
    v_mfma_f32_16x16x32_bf16 v[12:15], v[124:127], v[72:75], v[12:15]
    ds_read_b64_tr_b16 v[124:125], v131 offset:53248
    ds_read_b64_tr_b16 v[126:127], v131 offset:55296
    s_waitcnt vmcnt(4)
    s_barrier
    s_waitcnt lgkmcnt(14)
    v_mfma_f32_16x16x32_bf16 v[0:3], v[96:99], v[80:83], v[0:3]
    s_add_u32 m0, s25, 32768
    s_nop 0
    buffer_load_dwordx4 v133, s[8:11], s26 offen lds
    ds_read_b64_tr_b16 v[96:97], v128
    ds_read_b64_tr_b16 v[98:99], v128 offset:2048
    s_waitcnt lgkmcnt(14)
    v_mfma_f32_16x16x32_bf16 v[4:7], v[100:103], v[80:83], v[4:7]
    ds_read_b64_tr_b16 v[100:101], v129
    ds_read_b64_tr_b16 v[102:103], v129 offset:2048
    s_waitcnt lgkmcnt(14)
    v_mfma_f32_16x16x32_bf16 v[8:11], v[104:107], v[80:83], v[8:11]
    buffer_load_dwordx4 v[64:67], v132, s[12:15], s27 offen
    ds_read_b64_tr_b16 v[104:105], v130
    ds_read_b64_tr_b16 v[106:107], v130 offset:2048
    s_waitcnt lgkmcnt(14)
    v_mfma_f32_16x16x32_bf16 v[12:15], v[108:111], v[80:83], v[12:15]
    ds_read_b64_tr_b16 v[108:109], v131
    ds_read_b64_tr_b16 v[110:111], v131 offset:2048
    s_waitcnt lgkmcnt(14)
    v_mfma_f32_16x16x32_bf16 v[0:3], v[112:115], v[88:91], v[0:3]
    s_add_u32 m0, s25, 33792
    s_add_u32 s21, s26, 8192
    buffer_load_dwordx4 v133, s[8:11], s21 offen lds
    s_add_u32 s26, s26, 131072
    ds_read_b64_tr_b16 v[112:113], v128 offset:4096
    ds_read_b64_tr_b16 v[114:115], v128 offset:6144
    s_waitcnt lgkmcnt(14)
    v_mfma_f32_16x16x32_bf16 v[4:7], v[116:119], v[88:91], v[4:7]
    ds_read_b64_tr_b16 v[116:117], v129 offset:4096
    ds_read_b64_tr_b16 v[118:119], v129 offset:6144
    s_waitcnt lgkmcnt(14)
    v_mfma_f32_16x16x32_bf16 v[8:11], v[120:123], v[88:91], v[8:11]
    buffer_load_dwordx4 v[72:75], v132, s[12:15], s27 offen offset:1024
    s_add_u32 s27, s27, 4096
    ds_read_b64_tr_b16 v[120:121], v130 offset:4096
    ds_read_b64_tr_b16 v[122:123], v130 offset:6144
    s_waitcnt lgkmcnt(14)
    v_mfma_f32_16x16x32_bf16 v[12:15], v[124:127], v[88:91], v[12:15]
    ds_read_b64_tr_b16 v[124:125], v131 offset:4096
    ds_read_b64_tr_b16 v[126:127], v131 offset:6144
    s_add_u32 s29, s29, 1
    s_cmp_lt_u32 s29, 6
    s_cbranch_scc1 k2_loopb
    s_waitcnt vmcnt(4)
    s_barrier
    s_waitcnt lgkmcnt(14)
    v_mfma_f32_16x16x32_bf16 v[0:3], v[96:99], v[32:35], v[0:3]
    s_add_u32 m0, s25, 49152
    s_nop 0
    buffer_load_dwordx4 v133, s[8:11], s26 offen lds
    ds_read_b64_tr_b16 v[96:97], v128 offset:16384
    ds_read_b64_tr_b16 v[98:99], v128 offset:18432
    s_waitcnt lgkmcnt(14)
    v_mfma_f32_16x16x32_bf16 v[4:7], v[100:103], v[32:35], v[4:7]
    ds_read_b64_tr_b16 v[100:101], v129 offset:16384
    ds_read_b64_tr_b16 v[102:103], v129 offset:18432
    s_waitcnt lgkmcnt(14)
    v_mfma_f32_16x16x32_bf16 v[8:11], v[104:107], v[32:35], v[8:11]
    buffer_load_dwordx4 v[80:83], v132, s[12:15], s27 offen
    ds_read_b64_tr_b16 v[104:105], v130 offset:16384
    ds_read_b64_tr_b16 v[106:107], v130 offset:18432
    s_waitcnt lgkmcnt(14)
    v_mfma_f32_16x16x32_bf16 v[12:15], v[108:111], v[32:35], v[12:15]
    ds_read_b64_tr_b16 v[108:109], v131 offset:16384
    ds_read_b64_tr_b16 v[110:111], v131 offset:18432
    s_waitcnt lgkmcnt(14)
    v_mfma_f32_16x16x32_bf16 v[0:3], v[112:115], v[40:43], v[0:3]
    s_add_u32 m0, s25, 50176
    s_add_u32 s21, s26, 8192
    buffer_load_dwordx4 v133, s[8:11], s21 offen lds
    s_add_u32 s26, s26, 131072
    ds_read_b64_tr_b16 v[112:113], v128 offset:20480
    ds_read_b64_tr_b16 v[114:115], v128 offset:22528
    s_waitcnt lgkmcnt(14)
    v_mfma_f32_16x16x32_bf16 v[4:7], v[116:119], v[40:43], v[4:7]
    ds_read_b64_tr_b16 v[116:117], v129 offset:20480
    ds_read_b64_tr_b16 v[118:119], v129 offset:22528
    s_waitcnt lgkmcnt(14)
    v_mfma_f32_16x16x32_bf16 v[8:11], v[120:123], v[40:43], v[8:11]
    buffer_load_dwordx4 v[88:91], v132, s[12:15], s27 offen offset:1024
    s_add_u32 s27, s27, 4096
    ds_read_b64_tr_b16 v[120:121], v130 offset:20480
    ds_read_b64_tr_b16 v[122:123], v130 offset:22528
    s_waitcnt lgkmcnt(14)
    v_mfma_f32_16x16x32_bf16 v[12:15], v[124:127], v[40:43], v[12:15]
    ds_read_b64_tr_b16 v[124:125], v131 offset:20480
    ds_read_b64_tr_b16 v[126:127], v131 offset:22528
    s_waitcnt vmcnt(4)
    s_barrier
    s_waitcnt lgkmcnt(14)
    v_mfma_f32_16x16x32_bf16 v[0:3], v[96:99], v[48:51], v[0:3]
    ds_read_b64_tr_b16 v[96:97], v128 offset:32768
    ds_read_b64_tr_b16 v[98:99], v128 offset:34816
    s_waitcnt lgkmcnt(14)
    v_mfma_f32_16x16x32_bf16 v[4:7], v[100:103], v[48:51], v[4:7]
    ds_read_b64_tr_b16 v[100:101], v129 offset:32768
    ds_read_b64_tr_b16 v[102:103], v129 offset:34816
    s_waitcnt lgkmcnt(14)
    v_mfma_f32_16x16x32_bf16 v[8:11], v[104:107], v[48:51], v[8:11]
    ds_read_b64_tr_b16 v[104:105], v130 offset:32768
    ds_read_b64_tr_b16 v[106:107], v130 offset:34816
    s_waitcnt lgkmcnt(14)
    v_mfma_f32_16x16x32_bf16 v[12:15], v[108:111], v[48:51], v[12:15]
    ds_read_b64_tr_b16 v[108:109], v131 offset:32768
    ds_read_b64_tr_b16 v[110:111], v131 offset:34816
    s_waitcnt lgkmcnt(14)
    v_mfma_f32_16x16x32_bf16 v[0:3], v[112:115], v[56:59], v[0:3]
    ds_read_b64_tr_b16 v[112:113], v128 offset:36864
    ds_read_b64_tr_b16 v[114:115], v128 offset:38912
    s_waitcnt lgkmcnt(14)
    v_mfma_f32_16x16x32_bf16 v[4:7], v[116:119], v[56:59], v[4:7]
    ds_read_b64_tr_b16 v[116:117], v129 offset:36864
    ds_read_b64_tr_b16 v[118:119], v129 offset:38912
    s_waitcnt lgkmcnt(14)
    v_mfma_f32_16x16x32_bf16 v[8:11], v[120:123], v[56:59], v[8:11]
    ds_read_b64_tr_b16 v[120:121], v130 offset:36864
    ds_read_b64_tr_b16 v[122:123], v130 offset:38912
    s_waitcnt lgkmcnt(14)
    v_mfma_f32_16x16x32_bf16 v[12:15], v[124:127], v[56:59], v[12:15]
    ds_read_b64_tr_b16 v[124:125], v131 offset:36864
    ds_read_b64_tr_b16 v[126:127], v131 offset:38912
    s_waitcnt vmcnt(0)
    s_barrier
    s_waitcnt lgkmcnt(14)
    v_mfma_f32_16x16x32_bf16 v[0:3], v[96:99], v[64:67], v[0:3]
    ds_read_b64_tr_b16 v[96:97], v128 offset:49152
    ds_read_b64_tr_b16 v[98:99], v128 offset:51200
    s_waitcnt lgkmcnt(14)
    v_mfma_f32_16x16x32_bf16 v[4:7], v[100:103], v[64:67], v[4:7]
    ds_read_b64_tr_b16 v[100:101], v129 offset:49152
    ds_read_b64_tr_b16 v[102:103], v129 offset:51200
    s_waitcnt lgkmcnt(14)
    v_mfma_f32_16x16x32_bf16 v[8:11], v[104:107], v[64:67], v[8:11]
    ds_read_b64_tr_b16 v[104:105], v130 offset:49152
    ds_read_b64_tr_b16 v[106:107], v130 offset:51200
    s_waitcnt lgkmcnt(14)
    v_mfma_f32_16x16x32_bf16 v[12:15], v[108:111], v[64:67], v[12:15]
    ds_read_b64_tr_b16 v[108:109], v131 offset:49152
    ds_read_b64_tr_b16 v[110:111], v131 offset:51200
    s_waitcnt lgkmcnt(14)
    v_mfma_f32_16x16x32_bf16 v[0:3], v[112:115], v[72:75], v[0:3]
    ds_read_b64_tr_b16 v[112:113], v128 offset:53248
    ds_read_b64_tr_b16 v[114:115], v128 offset:55296
    s_waitcnt lgkmcnt(14)
    v_mfma_f32_16x16x32_bf16 v[4:7], v[116:119], v[72:75], v[4:7]
    ds_read_b64_tr_b16 v[116:117], v129 offset:53248
    ds_read_b64_tr_b16 v[118:119], v129 offset:55296
    s_waitcnt lgkmcnt(14)
    v_mfma_f32_16x16x32_bf16 v[8:11], v[120:123], v[72:75], v[8:11]
    ds_read_b64_tr_b16 v[120:121], v130 offset:53248
    ds_read_b64_tr_b16 v[122:123], v130 offset:55296
    s_waitcnt lgkmcnt(14)
    v_mfma_f32_16x16x32_bf16 v[12:15], v[124:127], v[72:75], v[12:15]
    ds_read_b64_tr_b16 v[124:125], v131 offset:53248
    ds_read_b64_tr_b16 v[126:127], v131 offset:55296
    s_waitcnt lgkmcnt(14)
    v_mfma_f32_16x16x32_bf16 v[0:3], v[96:99], v[80:83], v[0:3]
    s_waitcnt lgkmcnt(12)
    v_mfma_f32_16x16x32_bf16 v[4:7], v[100:103], v[80:83], v[4:7]
    s_waitcnt lgkmcnt(10)
    v_mfma_f32_16x16x32_bf16 v[8:11], v[104:107], v[80:83], v[8:11]
    s_waitcnt lgkmcnt(8)
    v_mfma_f32_16x16x32_bf16 v[12:15], v[108:111], v[80:83], v[12:15]
    s_waitcnt lgkmcnt(6)
    v_mfma_f32_16x16x32_bf16 v[0:3], v[112:115], v[88:91], v[0:3]
    s_waitcnt lgkmcnt(4)
    v_mfma_f32_16x16x32_bf16 v[4:7], v[116:119], v[88:91], v[4:7]
    s_waitcnt lgkmcnt(2)
    v_mfma_f32_16x16x32_bf16 v[8:11], v[120:123], v[88:91], v[8:11]
    s_waitcnt lgkmcnt(0)
    v_mfma_f32_16x16x32_bf16 v[12:15], v[124:127], v[88:91], v[12:15]
    s_lshl_b32 s21, s20, 13
    v_add_u32 v135, s21, v132
    s_cmp_eq_u32 s38, 0
    s_cbranch_scc1 k2_lob
    s_nop 7
    ds_write_b128 v135, v[0:3]
    ds_write_b128 v135, v[4:7] offset:1024
    ds_write_b128 v135, v[8:11] offset:2048
    ds_write_b128 v135, v[12:15] offset:3072
    s_waitcnt lgkmcnt(0)
    s_barrier
    s_branch k2_done
k2_lob:
    s_barrier
    ds_read_b128 v[32:35], v135
    ds_read_b128 v[36:39], v135 offset:1024
    ds_read_b128 v[40:43], v135 offset:2048
    ds_read_b128 v[44:47], v135 offset:3072
    s_waitcnt lgkmcnt(0)
    s_nop 7
    v_add_f32 v0, v0, v32
    v_add_f32 v1, v1, v33
    v_add_f32 v2, v2, v34
    v_add_f32 v3, v3, v35
    v_add_f32 v4, v4, v36
    v_add_f32 v5, v5, v37
    v_add_f32 v6, v6, v38
    v_add_f32 v7, v7, v39
    v_add_f32 v8, v8, v40
    v_add_f32 v9, v9, v41
    v_add_f32 v10, v10, v42
    v_add_f32 v11, v11, v43
    v_add_f32 v12, v12, v44
    v_add_f32 v13, v13, v45
    v_add_f32 v14, v14, v46
    v_add_f32 v15, v15, v47
    s_lshl_b32 s21, s20, 16
    v_cvt_pk_bf16_f32 v0, v0, v1
    v_cvt_pk_bf16_f32 v1, v2, v3
    v_cvt_pk_bf16_f32 v2, v4, v5
    v_cvt_pk_bf16_f32 v3, v6, v7
    s_nop 0
    v_permlane32_swap_b32 v0, v2
    v_permlane32_swap_b32 v1, v3
    s_nop 0
    v_permlane16_swap_b32 v0, v2
    v_permlane16_swap_b32 v1, v3
    s_nop 1
    buffer_store_dwordx4 v[0:3], v134, s[16:19], s21 offen
    v_cvt_pk_bf16_f32 v8, v8, v9
    v_cvt_pk_bf16_f32 v9, v10, v11
    v_cvt_pk_bf16_f32 v10, v12, v13
    v_cvt_pk_bf16_f32 v11, v14, v15
    s_nop 0
    v_permlane32_swap_b32 v8, v10
    v_permlane32_swap_b32 v9, v11
    s_nop 0
    v_permlane16_swap_b32 v8, v10
    v_permlane16_swap_b32 v9, v11
    s_nop 1
    buffer_store_dwordx4 v[8:11], v134, s[16:19], s21 offen offset:64
    s_add_u32 s21, s21, 32768
    s_branch k2_done
k2_w3e:
    s_add_u32 m0, s25, 0
    s_nop 0
    buffer_load_dwordx4 v133, s[8:11], s26 offen lds
    s_add_u32 m0, s25, 1024
    s_add_u32 s21, s26, 8192
    buffer_load_dwordx4 v133, s[8:11], s21 offen lds
    s_add_u32 s26, s26, 131072
    s_add_u32 m0, s25, 16384
    s_nop 0
    buffer_load_dwordx4 v133, s[8:11], s26 offen lds
    s_add_u32 m0, s25, 17408
    s_add_u32 s21, s26, 8192
    buffer_load_dwordx4 v133, s[8:11], s21 offen lds
    s_add_u32 s26, s26, 131072
    s_add_u32 m0, s25, 32768
    s_nop 0
    buffer_load_dwordx4 v133, s[8:11], s26 offen lds
    s_add_u32 m0, s25, 33792
    s_add_u32 s21, s26, 8192
    buffer_load_dwordx4 v133, s[8:11], s21 offen lds
    s_add_u32 s26, s26, 131072
    s_mul_i32 s21, s33, 208
    s_lshl_b32 s22, s36, 4
    s_add_u32 s21, s21, s22
    s_lshl_b32 s21, s21, 11
    s_lshl_b32 s22, s30, 10
    s_add_u32 s21, s21, s22
    s_lshl_b32 s22, s32, 7
    s_add_u32 s21, s21, s22
    s_add_u32 s16, s42, s21
    s_addc_u32 s17, s43, 0
    s_lshl_b32 s21, s35, 15
    s_sub_u32 s18, s21, 1920
    s_mov_b32 s19, 131072
    v_and_b32 v140, 1, v136
    v_lshlrev_b32 v140, 1, v140
    v_lshrrev_b32 v128, 1, v138
    v_or_b32 v140, v140, v128
    v_lshlrev_b32 v128, 5, v140
    v_lshl_add_u32 v128, v139, 3, v128
    v_lshl_add_u32 v128, v138, 7, v128
    v_lshl_add_u32 v128, v136, 9, v128
    v_xor_b32 v129, 32, v128
    v_xor_b32 v130, 64, v128
    v_xor_b32 v131, 96, v128
    v_lshlrev_b32 v134, 11, v137
    v_lshl_add_u32 v134, v136, 4, v134
    s_lshl_b32 s21, s38, 13
    v_add_u32 v128, s21, v128
    v_add_u32 v129, s21, v129
    v_add_u32 v130, s21, v130
    v_add_u32 v131, s21, v131
    s_waitcnt vmcnt(4)
    s_barrier
    s_waitcnt vmcnt(2)
    s_barrier
    s_add_u32 m0, s25, 49152
    s_nop 0
    buffer_load_dwordx4 v133, s[8:11], s26 offen lds
    s_add_u32 m0, s25, 50176
    s_add_u32 s21, s26, 8192
    buffer_load_dwordx4 v133, s[8:11], s21 offen lds
    s_add_u32 s26, s26, 131072
    s_waitcnt vmcnt(2)
    s_barrier
    s_add_u32 m0, s25, 0
    s_nop 0
    buffer_load_dwordx4 v133, s[8:11], s26 offen lds
    s_add_u32 m0, s25, 1024
    s_add_u32 s21, s26, 8192
    buffer_load_dwordx4 v133, s[8:11], s21 offen lds
    s_add_u32 s26, s26, 131072
    s_waitcnt vmcnt(2)
    s_barrier
    s_add_u32 m0, s25, 16384
    s_nop 0
    buffer_load_dwordx4 v133, s[8:11], s26 offen lds
    s_add_u32 m0, s25, 17408
    s_add_u32 s21, s26, 8192
    buffer_load_dwordx4 v133, s[8:11], s21 offen lds
    s_add_u32 s26, s26, 131072
    s_waitcnt vmcnt(2)
    s_barrier
    s_add_u32 m0, s25, 32768
    s_nop 0
    buffer_load_dwordx4 v133, s[8:11], s26 offen lds
    s_add_u32 m0, s25, 33792
    s_add_u32 s21, s26, 8192
    buffer_load_dwordx4 v133, s[8:11], s21 offen lds
    s_add_u32 s26, s26, 131072
    s_mov_b32 s29, 0
k2_loopc:
    s_waitcnt vmcnt(2)
    s_barrier
    s_add_u32 m0, s25, 49152
    s_nop 0
    buffer_load_dwordx4 v133, s[8:11], s26 offen lds
    s_add_u32 m0, s25, 50176
    s_add_u32 s21, s26, 8192
    buffer_load_dwordx4 v133, s[8:11], s21 offen lds
    s_add_u32 s26, s26, 131072
    s_waitcnt vmcnt(2)
    s_barrier
    s_add_u32 m0, s25, 0
    s_nop 0
    buffer_load_dwordx4 v133, s[8:11], s26 offen lds
    s_add_u32 m0, s25, 1024
    s_add_u32 s21, s26, 8192
    buffer_load_dwordx4 v133, s[8:11], s21 offen lds
    s_add_u32 s26, s26, 131072
    s_waitcnt vmcnt(2)
    s_barrier
    s_add_u32 m0, s25, 16384
    s_nop 0
    buffer_load_dwordx4 v133, s[8:11], s26 offen lds
    s_add_u32 m0, s25, 17408
    s_add_u32 s21, s26, 8192
    buffer_load_dwordx4 v133, s[8:11], s21 offen lds
    s_add_u32 s26, s26, 131072
    s_waitcnt vmcnt(2)
    s_barrier
    s_add_u32 m0, s25, 32768
    s_nop 0
    buffer_load_dwordx4 v133, s[8:11], s26 offen lds
    s_add_u32 m0, s25, 33792
    s_add_u32 s21, s26, 8192
    buffer_load_dwordx4 v133, s[8:11], s21 offen lds
    s_add_u32 s26, s26, 131072
    s_add_u32 s29, s29, 1
    s_cmp_lt_u32 s29, 6
    s_cbranch_scc1 k2_loopc
    s_waitcnt vmcnt(2)
    s_barrier
    s_add_u32 m0, s25, 49152
    s_nop 0
    buffer_load_dwordx4 v133, s[8:11], s26 offen lds
    s_add_u32 m0, s25, 50176
    s_add_u32 s21, s26, 8192
    buffer_load_dwordx4 v133, s[8:11], s21 offen lds
    s_add_u32 s26, s26, 131072
    s_waitcnt vmcnt(2)
    s_barrier
    s_waitcnt vmcnt(0)
    s_barrier
    s_lshl_b32 s21, s20, 13
    v_add_u32 v135, s21, v132
    s_cmp_eq_u32 s38, 0
    s_cbranch_scc1 k2_loc
    s_nop 7
    s_waitcnt lgkmcnt(0)
    s_barrier
    s_branch k2_done
k2_loc:
    s_barrier
    s_waitcnt lgkmcnt(0)
    s_nop 7
    s_lshl_b32 s21, s20, 16
    s_branch k2_done
k2_end:
k2_done:
    s_endpgm
.section .rodata,"a"
.p2align 6
.amdhsa_kernel concat_heads__mha_block_cached__mha_block_cached__near_ridge_kernel
  .amdhsa_next_free_vgpr 256
  .amdhsa_next_free_sgpr 102
  .amdhsa_accum_offset 256
  .amdhsa_group_segment_fixed_size 0
  .amdhsa_kernarg_size 104
  .amdhsa_user_sgpr_count 2
  .amdhsa_user_sgpr_kernarg_segment_ptr 1
  .amdhsa_system_sgpr_workgroup_id_x 1
.end_amdhsa_kernel
.p2align 6
.amdhsa_kernel oproj_kernel
  .amdhsa_next_free_vgpr 144
  .amdhsa_next_free_sgpr 102
  .amdhsa_accum_offset 144
  .amdhsa_group_segment_fixed_size 0
  .amdhsa_kernarg_size 104
  .amdhsa_user_sgpr_count 2
  .amdhsa_user_sgpr_kernarg_segment_ptr 1
  .amdhsa_system_sgpr_workgroup_id_x 1
.end_amdhsa_kernel
```
